```python
import torch

def _softmax(x, axis=-1):
    return torch.softmax(x, dim=axis)

def _gelu(x):
    return torch.nn.functional.gelu(x, approximate='tanh')

def _silu(x):
    return torch.nn.functional.silu(x)

def _sigmoid(x):
    return torch.sigmoid(x)

def _layernorm(x, axis=-1, eps=1e-05):
    m = x.mean(dim=axis, keepdim=True)
    v = x.var(dim=axis, keepdim=True, unbiased=False)
    return (x - m) / torch.sqrt(v + eps)

def _scatter_add(tgt, idx, src, axis=0):
    return tgt.clone().index_add_(axis, idx, src)

def _segment_sum(src, seg, n):
    out = torch.zeros((n,) + src.shape[1:], dtype=src.dtype)
    return out.index_add_(0, seg, src)

def _pad(x, pw):
    flat = tuple((v for pair in reversed(pw) for v in pair))
    return torch.nn.functional.pad(x, flat)
kernel_name = 'gated_mix__memory_aug_recurrent_mem_tr__glu_gated_bilinear__prompt'

def setup_inputs():

    _w = lambda a: (lambda t: t.to(torch.bfloat16) if t.is_floating_point() else t)(torch.as_tensor(a))

    def _A_setup():
        B, S, Dm = (1, 2048, 576)
        H, Dh = (32, 128)
        M, seg = (8, 32)
        seg = min(seg, S)
        S = S // seg * seg
        return {'x': _w((lambda *s: torch.randn(*s, dtype=torch.bfloat16) * 0.05)(B, S, Dm)), 'mem0': _w((lambda *s: torch.randn(*s, dtype=torch.bfloat16) * 0.4)(B, M, Dm)), 'Wq': _w((lambda *s: torch.randn(*s, dtype=torch.bfloat16) * 6.4)(Dm, H, Dh) * Dm ** (-0.5)), 'Wk': _w((lambda *s: torch.randn(*s, dtype=torch.bfloat16) * 6.4)(Dm, H, Dh) * Dm ** (-0.5)), 'Wv': _w((lambda *s: torch.randn(*s, dtype=torch.bfloat16) * 0.4)(Dm, H, Dh) * Dm ** (-0.5)), 'Wo': _w((lambda *s: torch.randn(*s, dtype=torch.bfloat16) * 0.4)(H, Dh, Dm) * (H * Dh) ** (-0.5)), 'seg_len': seg}
    _A_in = _A_setup()

    def _B_setup():
        B, S, D, F = (1, 2048, 576, 4608)
        return {'x': _w((lambda *s: torch.randn(*s, dtype=torch.bfloat16) * 0.05)(B, S, D)), 'w_gate': _w((lambda *s: torch.randn(*s, dtype=torch.bfloat16) * 1.6)(D, F) * D ** (-0.5)), 'w_up': _w((lambda *s: torch.randn(*s, dtype=torch.bfloat16) * 1.6)(D, F) * D ** (-0.5)), 'w_down': _w((lambda *s: torch.randn(*s, dtype=torch.bfloat16) * 1.6)(F, D) * F ** (-0.5))}
    _B_in = _B_setup()
    return {'A_x': _A_in['x'], 'A_mem0': _A_in['mem0'], 'A_Wq': _A_in['Wq'], 'A_Wk': _A_in['Wk'], 'A_Wv': _A_in['Wv'], 'A_Wo': _A_in['Wo'], 'A_seg_len': _A_in['seg_len'], 'B_x': _B_in['x'], 'B_w_gate': _B_in['w_gate'], 'B_w_up': _B_in['w_up'], 'B_w_down': _B_in['w_down'], 'gate_w': _w((lambda *s: torch.randn(*s, dtype=torch.bfloat16) * 0.05)(576) * 16.0)}

def reference(A_x, A_mem0, A_Wq, A_Wk, A_Wv, A_Wo, A_seg_len, B_x, B_w_gate, B_w_up, B_w_down, gate_w):

    def _A_ref(x, mem0, Wq, Wk, Wv, Wo, seg_len):
        B, S, Dm = x.shape
        H, Dh = (Wq.shape[1], Wq.shape[2])
        M = mem0.shape[1]
        scale = Dh ** (-0.5)
        n_seg = S // seg_len
        L = M + seg_len
        idx = torch.arange(L)
        mask = (idx[:, None] < M) | (idx[:, None] >= idx[None, :])
        mem = mem0
        outs = []
        for s in range(n_seg):
            xs = x[:, s * seg_len:(s + 1) * seg_len, :].clone()
            h = torch.concatenate([mem, xs], axis=1)
            q = torch.einsum('btd,dhe->bhte', h, Wq)
            k = torch.einsum('btd,dhe->bhte', h, Wk)
            v = torch.einsum('btd,dhe->bhte', h, Wv)
            scores = torch.einsum('bhqe,bhke->bhqk', q, k) * scale
            scores = torch.where(mask[None, None], scores, -1000000000.0)
            p = _softmax(scores, axis=-1)
            o = torch.einsum('bhqk,bhke->bhqe', p, v)
            o = torch.einsum('bhte,hed->btd', o, Wo)
            mem = o[:, :M, :].clone()
            outs.append(o[:, M:, :])
        return torch.concatenate(outs, axis=1)

    def _B_ref(x, w_gate, w_up, w_down):
        g = torch.einsum('bsd,df->bsf', x, w_gate)
        u = torch.einsum('bsd,df->bsf', x, w_up)
        h = g * u
        return torch.einsum('bsf,fd->bsd', h, w_down)
    x = A_x
    g = _sigmoid((x * gate_w).sum(-1, keepdims=True))
    a = _A_ref(x, A_mem0, A_Wq, A_Wk, A_Wv, A_Wo, A_seg_len)
    b = _B_ref(x, B_w_gate, B_w_up, B_w_down)
    return g * a + (1 - g) * b
```

```asm
; @launch grid=(256,1,1) block=(256,1,1) lds=163840
.amdgcn_target "amdgcn-amd-amdhsa--gfx950"
.text
.globl gated_mix__memory_aug_recurrent_mem_tr__glu_gated_bilinear__prompt_kernel
.p2align 8
.type gated_mix__memory_aug_recurrent_mem_tr__glu_gated_bilinear__prompt_kernel,@function
gated_mix__memory_aug_recurrent_mem_tr__glu_gated_bilinear__prompt_kernel:
    s_cmp_ge_u32 s2, 256
    s_cbranch_scc0 L_gated_mix__memory_aug_recurrent_mem_tr__glu_gated_bilinear__prompt_kernel_go
    s_endpgm
L_gated_mix__memory_aug_recurrent_mem_tr__glu_gated_bilinear__prompt_kernel_go:
    s_load_dwordx2 s[4:5], s[0:1], 112
    s_load_dwordx2 s[8:9], s[0:1], 104
    v_lshrrev_b32 v1, 6, v0
    s_waitcnt lgkmcnt(0)
    s_mov_b32 s6, 268435456
    s_mov_b32 s7, 0x00020000
    s_mov_b32 s10, 256
    s_mov_b32 s11, 0x00020000
    v_readfirstlane_b32 s13, v1
    s_getreg_b32 s98, hwreg(HW_REG_XCC_ID)
    s_add_u32 s98, s98, 5
    s_and_b32 s98, s98, 7
    s_cmp_eq_u32 s13, 0
    s_cbranch_scc0 L_role_wait
    s_lshl_b32 s20, s98, 5
    s_mov_b64 exec, 1
    v_mov_b32 v1, 1
    buffer_atomic_add v1, off, s[8:11], s20 offset:0 sc0
    s_waitcnt vmcnt(0)
    v_readfirstlane_b32 s21, v1
    s_nop 0
    s_add_u32 s99, s20, s21
    s_cmp_lt_u32 s21, 32
    s_cbranch_scc1 L_role_pub
    v_mov_b32 v1, 1
    buffer_atomic_add v1, off, s[8:11], 0 offset:4 sc0
    s_waitcnt vmcnt(0)
    v_readfirstlane_b32 s22, v1
    s_mov_b32 s23, 0
L_role_all:
    s_add_u32 s23, s23, 1
    s_cmp_gt_u32 s23, 0x20000
    s_cbranch_scc1 L_fail
    s_mov_b32 s24, 0
    buffer_load_dword v2, off, s[8:11], 0 offset:0 sc1
    buffer_load_dword v3, off, s[8:11], 0 offset:32 sc1
    buffer_load_dword v4, off, s[8:11], 0 offset:64 sc1
    buffer_load_dword v5, off, s[8:11], 0 offset:96 sc1
    buffer_load_dword v6, off, s[8:11], 0 offset:128 sc1
    buffer_load_dword v7, off, s[8:11], 0 offset:160 sc1
    buffer_load_dword v8, off, s[8:11], 0 offset:192 sc1
    buffer_load_dword v9, off, s[8:11], 0 offset:224 sc1
    s_waitcnt vmcnt(0)
    v_readfirstlane_b32 s30, v2
    v_readfirstlane_b32 s31, v3
    v_readfirstlane_b32 s32, v4
    v_readfirstlane_b32 s33, v5
    v_readfirstlane_b32 s34, v6
    v_readfirstlane_b32 s35, v7
    v_readfirstlane_b32 s36, v8
    v_readfirstlane_b32 s37, v9
    s_add_u32 s24, s24, s30
    s_add_u32 s24, s24, s31
    s_add_u32 s24, s24, s32
    s_add_u32 s24, s24, s33
    s_add_u32 s24, s24, s34
    s_add_u32 s24, s24, s35
    s_add_u32 s24, s24, s36
    s_add_u32 s24, s24, s37
    s_cmp_lt_u32 s24, 256
    s_cbranch_scc1 L_role_all
    s_min_u32 s25, s30, 32
    s_sub_u32 s26, 32, s25
    s_add_u32 s99, s25, 0
    s_add_u32 s99, s99, s22
    s_cmp_lt_u32 s22, s26
    s_cbranch_scc1 L_role_pub
    s_sub_u32 s22, s22, s26
    s_min_u32 s25, s31, 32
    s_sub_u32 s26, 32, s25
    s_add_u32 s99, s25, 32
    s_add_u32 s99, s99, s22
    s_cmp_lt_u32 s22, s26
    s_cbranch_scc1 L_role_pub
    s_sub_u32 s22, s22, s26
    s_min_u32 s25, s32, 32
    s_sub_u32 s26, 32, s25
    s_add_u32 s99, s25, 64
    s_add_u32 s99, s99, s22
    s_cmp_lt_u32 s22, s26
    s_cbranch_scc1 L_role_pub
    s_sub_u32 s22, s22, s26
    s_min_u32 s25, s33, 32
    s_sub_u32 s26, 32, s25
    s_add_u32 s99, s25, 96
    s_add_u32 s99, s99, s22
    s_cmp_lt_u32 s22, s26
    s_cbranch_scc1 L_role_pub
    s_sub_u32 s22, s22, s26
    s_min_u32 s25, s34, 32
    s_sub_u32 s26, 32, s25
    s_add_u32 s99, s25, 128
    s_add_u32 s99, s99, s22
    s_cmp_lt_u32 s22, s26
    s_cbranch_scc1 L_role_pub
    s_sub_u32 s22, s22, s26
    s_min_u32 s25, s35, 32
    s_sub_u32 s26, 32, s25
    s_add_u32 s99, s25, 160
    s_add_u32 s99, s99, s22
    s_cmp_lt_u32 s22, s26
    s_cbranch_scc1 L_role_pub
    s_sub_u32 s22, s22, s26
    s_min_u32 s25, s36, 32
    s_sub_u32 s26, 32, s25
    s_add_u32 s99, s25, 192
    s_add_u32 s99, s99, s22
    s_cmp_lt_u32 s22, s26
    s_cbranch_scc1 L_role_pub
    s_sub_u32 s22, s22, s26
    s_min_u32 s25, s37, 32
    s_sub_u32 s26, 32, s25
    s_add_u32 s99, s25, 224
    s_add_u32 s99, s99, s22
    s_cmp_lt_u32 s22, s26
    s_cbranch_scc1 L_role_pub
    s_sub_u32 s22, s22, s26
    s_branch L_fail
L_role_pub:
    v_mov_b32 v1, s99
    v_mov_b32 v2, 0
    ds_write_b32 v2, v1
    s_waitcnt lgkmcnt(0)
    s_mov_b64 exec, -1
L_role_wait:
    s_barrier
    v_mov_b32 v2, 0
    ds_read_b32 v1, v2
    s_waitcnt lgkmcnt(0)
    v_readfirstlane_b32 s99, v1
    s_nop 0
    s_and_b32 s99, s99, 255
    s_barrier
    s_cmp_lt_u32 s99, 32
    s_cbranch_scc0 L_worker
    s_mov_b32 s12, s99
    s_load_dwordx2 s[32:33], s[0:1], 16
    s_load_dwordx2 s[36:37], s[0:1], 24
    s_load_dwordx2 s[40:41], s[0:1], 32
    s_load_dwordx2 s[44:45], s[0:1], 40
    s_load_dwordx2 s[60:61], s[0:1], 8
    s_waitcnt lgkmcnt(0)
    s_mov_b32 s34, 4718592
    s_mov_b32 s35, 0x00020000
    s_mov_b32 s38, 4718592
    s_mov_b32 s39, 0x00020000
    s_mov_b32 s42, 4718592
    s_mov_b32 s43, 0x00020000
    s_mov_b32 s46, 4718592
    s_mov_b32 s47, 0x00020000
    s_mov_b32 s62, 9216
    s_mov_b32 s63, 0x00020000
    v_and_b32 v12, 63, v0
    v_and_b32 v13, 15, v12
    v_lshrrev_b32 v14, 4, v12
    s_lshl_b32 s48, s13, 15
    v_lshrrev_b32 v15, 2, v13
    v_and_b32 v16, 3, v12
    v_lshrrev_b32 v17, 2, v12
    v_lshlrev_b32 v17, 13, v17
    v_lshl_add_u32 v20, v16, 4, v17
    s_mov_b32 s30, 1152
    v_lshrrev_b32 v17, 3, v12
    v_mul_lo_u32 v17, v17, s30
    v_and_b32 v18, 7, v12
    v_lshl_add_u32 v21, v18, 4, v17
    v_lshrrev_b32 v17, 2, v12
    v_mul_lo_u32 v17, v17, s30
    v_lshl_add_u32 v22, v16, 4, v17
    v_lshrrev_b32 v17, 1, v14
    v_lshlrev_b32 v17, 4, v17
    v_and_b32 v18, 1, v14
    v_lshl_add_u32 v17, v18, 2, v17
    v_and_b32 v18, 1, v15
    v_lshl_add_u32 v17, v18, 3, v17
    v_lshrrev_b32 v18, 1, v15
    v_add_u32 v17, v17, v18
    v_lshlrev_b32 v17, 6, v17
    v_lshl_add_u32 v17, v16, 3, v17
    v_add_u32 v26, s48, v17
    v_and_b32 v18, 1, v15
    v_lshl_add_u32 v23, v18, 5, v26
    v_xor_b32 v27, 512, v23
    v_lshrrev_b32 v17, 1, v15
    v_lshlrev_b32 v17, 4, v17
    v_lshl_add_u32 v17, v14, 1, v17
    v_and_b32 v18, 1, v15
    v_lshlrev_b32 v24, 7, v17
    v_lshl_add_u32 v24, v18, 5, v24
    v_lshl_add_u32 v24, v16, 3, v24
    v_add_u32 v24, s48, v24
    v_lshlrev_b32 v17, 6, v17
    v_lshl_add_u32 v17, v18, 5, v17
    v_lshl_add_u32 v17, v16, 3, v17
    v_add_u32 v25, s48, v17
    s_lshl_b32 s80, s12, 8
    s_lshl_b32 s30, s13, 6
    s_add_u32 s80, s80, s30
    s_mul_i32 s81, s12, 147456
    s_and_b32 s30, s13, 1
    s_mul_i32 s30, s30, 73728
    s_lshr_b32 s31, s13, 1
    s_lshl_b32 s31, s31, 6
    s_add_u32 s31, s31, s30
    s_add_u32 s57, s81, s31
    s_lshl_b32 s31, s13, 8
    s_add_u32 s81, s81, s31
    s_sub_u32 s86, s81, s30
    s_add_u32 s81, s81, s30
    s_add_u32 m0, s48, 0
    s_add_u32 s30, s81, 0
    buffer_load_dwordx4 v21, s[44:47], s30 offen lds
    s_add_u32 m0, s48, 1024
    s_add_u32 s30, s81, 9216
    buffer_load_dwordx4 v21, s[44:47], s30 offen lds
    s_add_u32 m0, s48, 2048
    s_add_u32 s30, s81, 18432
    buffer_load_dwordx4 v21, s[44:47], s30 offen lds
    s_add_u32 m0, s48, 3072
    s_add_u32 s30, s81, 27648
    buffer_load_dwordx4 v21, s[44:47], s30 offen lds
    s_add_u32 m0, s48, 4096
    s_add_u32 s30, s81, 36864
    buffer_load_dwordx4 v21, s[44:47], s30 offen lds
    s_add_u32 m0, s48, 5120
    s_add_u32 s30, s81, 46080
    buffer_load_dwordx4 v21, s[44:47], s30 offen lds
    s_add_u32 m0, s48, 6144
    s_add_u32 s30, s81, 55296
    buffer_load_dwordx4 v21, s[44:47], s30 offen lds
    s_add_u32 m0, s48, 7168
    s_add_u32 s30, s81, 64512
    buffer_load_dwordx4 v21, s[44:47], s30 offen lds
    s_add_u32 m0, s48, 8192
    s_add_u32 s30, s86, 73728
    buffer_load_dwordx4 v21, s[44:47], s30 offen lds
    s_add_u32 m0, s48, 9216
    s_add_u32 s30, s86, 82944
    buffer_load_dwordx4 v21, s[44:47], s30 offen lds
    s_add_u32 m0, s48, 10240
    s_add_u32 s30, s86, 92160
    buffer_load_dwordx4 v21, s[44:47], s30 offen lds
    s_add_u32 m0, s48, 11264
    s_add_u32 s30, s86, 101376
    buffer_load_dwordx4 v21, s[44:47], s30 offen lds
    s_add_u32 m0, s48, 12288
    s_add_u32 s30, s86, 110592
    buffer_load_dwordx4 v21, s[44:47], s30 offen lds
    s_add_u32 m0, s48, 13312
    s_add_u32 s30, s86, 119808
    buffer_load_dwordx4 v21, s[44:47], s30 offen lds
    s_add_u32 m0, s48, 14336
    s_add_u32 s30, s86, 129024
    buffer_load_dwordx4 v21, s[44:47], s30 offen lds
    s_add_u32 m0, s48, 15360
    s_add_u32 s30, s86, 138240
    buffer_load_dwordx4 v21, s[44:47], s30 offen lds
    s_add_u32 m0, s48, 16384
    s_add_u32 s30, s81, 128
    buffer_load_dwordx4 v21, s[44:47], s30 offen lds
    s_add_u32 m0, s48, 17408
    s_add_u32 s30, s81, 9344
    buffer_load_dwordx4 v21, s[44:47], s30 offen lds
    s_add_u32 m0, s48, 18432
    s_add_u32 s30, s81, 18560
    buffer_load_dwordx4 v21, s[44:47], s30 offen lds
    s_add_u32 m0, s48, 19456
    s_add_u32 s30, s81, 27776
    buffer_load_dwordx4 v21, s[44:47], s30 offen lds
    s_add_u32 m0, s48, 20480
    s_add_u32 s30, s86, 73856
    buffer_load_dwordx4 v21, s[44:47], s30 offen lds
    s_add_u32 m0, s48, 21504
    s_add_u32 s30, s86, 83072
    buffer_load_dwordx4 v21, s[44:47], s30 offen lds
    s_add_u32 m0, s48, 22528
    s_add_u32 s30, s86, 92288
    buffer_load_dwordx4 v21, s[44:47], s30 offen lds
    s_add_u32 m0, s48, 23552
    s_add_u32 s30, s86, 101504
    buffer_load_dwordx4 v21, s[44:47], s30 offen lds
    s_add_u32 m0, s48, 24576
    s_add_u32 s30, s80, 0
    buffer_load_dwordx4 v20, s[32:35], s30 offen lds
    s_add_u32 m0, s48, 25600
    s_add_u32 s30, s80, 131072
    buffer_load_dwordx4 v20, s[32:35], s30 offen lds
    s_add_u32 m0, s48, 26624
    s_add_u32 s30, s80, 262144
    buffer_load_dwordx4 v20, s[32:35], s30 offen lds
    s_add_u32 m0, s48, 27648
    s_add_u32 s30, s80, 393216
    buffer_load_dwordx4 v20, s[32:35], s30 offen lds
    s_add_u32 m0, s48, 28672
    s_add_u32 s30, s80, 1048576
    buffer_load_dwordx4 v20, s[32:35], s30 offen lds
    s_add_u32 m0, s48, 29696
    s_add_u32 s30, s80, 1179648
    buffer_load_dwordx4 v20, s[32:35], s30 offen lds
    s_add_u32 m0, s48, 30720
    s_add_u32 s30, s80, 1310720
    buffer_load_dwordx4 v20, s[32:35], s30 offen lds
    s_add_u32 m0, s48, 31744
    s_add_u32 s30, s80, 1441792
    buffer_load_dwordx4 v20, s[32:35], s30 offen lds
    s_mul_i32 s58, s13, 4096
    s_add_u32 s53, s58, 131072
    s_add_u32 s21, s58, 117641216
    s_add_u32 s67, s58, 116723832
    v_lshlrev_b32 v15, 4, v12
    v_add_u32 v1, s48, v15
    v_add_u32 v2, 131072, v15
    v_mov_b32 v15, 0x88888888
    v_mov_b32 v16, 0xdddddddd
    v_cmp_gt_u32 vcc, 8, v13
    s_nop 1
    v_cndmask_b32 v0, v16, v15, vcc
    s_mul_i32 s30, s13, 1160
    s_add_u32 s31, s30, 156672
    v_lshlrev_b32 v15, 3, v13
    v_lshrrev_b32 v16, 1, v14
    v_lshl_add_u32 v16, v16, 7, v15
    v_and_b32 v17, 1, v14
    v_lshl_add_u32 v16, v17, 2, v16
    v_add_u32 v4, s31, v16
    v_bfe_u32 v15, v12, 3, 1
    v_lshl_add_u32 v15, v14, 2, v15
    v_lshlrev_b32 v15, 3, v15
    v_bfe_u32 v16, v12, 2, 1
    v_lshl_add_u32 v15, v16, 7, v15
    v_and_b32 v16, 1, v12
    v_mul_u32_u24 v16, 320, v16
    v_add_u32 v16, v16, v15
    v_add_u32 v5, 135168, v16
    v_bfe_u32 v17, v12, 1, 1
    v_mul_u32_u24 v16, 320, v17
    v_add_u32 v16, v16, v15
    v_add_u32 v6, 157248, v16
    s_and_b32 s30, s13, 1
    s_mul_i32 s30, s30, 2320
    v_add_u32 v7, s30, v5
    s_sub_u32 s30, 2320, s30
    v_add_u32 v3, s30, v5
    s_lshl_b32 s30, s13, 11
    s_add_u32 s66, s30, 148480
    s_add_u32 s65, s30, 140288
    s_add_u32 s71, s30, 17408
    v_lshl_add_u32 v8, v12, 2, s66
    s_lshl_b32 s31, s13, 7
    s_add_u32 s87, s31, 131568
    v_xor_b32 v11, 128, v2
    s_mul_i32 s58, s12, 10368
    s_mul_i32 s31, s13, 2048
    s_add_u32 s58, s58, s31
    v_lshrrev_b32 v15, 1, v14
    v_lshlrev_b32 v15, 8, v15
    v_lshl_add_u32 v15, v13, 4, v15
    v_and_b32 v16, 1, v14
    v_lshl_add_u32 v15, v16, 3, v15
    v_add_u32 v9, s58, v15
    s_lshr_b32 s30, s13, 1
    s_lshl_b32 s30, s30, 9
    s_and_b32 s31, s13, 1
    s_lshl_b32 s31, s31, 10
    s_add_u32 s30, s30, s31
    s_lshl_b32 s31, s13, 11
    s_sub_u32 s30, s30, s31
    s_add_u32 s3, s30, 117448704
    s_lshl_b32 s30, s13, 5
    s_add_u32 s30, s30, s12
    s_cmp_lt_u32 s30, 72
    s_cselect_b32 s23, 1, 0
    s_lshl_b32 s31, s30, 7
    s_add_u32 s22, s31, 117772288
    s_sub_u32 s22, s22, s58
    s_add_u32 s56, s22, 1774592
    s_lshr_b32 s31, s12, 3
    s_add_u32 s31, s31, s13
    s_lshl_b32 s31, s31, 3
    s_add_u32 s31, s31, s12
    s_cmp_lt_u32 s13, 2
    s_cselect_b32 s30, s31, s30
    s_lshl_b32 s30, s30, 7
    s_mov_b32 s31, 10368
    v_lshrrev_b32 v15, 3, v12
    v_mul_lo_u32 v15, v15, s31
    v_and_b32 v16, 7, v12
    v_lshl_add_u32 v15, v16, 4, v15
    v_add_u32 v10, s30, v15
    s_mov_b32 s16, 117440512
    s_mov_b32 s17, 117523456
    s_mov_b32 s18, 117606400
    s_mov_b32 s19, 117689344
    s_mov_b32 s20, 117440512
    s_mov_b32 s24, 0x00ff00ff
    s_mov_b32 s25, 0
    s_mov_b32 s26, -1
    s_mov_b32 s27, 0
    s_mov_b32 s28, 0x3e0293ee
    s_lshl_b32 s30, s12, 13
    s_lshl_b32 s31, s13, 11
    s_add_u32 s31, s31, s30
    s_add_u32 s49, s30, s65
    s_add_u32 s49, s49, 16505856
    s_add_u32 s50, s31, 33423360
    s_and_b32 s31, s13, 1
    s_lshl_b32 s31, s31, 12
    s_add_u32 s30, s30, s31
    s_lshr_b32 s31, s13, 1
    s_mul_i32 s31, s31, 16777216
    s_add_u32 s30, s30, s31
    s_add_u32 s64, s30, 16777216
    s_lshl_b32 s30, s12, 2
    s_add_u32 s30, s30, s13
    s_lshl_b32 s31, s12, 7
    s_add_u32 s15, s31, 117781504
    s_lshl_b32 s31, s30, 10
    s_add_u32 s52, s31, 105775104
    s_lshl_b32 s31, s30, 9
    s_add_u32 s51, s31, 100663296
    s_sub_u32 s51, s51, 65536
    s_mul_i32 s84, s13, 1160
    s_add_u32 s84, s84, 91712
    s_mov_b32 s72, 0x30003
    s_mov_b32 s73, 0x30003
    s_mov_b32 s74, 0xc000c
    s_mov_b32 s75, 0xc000c
    s_mov_b32 s76, 0x300030
    s_mov_b32 s77, 0x300030
    s_mov_b32 s78, 0xc000c0
    s_mov_b32 s79, 0xc000c0
    v_mov_b32 v48, 0x3f003f00
    v_mov_b32 v28, 0
    v_mov_b32 v49, 0x3f003f00
    v_mov_b32 v29, 0
    v_mov_b32 v50, 0x3f003f00
    v_mov_b32 v30, 0
    v_mov_b32 v51, 0x3f003f00
    v_mov_b32 v31, 0
    ds_write_b128 v2, v[48:51] offset:30720
    ds_write_b128 v2, v[28:31] offset:31744
    s_waitcnt vmcnt(28)
    ds_read_b64_tr_b16 a[0:1], v24 offset:0
    ds_read_b64_tr_b16 a[2:3], v24 offset:128
    ds_read_b64_tr_b16 a[4:5], v24 offset:1024
    ds_read_b64_tr_b16 a[6:7], v24 offset:1152
    ds_read_b64_tr_b16 a[8:9], v24 offset:64
    ds_read_b64_tr_b16 a[10:11], v24 offset:192
    ds_read_b64_tr_b16 a[12:13], v24 offset:1088
    ds_read_b64_tr_b16 a[14:15], v24 offset:1216
    s_waitcnt lgkmcnt(0)
    s_add_u32 m0, s48, 0
    s_add_u32 s30, s80, 2097152
    buffer_load_dwordx4 v20, s[32:35], s30 offen lds
    s_add_u32 m0, s48, 1024
    s_add_u32 s30, s80, 2228224
    buffer_load_dwordx4 v20, s[32:35], s30 offen lds
    s_add_u32 m0, s48, 2048
    s_add_u32 s30, s80, 2359296
    buffer_load_dwordx4 v20, s[32:35], s30 offen lds
    s_add_u32 m0, s48, 3072
    s_add_u32 s30, s80, 2490368
    buffer_load_dwordx4 v20, s[32:35], s30 offen lds
    s_cmp_eq_u32 s13, 0
    s_cbranch_scc0 Lfj_1
    v_and_b32 v15, 7, v13
    v_mul_u32_u24 v15, 1152, v15
    v_lshrrev_b32 v16, 3, v12
    v_lshl_add_u32 v17, v16, 4, v15
    s_mov_b32 m0, 131072
    s_mov_b32 s30, 0
    buffer_load_dwordx4 v17, s[60:63], s30 offen lds
    s_mov_b32 m0, 132096
    s_mov_b32 s30, 256
    buffer_load_dwordx4 v17, s[60:63], s30 offen lds
    s_mov_b32 m0, 133120
    s_mov_b32 s30, 512
    buffer_load_dwordx4 v17, s[60:63], s30 offen lds
    s_mov_b32 m0, 134144
    s_mov_b32 s30, 768
    buffer_load_dwordx4 v17, s[60:63], s30 offen lds
    s_mov_b32 m0, 135168
    s_mov_b32 s30, 128
    buffer_load_dwordx4 v17, s[60:63], s30 offen lds
    s_mov_b32 m0, 136192
    s_mov_b32 s30, 384
    buffer_load_dwordx4 v17, s[60:63], s30 offen lds
    s_mov_b32 m0, 137216
    s_mov_b32 s30, 640
    buffer_load_dwordx4 v17, s[60:63], s30 offen lds
    s_mov_b32 m0, 138240
    s_mov_b32 s30, 896
    buffer_load_dwordx4 v17, s[60:63], s30 offen lds
    s_mov_b32 m0, 139264
    s_mov_b32 s30, 1024
    buffer_load_dwordx4 v17, s[60:63], s30 offen lds
Lfj_1:
    s_waitcnt vmcnt(28)
    ds_read_b64_tr_b16 a[16:17], v24 offset:4096
    ds_read_b64_tr_b16 a[18:19], v24 offset:4224
    ds_read_b64_tr_b16 a[20:21], v24 offset:5120
    ds_read_b64_tr_b16 a[22:23], v24 offset:5248
    ds_read_b64_tr_b16 a[24:25], v24 offset:4160
    ds_read_b64_tr_b16 a[26:27], v24 offset:4288
    ds_read_b64_tr_b16 a[28:29], v24 offset:5184
    ds_read_b64_tr_b16 a[30:31], v24 offset:5312
    s_waitcnt lgkmcnt(0)
    s_add_u32 m0, s48, 4096
    s_add_u32 s30, s80, 3145728
    buffer_load_dwordx4 v20, s[32:35], s30 offen lds
    s_add_u32 m0, s48, 5120
    s_add_u32 s30, s80, 3276800
    buffer_load_dwordx4 v20, s[32:35], s30 offen lds
    s_add_u32 m0, s48, 6144
    s_add_u32 s30, s80, 3407872
    buffer_load_dwordx4 v20, s[32:35], s30 offen lds
    s_add_u32 m0, s48, 7168
    s_add_u32 s30, s80, 3538944
    buffer_load_dwordx4 v20, s[32:35], s30 offen lds
    s_waitcnt vmcnt(28)
    ds_read_b64_tr_b16 a[32:33], v24 offset:8192
    ds_read_b64_tr_b16 a[34:35], v24 offset:8320
    ds_read_b64_tr_b16 a[36:37], v24 offset:9216
    ds_read_b64_tr_b16 a[38:39], v24 offset:9344
    ds_read_b64_tr_b16 a[40:41], v24 offset:8256
    ds_read_b64_tr_b16 a[42:43], v24 offset:8384
    ds_read_b64_tr_b16 a[44:45], v24 offset:9280
    ds_read_b64_tr_b16 a[46:47], v24 offset:9408
    s_waitcnt lgkmcnt(0)
    s_add_u32 m0, s48, 8192
    s_add_u32 s30, s80, 524288
    buffer_load_dwordx4 v20, s[32:35], s30 offen lds
    s_add_u32 m0, s48, 9216
    s_add_u32 s30, s80, 655360
    buffer_load_dwordx4 v20, s[32:35], s30 offen lds
    s_add_u32 m0, s48, 10240
    s_add_u32 s30, s80, 786432
    buffer_load_dwordx4 v20, s[32:35], s30 offen lds
    s_add_u32 m0, s48, 11264
    s_add_u32 s30, s80, 917504
    buffer_load_dwordx4 v20, s[32:35], s30 offen lds
    s_waitcnt vmcnt(28)
    ds_read_b64_tr_b16 a[48:49], v24 offset:12288
    ds_read_b64_tr_b16 a[50:51], v24 offset:12416
    ds_read_b64_tr_b16 a[52:53], v24 offset:13312
    ds_read_b64_tr_b16 a[54:55], v24 offset:13440
    ds_read_b64_tr_b16 a[56:57], v24 offset:12352
    ds_read_b64_tr_b16 a[58:59], v24 offset:12480
    ds_read_b64_tr_b16 a[60:61], v24 offset:13376
    ds_read_b64_tr_b16 a[62:63], v24 offset:13504
    s_waitcnt lgkmcnt(0)
    s_add_u32 m0, s48, 12288
    s_add_u32 s30, s80, 2621440
    buffer_load_dwordx4 v20, s[32:35], s30 offen lds
    s_add_u32 m0, s48, 13312
    s_add_u32 s30, s80, 2752512
    buffer_load_dwordx4 v20, s[32:35], s30 offen lds
    s_add_u32 m0, s48, 14336
    s_add_u32 s30, s80, 2883584
    buffer_load_dwordx4 v20, s[32:35], s30 offen lds
    s_add_u32 m0, s48, 15360
    s_add_u32 s30, s80, 3014656
    buffer_load_dwordx4 v20, s[32:35], s30 offen lds
    s_waitcnt vmcnt(28)
    ds_read_b64_tr_b16 a[64:65], v24 offset:16384
    ds_read_b64_tr_b16 a[66:67], v24 offset:16512
    ds_read_b64_tr_b16 a[68:69], v24 offset:17408
    ds_read_b64_tr_b16 a[70:71], v24 offset:17536
    ds_read_b64_tr_b16 a[72:73], v24 offset:16448
    ds_read_b64_tr_b16 a[74:75], v24 offset:16576
    ds_read_b64_tr_b16 a[76:77], v24 offset:17472
    ds_read_b64_tr_b16 a[78:79], v24 offset:17600
    s_waitcnt lgkmcnt(0)
    s_add_u32 m0, s48, 16384
    s_add_u32 s30, s80, 3670016
    buffer_load_dwordx4 v20, s[32:35], s30 offen lds
    s_add_u32 m0, s48, 17408
    s_add_u32 s30, s80, 3801088
    buffer_load_dwordx4 v20, s[32:35], s30 offen lds
    s_add_u32 m0, s48, 18432
    s_add_u32 s30, s80, 3932160
    buffer_load_dwordx4 v20, s[32:35], s30 offen lds
    s_add_u32 m0, s48, 19456
    s_add_u32 s30, s80, 4063232
    buffer_load_dwordx4 v20, s[32:35], s30 offen lds
    s_waitcnt vmcnt(28)
    ds_read_b64_tr_b16 a[80:81], v24 offset:20480
    ds_read_b64_tr_b16 a[82:83], v24 offset:20608
    ds_read_b64_tr_b16 a[84:85], v24 offset:21504
    ds_read_b64_tr_b16 a[86:87], v24 offset:21632
    ds_read_b64_tr_b16 a[88:89], v24 offset:20544
    ds_read_b64_tr_b16 a[90:91], v24 offset:20672
    ds_read_b64_tr_b16 a[92:93], v24 offset:21568
    ds_read_b64_tr_b16 a[94:95], v24 offset:21696
    s_waitcnt lgkmcnt(0)
    s_add_u32 m0, s48, 20480
    s_add_u32 s30, s80, 4194304
    buffer_load_dwordx4 v20, s[32:35], s30 offen lds
    s_add_u32 m0, s48, 21504
    s_add_u32 s30, s80, 4325376
    buffer_load_dwordx4 v20, s[32:35], s30 offen lds
    s_add_u32 m0, s48, 22528
    s_add_u32 s30, s80, 4456448
    buffer_load_dwordx4 v20, s[32:35], s30 offen lds
    s_add_u32 m0, s48, 23552
    s_add_u32 s30, s80, 4587520
    buffer_load_dwordx4 v20, s[32:35], s30 offen lds
    s_waitcnt vmcnt(28)
    ds_read_b64_tr_b16 a[96:97], v23 offset:24576
    ds_read_b64_tr_b16 a[98:99], v23 offset:24704
    ds_read_b64_tr_b16 a[100:101], v23 offset:26624
    ds_read_b64_tr_b16 a[102:103], v23 offset:26752
    ds_read_b64_tr_b16 a[104:105], v27 offset:24576
    ds_read_b64_tr_b16 a[106:107], v27 offset:24704
    ds_read_b64_tr_b16 a[108:109], v27 offset:26624
    ds_read_b64_tr_b16 a[110:111], v27 offset:26752
    s_waitcnt lgkmcnt(0)
    s_add_u32 m0, s48, 24576
    s_add_u32 s30, s80, 0
    buffer_load_dwordx4 v20, s[36:39], s30 offen lds
    s_add_u32 m0, s48, 25600
    s_add_u32 s30, s80, 131072
    buffer_load_dwordx4 v20, s[36:39], s30 offen lds
    s_add_u32 m0, s48, 26624
    s_add_u32 s30, s80, 262144
    buffer_load_dwordx4 v20, s[36:39], s30 offen lds
    s_add_u32 m0, s48, 27648
    s_add_u32 s30, s80, 393216
    buffer_load_dwordx4 v20, s[36:39], s30 offen lds
    s_waitcnt vmcnt(28)
    ds_read_b64_tr_b16 a[112:113], v23 offset:28672
    ds_read_b64_tr_b16 a[114:115], v23 offset:28800
    ds_read_b64_tr_b16 a[116:117], v23 offset:30720
    ds_read_b64_tr_b16 a[118:119], v23 offset:30848
    ds_read_b64_tr_b16 a[120:121], v27 offset:28672
    ds_read_b64_tr_b16 a[122:123], v27 offset:28800
    ds_read_b64_tr_b16 a[124:125], v27 offset:30720
    ds_read_b64_tr_b16 a[126:127], v27 offset:30848
    s_waitcnt lgkmcnt(0)
    s_add_u32 m0, s48, 28672
    s_add_u32 s30, s80, 1048576
    buffer_load_dwordx4 v20, s[36:39], s30 offen lds
    s_add_u32 m0, s48, 29696
    s_add_u32 s30, s80, 1179648
    buffer_load_dwordx4 v20, s[36:39], s30 offen lds
    s_add_u32 m0, s48, 30720
    s_add_u32 s30, s80, 1310720
    buffer_load_dwordx4 v20, s[36:39], s30 offen lds
    s_add_u32 m0, s48, 31744
    s_add_u32 s30, s80, 1441792
    buffer_load_dwordx4 v20, s[36:39], s30 offen lds
    s_waitcnt vmcnt(28)
    ds_read_b64_tr_b16 a[128:129], v23 offset:0
    ds_read_b64_tr_b16 a[130:131], v23 offset:128
    ds_read_b64_tr_b16 a[132:133], v23 offset:2048
    ds_read_b64_tr_b16 a[134:135], v23 offset:2176
    ds_read_b64_tr_b16 a[136:137], v27 offset:0
    ds_read_b64_tr_b16 a[138:139], v27 offset:128
    ds_read_b64_tr_b16 a[140:141], v27 offset:2048
    ds_read_b64_tr_b16 a[142:143], v27 offset:2176
    s_waitcnt lgkmcnt(0)
    s_add_u32 m0, s48, 0
    s_add_u32 s30, s80, 2097152
    buffer_load_dwordx4 v20, s[36:39], s30 offen lds
    s_add_u32 m0, s48, 1024
    s_add_u32 s30, s80, 2228224
    buffer_load_dwordx4 v20, s[36:39], s30 offen lds
    s_add_u32 m0, s48, 2048
    s_add_u32 s30, s80, 2359296
    buffer_load_dwordx4 v20, s[36:39], s30 offen lds
    s_add_u32 m0, s48, 3072
    s_add_u32 s30, s80, 2490368
    buffer_load_dwordx4 v20, s[36:39], s30 offen lds
    s_waitcnt vmcnt(28)
    ds_read_b64_tr_b16 a[144:145], v23 offset:4096
    ds_read_b64_tr_b16 a[146:147], v23 offset:4224
    ds_read_b64_tr_b16 a[148:149], v23 offset:6144
    ds_read_b64_tr_b16 a[150:151], v23 offset:6272
    ds_read_b64_tr_b16 a[152:153], v27 offset:4096
    ds_read_b64_tr_b16 a[154:155], v27 offset:4224
    ds_read_b64_tr_b16 a[156:157], v27 offset:6144
    ds_read_b64_tr_b16 a[158:159], v27 offset:6272
    s_waitcnt lgkmcnt(0)
    s_add_u32 m0, s48, 4096
    s_add_u32 s30, s80, 3145728
    buffer_load_dwordx4 v20, s[36:39], s30 offen lds
    s_add_u32 m0, s48, 5120
    s_add_u32 s30, s80, 3276800
    buffer_load_dwordx4 v20, s[36:39], s30 offen lds
    s_add_u32 m0, s48, 6144
    s_add_u32 s30, s80, 3407872
    buffer_load_dwordx4 v20, s[36:39], s30 offen lds
    s_add_u32 m0, s48, 7168
    s_add_u32 s30, s80, 3538944
    buffer_load_dwordx4 v20, s[36:39], s30 offen lds
    s_waitcnt vmcnt(28)
    ds_read_b64_tr_b16 a[160:161], v23 offset:8192
    ds_read_b64_tr_b16 a[162:163], v23 offset:8320
    ds_read_b64_tr_b16 a[164:165], v23 offset:10240
    ds_read_b64_tr_b16 a[166:167], v23 offset:10368
    ds_read_b64_tr_b16 a[168:169], v27 offset:8192
    ds_read_b64_tr_b16 a[170:171], v27 offset:8320
    ds_read_b64_tr_b16 a[172:173], v27 offset:10240
    ds_read_b64_tr_b16 a[174:175], v27 offset:10368
    s_waitcnt lgkmcnt(0)
    s_add_u32 m0, s48, 8192
    s_add_u32 s30, s80, 524288
    buffer_load_dwordx4 v20, s[36:39], s30 offen lds
    s_add_u32 m0, s48, 9216
    s_add_u32 s30, s80, 655360
    buffer_load_dwordx4 v20, s[36:39], s30 offen lds
    s_add_u32 m0, s48, 10240
    s_add_u32 s30, s80, 786432
    buffer_load_dwordx4 v20, s[36:39], s30 offen lds
    s_add_u32 m0, s48, 11264
    s_add_u32 s30, s80, 917504
    buffer_load_dwordx4 v20, s[36:39], s30 offen lds
    s_waitcnt vmcnt(28)
    ds_read_b64_tr_b16 a[176:177], v23 offset:12288
    ds_read_b64_tr_b16 a[178:179], v23 offset:12416
    ds_read_b64_tr_b16 a[180:181], v23 offset:14336
    ds_read_b64_tr_b16 a[182:183], v23 offset:14464
    ds_read_b64_tr_b16 a[184:185], v27 offset:12288
    ds_read_b64_tr_b16 a[186:187], v27 offset:12416
    ds_read_b64_tr_b16 a[188:189], v27 offset:14336
    ds_read_b64_tr_b16 a[190:191], v27 offset:14464
    s_waitcnt lgkmcnt(0)
    s_add_u32 m0, s48, 12288
    s_add_u32 s30, s80, 1572864
    buffer_load_dwordx4 v20, s[36:39], s30 offen lds
    s_add_u32 m0, s48, 13312
    s_add_u32 s30, s80, 1703936
    buffer_load_dwordx4 v20, s[36:39], s30 offen lds
    s_add_u32 m0, s48, 14336
    s_add_u32 s30, s80, 1835008
    buffer_load_dwordx4 v20, s[36:39], s30 offen lds
    s_add_u32 m0, s48, 15360
    s_add_u32 s30, s80, 1966080
    buffer_load_dwordx4 v20, s[36:39], s30 offen lds
    s_waitcnt vmcnt(28)
    ds_read_b64_tr_b16 a[192:193], v23 offset:16384
    ds_read_b64_tr_b16 a[194:195], v23 offset:16512
    ds_read_b64_tr_b16 a[196:197], v23 offset:18432
    ds_read_b64_tr_b16 a[198:199], v23 offset:18560
    ds_read_b64_tr_b16 a[200:201], v27 offset:16384
    ds_read_b64_tr_b16 a[202:203], v27 offset:16512
    ds_read_b64_tr_b16 a[204:205], v27 offset:18432
    ds_read_b64_tr_b16 a[206:207], v27 offset:18560
    s_waitcnt lgkmcnt(0)
    s_add_u32 m0, s48, 16384
    s_add_u32 s30, s80, 3670016
    buffer_load_dwordx4 v20, s[36:39], s30 offen lds
    s_add_u32 m0, s48, 17408
    s_add_u32 s30, s80, 3801088
    buffer_load_dwordx4 v20, s[36:39], s30 offen lds
    s_add_u32 m0, s48, 18432
    s_add_u32 s30, s80, 3932160
    buffer_load_dwordx4 v20, s[36:39], s30 offen lds
    s_add_u32 m0, s48, 19456
    s_add_u32 s30, s80, 4063232
    buffer_load_dwordx4 v20, s[36:39], s30 offen lds
    s_waitcnt vmcnt(28)
    ds_read_b64_tr_b16 a[208:209], v23 offset:20480
    ds_read_b64_tr_b16 a[210:211], v23 offset:20608
    ds_read_b64_tr_b16 a[212:213], v23 offset:22528
    ds_read_b64_tr_b16 a[214:215], v23 offset:22656
    ds_read_b64_tr_b16 a[216:217], v27 offset:20480
    ds_read_b64_tr_b16 a[218:219], v27 offset:20608
    ds_read_b64_tr_b16 a[220:221], v27 offset:22528
    ds_read_b64_tr_b16 a[222:223], v27 offset:22656
    s_waitcnt lgkmcnt(0)
    s_add_u32 m0, s48, 20480
    s_add_u32 s30, s80, 0
    buffer_load_dwordx4 v20, s[40:43], s30 offen lds
    s_add_u32 m0, s48, 21504
    s_add_u32 s30, s80, 131072
    buffer_load_dwordx4 v20, s[40:43], s30 offen lds
    s_add_u32 m0, s48, 22528
    s_add_u32 s30, s80, 262144
    buffer_load_dwordx4 v20, s[40:43], s30 offen lds
    s_add_u32 m0, s48, 23552
    s_add_u32 s30, s80, 393216
    buffer_load_dwordx4 v20, s[40:43], s30 offen lds
    s_waitcnt vmcnt(28)
    ds_read_b64_tr_b16 a[224:225], v23 offset:24576
    ds_read_b64_tr_b16 a[226:227], v23 offset:24704
    ds_read_b64_tr_b16 a[228:229], v23 offset:26624
    ds_read_b64_tr_b16 a[230:231], v23 offset:26752
    ds_read_b64_tr_b16 a[232:233], v27 offset:24576
    ds_read_b64_tr_b16 a[234:235], v27 offset:24704
    ds_read_b64_tr_b16 a[236:237], v27 offset:26624
    ds_read_b64_tr_b16 a[238:239], v27 offset:26752
    s_waitcnt lgkmcnt(0)
    s_add_u32 m0, s48, 24576
    s_add_u32 s30, s80, 1048576
    buffer_load_dwordx4 v20, s[40:43], s30 offen lds
    s_add_u32 m0, s48, 25600
    s_add_u32 s30, s80, 1179648
    buffer_load_dwordx4 v20, s[40:43], s30 offen lds
    s_add_u32 m0, s48, 26624
    s_add_u32 s30, s80, 1310720
    buffer_load_dwordx4 v20, s[40:43], s30 offen lds
    s_add_u32 m0, s48, 27648
    s_add_u32 s30, s80, 1441792
    buffer_load_dwordx4 v20, s[40:43], s30 offen lds
    s_waitcnt vmcnt(28)
    ds_read_b64_tr_b16 a[240:241], v23 offset:28672
    ds_read_b64_tr_b16 a[242:243], v23 offset:28800
    ds_read_b64_tr_b16 a[244:245], v23 offset:30720
    ds_read_b64_tr_b16 a[246:247], v23 offset:30848
    ds_read_b64_tr_b16 a[248:249], v27 offset:28672
    ds_read_b64_tr_b16 a[250:251], v27 offset:28800
    ds_read_b64_tr_b16 a[252:253], v27 offset:30720
    ds_read_b64_tr_b16 a[254:255], v27 offset:30848
    s_waitcnt lgkmcnt(0)
    s_add_u32 m0, s48, 28672
    s_add_u32 s30, s80, 524288
    buffer_load_dwordx4 v20, s[40:43], s30 offen lds
    s_add_u32 m0, s48, 29696
    s_add_u32 s30, s80, 655360
    buffer_load_dwordx4 v20, s[40:43], s30 offen lds
    s_add_u32 m0, s48, 30720
    s_add_u32 s30, s80, 786432
    buffer_load_dwordx4 v20, s[40:43], s30 offen lds
    s_add_u32 m0, s48, 31744
    s_add_u32 s30, s80, 917504
    buffer_load_dwordx4 v20, s[40:43], s30 offen lds
    s_waitcnt vmcnt(28)
    ds_read_b64_tr_b16 v[64:65], v23 offset:0
    ds_read_b64_tr_b16 v[66:67], v23 offset:128
    ds_read_b64_tr_b16 v[68:69], v23 offset:2048
    ds_read_b64_tr_b16 v[70:71], v23 offset:2176
    ds_read_b64_tr_b16 v[72:73], v27 offset:0
    ds_read_b64_tr_b16 v[74:75], v27 offset:128
    ds_read_b64_tr_b16 v[76:77], v27 offset:2048
    ds_read_b64_tr_b16 v[78:79], v27 offset:2176
    s_waitcnt lgkmcnt(0)
    s_add_u32 m0, s48, 0
    s_add_u32 s30, s80, 1572864
    buffer_load_dwordx4 v20, s[40:43], s30 offen lds
    s_add_u32 m0, s48, 1024
    s_add_u32 s30, s80, 1703936
    buffer_load_dwordx4 v20, s[40:43], s30 offen lds
    s_add_u32 m0, s48, 2048
    s_add_u32 s30, s80, 1835008
    buffer_load_dwordx4 v20, s[40:43], s30 offen lds
    s_add_u32 m0, s48, 3072
    s_add_u32 s30, s80, 1966080
    buffer_load_dwordx4 v20, s[40:43], s30 offen lds
    s_waitcnt vmcnt(28)
    ds_read_b64_tr_b16 v[80:81], v23 offset:4096
    ds_read_b64_tr_b16 v[82:83], v23 offset:4224
    ds_read_b64_tr_b16 v[84:85], v23 offset:6144
    ds_read_b64_tr_b16 v[86:87], v23 offset:6272
    ds_read_b64_tr_b16 v[88:89], v27 offset:4096
    ds_read_b64_tr_b16 v[90:91], v27 offset:4224
    ds_read_b64_tr_b16 v[92:93], v27 offset:6144
    ds_read_b64_tr_b16 v[94:95], v27 offset:6272
    s_waitcnt lgkmcnt(0)
    s_add_u32 m0, s48, 4096
    s_add_u32 s30, s80, 2621440
    buffer_load_dwordx4 v20, s[40:43], s30 offen lds
    s_add_u32 m0, s48, 5120
    s_add_u32 s30, s80, 2752512
    buffer_load_dwordx4 v20, s[40:43], s30 offen lds
    s_add_u32 m0, s48, 6144
    s_add_u32 s30, s80, 2883584
    buffer_load_dwordx4 v20, s[40:43], s30 offen lds
    s_add_u32 m0, s48, 7168
    s_add_u32 s30, s80, 3014656
    buffer_load_dwordx4 v20, s[40:43], s30 offen lds
    s_waitcnt vmcnt(28)
    ds_read_b64_tr_b16 v[96:97], v23 offset:8192
    ds_read_b64_tr_b16 v[98:99], v23 offset:8320
    ds_read_b64_tr_b16 v[100:101], v23 offset:10240
    ds_read_b64_tr_b16 v[102:103], v23 offset:10368
    ds_read_b64_tr_b16 v[104:105], v27 offset:8192
    ds_read_b64_tr_b16 v[106:107], v27 offset:8320
    ds_read_b64_tr_b16 v[108:109], v27 offset:10240
    ds_read_b64_tr_b16 v[110:111], v27 offset:10368
    s_waitcnt lgkmcnt(0)
    s_add_u32 m0, s48, 8192
    s_add_u32 s30, s80, 3670016
    buffer_load_dwordx4 v20, s[40:43], s30 offen lds
    s_add_u32 m0, s48, 9216
    s_add_u32 s30, s80, 3801088
    buffer_load_dwordx4 v20, s[40:43], s30 offen lds
    s_add_u32 m0, s48, 10240
    s_add_u32 s30, s80, 3932160
    buffer_load_dwordx4 v20, s[40:43], s30 offen lds
    s_add_u32 m0, s48, 11264
    s_add_u32 s30, s80, 4063232
    buffer_load_dwordx4 v20, s[40:43], s30 offen lds
    s_waitcnt vmcnt(28)
    ds_read_b64_tr_b16 v[112:113], v23 offset:12288
    ds_read_b64_tr_b16 v[114:115], v23 offset:12416
    ds_read_b64_tr_b16 v[116:117], v23 offset:14336
    ds_read_b64_tr_b16 v[118:119], v23 offset:14464
    ds_read_b64_tr_b16 v[120:121], v27 offset:12288
    ds_read_b64_tr_b16 v[122:123], v27 offset:12416
    ds_read_b64_tr_b16 v[124:125], v27 offset:14336
    ds_read_b64_tr_b16 v[126:127], v27 offset:14464
    s_waitcnt lgkmcnt(0)
    s_add_u32 m0, s48, 12288
    s_add_u32 s30, s80, 4194304
    buffer_load_dwordx4 v20, s[40:43], s30 offen lds
    s_add_u32 m0, s48, 13312
    s_add_u32 s30, s80, 4325376
    buffer_load_dwordx4 v20, s[40:43], s30 offen lds
    s_add_u32 m0, s48, 14336
    s_add_u32 s30, s80, 4456448
    buffer_load_dwordx4 v20, s[40:43], s30 offen lds
    s_add_u32 m0, s48, 15360
    s_add_u32 s30, s80, 4587520
    buffer_load_dwordx4 v20, s[40:43], s30 offen lds
    s_waitcnt vmcnt(28)
    ds_read_b64_tr_b16 v[128:129], v23 offset:16384
    ds_read_b64_tr_b16 v[130:131], v23 offset:16512
    ds_read_b64_tr_b16 v[132:133], v23 offset:18432
    ds_read_b64_tr_b16 v[134:135], v23 offset:18560
    ds_read_b64_tr_b16 v[136:137], v27 offset:16384
    ds_read_b64_tr_b16 v[138:139], v27 offset:16512
    ds_read_b64_tr_b16 v[140:141], v27 offset:18432
    ds_read_b64_tr_b16 v[142:143], v27 offset:18560
    s_waitcnt lgkmcnt(0)
    s_add_u32 m0, s48, 16384
    s_add_u32 s30, s81, 36992
    buffer_load_dwordx4 v21, s[44:47], s30 offen lds
    s_add_u32 m0, s48, 17408
    s_add_u32 s30, s81, 46208
    buffer_load_dwordx4 v21, s[44:47], s30 offen lds
    s_add_u32 m0, s48, 18432
    s_add_u32 s30, s81, 55424
    buffer_load_dwordx4 v21, s[44:47], s30 offen lds
    s_add_u32 m0, s48, 19456
    s_add_u32 s30, s81, 64640
    buffer_load_dwordx4 v21, s[44:47], s30 offen lds
    v_min_u32 v14, 7, v12
    v_lshlrev_b32 v14, 5, v14
    v_cmp_eq_u32 vcc, 8, v12
    s_nop 1
    v_cndmask_b32 v14, v14, 8, vcc
    v_lshlrev_b32 v16, 6, v12
    buffer_load_dword v13, v14, s[8:11], 0 offen sc1
    s_waitcnt vmcnt(29)
    ds_read_b64_tr_b16 v[144:145], v26 offset:20480
    ds_read_b64_tr_b16 v[146:147], v26 offset:20608
    ds_read_b64_tr_b16 v[148:149], v26 offset:22528
    ds_read_b64_tr_b16 v[150:151], v26 offset:22656
    ds_read_b64_tr_b16 v[152:153], v26 offset:20512
    ds_read_b64_tr_b16 v[154:155], v26 offset:20640
    ds_read_b64_tr_b16 v[156:157], v26 offset:22560
    ds_read_b64_tr_b16 v[158:159], v26 offset:22688
    s_waitcnt lgkmcnt(0)
    s_add_u32 m0, s48, 20480
    s_add_u32 s30, s86, 110720
    buffer_load_dwordx4 v21, s[44:47], s30 offen lds
    s_add_u32 m0, s48, 21504
    s_add_u32 s30, s86, 119936
    buffer_load_dwordx4 v21, s[44:47], s30 offen lds
    s_add_u32 m0, s48, 22528
    s_add_u32 s30, s86, 129152
    buffer_load_dwordx4 v21, s[44:47], s30 offen lds
    s_add_u32 m0, s48, 23552
    s_add_u32 s30, s86, 138368
    buffer_load_dwordx4 v21, s[44:47], s30 offen lds
    s_waitcnt vmcnt(29)
    ds_read_b64_tr_b16 v[160:161], v26 offset:24576
    ds_read_b64_tr_b16 v[162:163], v26 offset:24704
    ds_read_b64_tr_b16 v[164:165], v26 offset:26624
    ds_read_b64_tr_b16 v[166:167], v26 offset:26752
    ds_read_b64_tr_b16 v[168:169], v26 offset:24608
    ds_read_b64_tr_b16 v[170:171], v26 offset:24736
    ds_read_b64_tr_b16 v[172:173], v26 offset:26656
    ds_read_b64_tr_b16 v[174:175], v26 offset:26784
    s_waitcnt lgkmcnt(0)
    s_add_u32 m0, s48, 24576
    s_add_u32 s30, s57, 1024
    buffer_load_dwordx4 v22, s[44:47], s30 offen lds
    s_add_u32 m0, s48, 25600
    s_add_u32 s30, s57, 19456
    buffer_load_dwordx4 v22, s[44:47], s30 offen lds
    s_add_u32 m0, s48, 26624
    s_add_u32 s30, s57, 37888
    buffer_load_dwordx4 v22, s[44:47], s30 offen lds
    s_add_u32 m0, s48, 27648
    s_add_u32 s30, s57, 56320
    buffer_load_dwordx4 v22, s[44:47], s30 offen lds
    s_waitcnt vmcnt(29)
    ds_read_b64_tr_b16 v[176:177], v26 offset:28672
    ds_read_b64_tr_b16 v[178:179], v26 offset:28800
    ds_read_b64_tr_b16 v[180:181], v26 offset:30720
    ds_read_b64_tr_b16 v[182:183], v26 offset:30848
    ds_read_b64_tr_b16 v[184:185], v26 offset:28704
    ds_read_b64_tr_b16 v[186:187], v26 offset:28832
    ds_read_b64_tr_b16 v[188:189], v26 offset:30752
    ds_read_b64_tr_b16 v[190:191], v26 offset:30880
    s_waitcnt lgkmcnt(0)
    s_add_u32 m0, s48, 28672
    s_add_u32 s30, s80, 1572864
    buffer_load_dwordx4 v20, s[32:35], s30 offen lds
    s_add_u32 m0, s48, 29696
    s_add_u32 s30, s80, 1703936
    buffer_load_dwordx4 v20, s[32:35], s30 offen lds
    s_add_u32 m0, s48, 30720
    s_add_u32 s30, s80, 1835008
    buffer_load_dwordx4 v20, s[32:35], s30 offen lds
    s_add_u32 m0, s48, 31744
    s_add_u32 s30, s80, 1966080
    buffer_load_dwordx4 v20, s[32:35], s30 offen lds
    s_waitcnt vmcnt(29)
    ds_read_b64_tr_b16 v[192:193], v26 offset:0
    ds_read_b64_tr_b16 v[194:195], v26 offset:128
    ds_read_b64_tr_b16 v[196:197], v26 offset:2048
    ds_read_b64_tr_b16 v[198:199], v26 offset:2176
    ds_read_b64_tr_b16 v[200:201], v26 offset:32
    ds_read_b64_tr_b16 v[202:203], v26 offset:160
    ds_read_b64_tr_b16 v[204:205], v26 offset:2080
    ds_read_b64_tr_b16 v[206:207], v26 offset:2208
    s_waitcnt lgkmcnt(0)
    s_add_u32 m0, s48, 0
    s_add_u32 s30, s80, 2621440
    buffer_load_dwordx4 v20, s[36:39], s30 offen lds
    s_add_u32 m0, s48, 1024
    s_add_u32 s30, s80, 2752512
    buffer_load_dwordx4 v20, s[36:39], s30 offen lds
    s_add_u32 m0, s48, 2048
    s_add_u32 s30, s80, 2883584
    buffer_load_dwordx4 v20, s[36:39], s30 offen lds
    s_add_u32 m0, s48, 3072
    s_add_u32 s30, s80, 3014656
    buffer_load_dwordx4 v20, s[36:39], s30 offen lds
    s_waitcnt vmcnt(29)
    ds_read_b64_tr_b16 v[208:209], v26 offset:4096
    ds_read_b64_tr_b16 v[210:211], v26 offset:4224
    ds_read_b64_tr_b16 v[212:213], v26 offset:6144
    ds_read_b64_tr_b16 v[214:215], v26 offset:6272
    ds_read_b64_tr_b16 v[216:217], v26 offset:4128
    ds_read_b64_tr_b16 v[218:219], v26 offset:4256
    ds_read_b64_tr_b16 v[220:221], v26 offset:6176
    ds_read_b64_tr_b16 v[222:223], v26 offset:6304
    s_waitcnt lgkmcnt(0)
    s_add_u32 m0, s48, 4096
    s_add_u32 s30, s80, 4194304
    buffer_load_dwordx4 v20, s[36:39], s30 offen lds
    s_add_u32 m0, s48, 5120
    s_add_u32 s30, s80, 4325376
    buffer_load_dwordx4 v20, s[36:39], s30 offen lds
    s_add_u32 m0, s48, 6144
    s_add_u32 s30, s80, 4456448
    buffer_load_dwordx4 v20, s[36:39], s30 offen lds
    s_add_u32 m0, s48, 7168
    s_add_u32 s30, s80, 4587520
    buffer_load_dwordx4 v20, s[36:39], s30 offen lds
    s_waitcnt vmcnt(29)
    ds_read_b64_tr_b16 v[224:225], v26 offset:8192
    ds_read_b64_tr_b16 v[226:227], v26 offset:8320
    ds_read_b64_tr_b16 v[228:229], v26 offset:10240
    ds_read_b64_tr_b16 v[230:231], v26 offset:10368
    ds_read_b64_tr_b16 v[232:233], v26 offset:8224
    ds_read_b64_tr_b16 v[234:235], v26 offset:8352
    ds_read_b64_tr_b16 v[236:237], v26 offset:10272
    ds_read_b64_tr_b16 v[238:239], v26 offset:10400
    s_waitcnt lgkmcnt(0)
    s_add_u32 m0, s48, 8192
    s_add_u32 s30, s80, 2097152
    buffer_load_dwordx4 v20, s[40:43], s30 offen lds
    s_add_u32 m0, s48, 9216
    s_add_u32 s30, s80, 2228224
    buffer_load_dwordx4 v20, s[40:43], s30 offen lds
    s_add_u32 m0, s48, 10240
    s_add_u32 s30, s80, 2359296
    buffer_load_dwordx4 v20, s[40:43], s30 offen lds
    s_add_u32 m0, s48, 11264
    s_add_u32 s30, s80, 2490368
    buffer_load_dwordx4 v20, s[40:43], s30 offen lds
    s_waitcnt vmcnt(29)
    ds_read_b64_tr_b16 v[240:241], v26 offset:12288
    ds_read_b64_tr_b16 v[242:243], v26 offset:12416
    ds_read_b64_tr_b16 v[244:245], v26 offset:14336
    ds_read_b64_tr_b16 v[246:247], v26 offset:14464
    ds_read_b64_tr_b16 v[248:249], v26 offset:12320
    ds_read_b64_tr_b16 v[250:251], v26 offset:12448
    ds_read_b64_tr_b16 v[252:253], v26 offset:14368
    ds_read_b64_tr_b16 v[254:255], v26 offset:14496
    s_waitcnt lgkmcnt(0)
    s_add_u32 m0, s48, 12288
    s_add_u32 s30, s80, 3145728
    buffer_load_dwordx4 v20, s[40:43], s30 offen lds
    s_add_u32 m0, s48, 13312
    s_add_u32 s30, s80, 3276800
    buffer_load_dwordx4 v20, s[40:43], s30 offen lds
    s_add_u32 m0, s48, 14336
    s_add_u32 s30, s80, 3407872
    buffer_load_dwordx4 v20, s[40:43], s30 offen lds
    s_add_u32 m0, s48, 15360
    s_add_u32 s30, s80, 3538944
    buffer_load_dwordx4 v20, s[40:43], s30 offen lds
    s_waitcnt vmcnt(29)
    ds_read_b64_tr_b16 v[32:33], v24 offset:16384
    ds_read_b64_tr_b16 v[34:35], v24 offset:16512
    ds_read_b64_tr_b16 v[36:37], v24 offset:17408
    ds_read_b64_tr_b16 v[38:39], v24 offset:17536
    ds_read_b64_tr_b16 v[40:41], v24 offset:16448
    ds_read_b64_tr_b16 v[42:43], v24 offset:16576
    ds_read_b64_tr_b16 v[44:45], v24 offset:17472
    ds_read_b64_tr_b16 v[46:47], v24 offset:17600
    s_waitcnt lgkmcnt(0)
    ds_write_b128 v1, v[32:35] offset:16384
    ds_write_b128 v1, v[36:39] offset:17408
    ds_write_b128 v1, v[40:43] offset:18432
    ds_write_b128 v1, v[44:47] offset:19456
    s_waitcnt lgkmcnt(0)
    s_waitcnt vmcnt(28)
    s_mov_b32 s30, 117785600
    buffer_load_dword v15, v16, s[4:7], s30 offen sc1
    s_waitcnt vmcnt(25)
    ds_read_b64_tr_b16 v[32:33], v24 offset:20480
    ds_read_b64_tr_b16 v[34:35], v24 offset:20608
    ds_read_b64_tr_b16 v[36:37], v24 offset:21504
    ds_read_b64_tr_b16 v[38:39], v24 offset:21632
    ds_read_b64_tr_b16 v[40:41], v24 offset:20544
    ds_read_b64_tr_b16 v[42:43], v24 offset:20672
    ds_read_b64_tr_b16 v[44:45], v24 offset:21568
    ds_read_b64_tr_b16 v[46:47], v24 offset:21696
    s_waitcnt lgkmcnt(0)
    ds_write_b128 v1, v[32:35] offset:20480
    ds_write_b128 v1, v[36:39] offset:21504
    ds_write_b128 v1, v[40:43] offset:22528
    ds_write_b128 v1, v[44:47] offset:23552
    s_waitcnt lgkmcnt(0)
    s_waitcnt vmcnt(21)
    ds_read_b64_tr_b16 v[32:33], v25 offset:24576
    ds_read_b64_tr_b16 v[34:35], v25 offset:24640
    ds_read_b64_tr_b16 v[36:37], v25 offset:25088
    ds_read_b64_tr_b16 v[38:39], v25 offset:25152
    ds_read_b64_tr_b16 v[40:41], v25 offset:26624
    ds_read_b64_tr_b16 v[42:43], v25 offset:26688
    ds_read_b64_tr_b16 v[44:45], v25 offset:27136
    ds_read_b64_tr_b16 v[46:47], v25 offset:27200
    s_waitcnt lgkmcnt(0)
    ds_write_b128 v1, v[32:35] offset:24576
    ds_write_b128 v1, v[36:39] offset:25600
    ds_write_b128 v1, v[40:43] offset:26624
    ds_write_b128 v1, v[44:47] offset:27648
    s_waitcnt lgkmcnt(0)
    s_waitcnt vmcnt(17)
    ds_read_b64_tr_b16 v[32:33], v23 offset:28672
    ds_read_b64_tr_b16 v[34:35], v23 offset:28800
    ds_read_b64_tr_b16 v[36:37], v23 offset:30720
    ds_read_b64_tr_b16 v[38:39], v23 offset:30848
    ds_read_b64_tr_b16 v[40:41], v27 offset:28672
    ds_read_b64_tr_b16 v[42:43], v27 offset:28800
    ds_read_b64_tr_b16 v[44:45], v27 offset:30720
    ds_read_b64_tr_b16 v[46:47], v27 offset:30848
    s_waitcnt lgkmcnt(0)
    ds_write_b128 v1, v[32:35] offset:28672
    ds_write_b128 v1, v[36:39] offset:29696
    ds_write_b128 v1, v[40:43] offset:30720
    ds_write_b128 v1, v[44:47] offset:31744
    s_waitcnt lgkmcnt(0)
    s_waitcnt vmcnt(13)
    ds_read_b64_tr_b16 v[32:33], v23 offset:0
    ds_read_b64_tr_b16 v[34:35], v23 offset:128
    ds_read_b64_tr_b16 v[36:37], v23 offset:2048
    ds_read_b64_tr_b16 v[38:39], v23 offset:2176
    ds_read_b64_tr_b16 v[40:41], v27 offset:0
    ds_read_b64_tr_b16 v[42:43], v27 offset:128
    ds_read_b64_tr_b16 v[44:45], v27 offset:2048
    ds_read_b64_tr_b16 v[46:47], v27 offset:2176
    s_waitcnt lgkmcnt(0)
    ds_write_b128 v1, v[32:35] offset:0
    ds_write_b128 v1, v[36:39] offset:1024
    ds_write_b128 v1, v[40:43] offset:2048
    ds_write_b128 v1, v[44:47] offset:3072
    s_waitcnt lgkmcnt(0)
    s_waitcnt vmcnt(0)
    s_mov_b32 s82, 0
    v_readlane_b32 s30, v13, 8
    s_nop 0
    s_cmp_ge_u32 s30, 32
    s_cbranch_scc0 Lek_2
    v_cmp_ne_u32 vcc, 1, v15
    s_cbranch_vccnz Lek_2
    v_and_b32 v63, 0x1f0, v2
    v_lshlrev_b32 v63, 3, v63
    s_mov_b32 m0, 161344
    s_nop 0
    buffer_load_dword v63, s[4:7], s64 offen sc1 lds
    s_add_u32 s64, s64, 262144
    v_and_b32 v63, 0x1f0, v2
    v_lshlrev_b32 v63, 3, v63
    s_mov_b32 m0, 161344
    s_nop 0
    buffer_load_dword v63, s[4:7], s64 offen sc1 lds
    s_add_u32 s64, s64, 262144
    s_mov_b32 m0, s65
    s_nop 0
    buffer_load_dwordx4 v2, s[4:7], s49 offen offset:0 sc1 lds
    buffer_load_dwordx4 v2, s[4:7], s49 offen offset:1024 sc1 lds
    s_add_u32 s49, s49, 262144
    s_mov_b32 s82, 1
Lek_2:
    ds_read_b64_tr_b16 v[32:33], v23 offset:4096
    ds_read_b64_tr_b16 v[34:35], v23 offset:4224
    ds_read_b64_tr_b16 v[36:37], v23 offset:6144
    ds_read_b64_tr_b16 v[38:39], v23 offset:6272
    ds_read_b64_tr_b16 v[40:41], v27 offset:4096
    ds_read_b64_tr_b16 v[42:43], v27 offset:4224
    ds_read_b64_tr_b16 v[44:45], v27 offset:6144
    ds_read_b64_tr_b16 v[46:47], v27 offset:6272
    s_waitcnt lgkmcnt(0)
    ds_write_b128 v1, v[32:35] offset:4096
    ds_write_b128 v1, v[36:39] offset:5120
    ds_write_b128 v1, v[40:43] offset:6144
    ds_write_b128 v1, v[44:47] offset:7168
    s_waitcnt lgkmcnt(0)
    ds_read_b64_tr_b16 v[32:33], v26 offset:8192
    ds_read_b64_tr_b16 v[34:35], v26 offset:8320
    ds_read_b64_tr_b16 v[36:37], v26 offset:10240
    ds_read_b64_tr_b16 v[38:39], v26 offset:10368
    ds_read_b64_tr_b16 v[40:41], v26 offset:8224
    ds_read_b64_tr_b16 v[42:43], v26 offset:8352
    ds_read_b64_tr_b16 v[44:45], v26 offset:10272
    ds_read_b64_tr_b16 v[46:47], v26 offset:10400
    s_waitcnt lgkmcnt(0)
    ds_write_b128 v1, v[32:35] offset:8192
    ds_write_b128 v1, v[36:39] offset:9216
    ds_write_b128 v1, v[40:43] offset:10240
    ds_write_b128 v1, v[44:47] offset:11264
    s_waitcnt lgkmcnt(0)
    ds_read_b64_tr_b16 v[32:33], v26 offset:12288
    ds_read_b64_tr_b16 v[34:35], v26 offset:12416
    ds_read_b64_tr_b16 v[36:37], v26 offset:14336
    ds_read_b64_tr_b16 v[38:39], v26 offset:14464
    ds_read_b64_tr_b16 v[40:41], v26 offset:12320
    ds_read_b64_tr_b16 v[42:43], v26 offset:12448
    ds_read_b64_tr_b16 v[44:45], v26 offset:14368
    ds_read_b64_tr_b16 v[46:47], v26 offset:14496
    s_waitcnt lgkmcnt(0)
    ds_write_b128 v1, v[32:35] offset:12288
    ds_write_b128 v1, v[36:39] offset:13312
    ds_write_b128 v1, v[40:43] offset:14336
    ds_write_b128 v1, v[44:47] offset:15360
    s_waitcnt lgkmcnt(0)
    v_mov_b32 v20, 0
    v_mov_b32 v21, 0
    v_mov_b32 v22, 0
    v_mov_b32 v23, 0
    v_mov_b32 v28, 0
    v_mov_b32 v29, 0
    v_mov_b32 v30, 0
    v_mov_b32 v31, 0
    v_mov_b32 v60, 0
    v_mov_b32 v61, 0
    v_and_b32 v62, 0x1f0, v2
    v_lshlrev_b32 v62, 3, v62
    v_add_u32 v44, s71, v2
    v_mov_b32 v52, 0
    v_mov_b32 v53, 0
    v_mov_b32 v54, 0
    v_mov_b32 v55, 0
    v_mov_b32 v56, 0
    v_mov_b32 v57, 0
    v_mov_b32 v58, 0
    v_mov_b32 v59, 0
    ds_read_b128 v[44:47], v44
    v_lshrrev_b32 v50, 1, v2
    v_and_b32 v51, 0x100, v50
    v_lshrrev_b32 v51, 2, v51
    v_add3_u32 v51, v51, v50, s84
    ds_read_b64 v[48:49], v51
    v_mov_b32 v51, s14
    v_min_u32 v18, s87, v2
    v_lshlrev_b32 v18, 3, v18
    s_mov_b32 s14, 0
    s_mov_b32 s68, 0
    s_mov_b32 s85, 0
    s_mov_b32 s69, 0
    s_mov_b32 s70, 0xf0000000
    s_mov_b32 s83, 0xf0000000
    s_mov_b32 s60, 0
    s_cmp_eq_u32 s13, 3
    s_cselect_b32 s62, s15, s70
    s_mov_b32 s29, 0
    s_branch Lfp_3_t
Lfp_3:
    s_add_u32 s29, s29, 1
    s_cmp_gt_u32 s29, 0x40000
    s_cbranch_scc1 L_chain_fail
    s_sleep 6
    buffer_load_dword v13, v14, s[8:11], 0 offen sc1
    s_waitcnt vmcnt(0)
    s_mov_b32 s30, 117785600
    buffer_load_dword v15, v16, s[4:7], s30 offen sc1
    s_waitcnt vmcnt(0)
Lfp_3_t:
    s_cmp_eq_u32 s82, 1
    s_cbranch_scc1 Lfp_3_k
    v_readlane_b32 s30, v13, 8
    s_nop 0
    s_cmp_ge_u32 s30, 32
    s_cbranch_scc0 Lfp_3
    v_cmp_ne_u32 vcc, 1, v15
    s_cbranch_vccnz Lfp_3
    v_and_b32 v63, 0x1f0, v2
    v_lshlrev_b32 v63, 3, v63
    s_mov_b32 m0, 161344
    s_nop 0
    buffer_load_dword v63, s[4:7], s64 offen sc1 lds
    s_add_u32 s64, s64, 262144
    v_and_b32 v63, 0x1f0, v2
    v_lshlrev_b32 v63, 3, v63
    s_mov_b32 m0, 161344
    s_nop 0
    buffer_load_dword v63, s[4:7], s64 offen sc1 lds
    s_add_u32 s64, s64, 262144
    s_mov_b32 m0, s65
    s_nop 0
    buffer_load_dwordx4 v2, s[4:7], s49 offen offset:0 sc1 lds
    buffer_load_dwordx4 v2, s[4:7], s49 offen offset:1024 sc1 lds
    s_add_u32 s49, s49, 262144
    s_mov_b32 s82, 1
Lfp_3_k:
    s_mov_b32 s58, 0
    buffer_load_dwordx4 v[36:39], v10, s[4:7], s16 offen sc1
    buffer_load_dwordx4 v[36:39], v10, s[4:7], s17 offen sc1
    buffer_load_dwordx4 v[36:39], v10, s[4:7], s18 offen sc1
    buffer_load_dwordx4 v[36:39], v10, s[4:7], s19 offen sc1
    buffer_load_dword v36, v18, s[4:7], s67 offen sc1
    v_readlane_b32 s30, v13, 7
    s_nop 0
    s_add_u32 s58, s58, s30
    v_readlane_b32 s30, v13, 6
    s_nop 0
    s_add_u32 s58, s58, s30
    v_readlane_b32 s30, v13, 5
    s_nop 0
    s_add_u32 s58, s58, s30
    v_readlane_b32 s30, v13, 4
    s_nop 0
    s_add_u32 s58, s58, s30
    v_readlane_b32 s30, v13, 3
    s_nop 0
    s_add_u32 s58, s58, s30
    v_readlane_b32 s30, v13, 2
    s_nop 0
    s_add_u32 s58, s58, s30
    v_readlane_b32 s30, v13, 1
    s_nop 0
    s_add_u32 s58, s58, s30
    v_readlane_b32 s30, v13, 0
    s_nop 0
    s_add_u32 s58, s58, s30
    s_cmp_ge_u32 s30, 32
    s_cbranch_scc1 Lfp_3_f
    s_cmp_lt_u32 s58, 256
    s_cbranch_scc1 Lfp_3
    s_waitcnt vmcnt(0) lgkmcnt(0)
    s_branch L_stepsc1
Lfp_3_f:
    s_waitcnt vmcnt(0) lgkmcnt(0)
L_step:
L_b10:
    s_barrier
    ds_read_b128 v[12:15], v2 offset:0
    s_mov_b32 m0, s66
    ds_read_b128 v[16:19], v2 offset:1024
    ds_read_b128 v[32:35], v11 offset:1024
    s_waitcnt lgkmcnt(2)
    v_smfmac_f32_16x16x64_bf16 v[56:59], v[12:15], v[152:159], v0
    v_smfmac_f32_16x16x64_bf16 v[28:31], v[12:15], a[224:231], v0
    s_waitcnt lgkmcnt(1)
    v_smfmac_f32_16x16x64_bf16 v[52:55], v[16:19], v[160:167], v0
    ds_read_b128 v[24:27], v11 offset:0
    v_smfmac_f32_16x16x64_bf16 v[52:55], v[12:15], v[144:151], v0
    ds_read_b128 v[40:43], v1 offset:9216
    v_smfmac_f32_16x16x64_bf16 v[20:23], v[12:15], a[96:103], v0
    ds_read_b128 v[36:39], v1 offset:8192
    v_bitop3_b32 v60, v60, v12, v14 bitop3:0xfe
    v_smfmac_f32_16x16x64_bf16 v[56:59], v[16:19], v[168:175], v0
    ds_read_b128 v[12:15], v2 offset:2048
    s_waitcnt lgkmcnt(3)
    v_smfmac_f32_16x16x64_bf16 v[28:31], v[24:27], a[232:239], v0
    buffer_load_dwordx4 v2, s[4:7], s50 offen sc1 lds
    v_smfmac_f32_16x16x64_bf16 v[20:23], v[24:27], a[104:111], v0
    ds_read_b128 v[24:27], v11 offset:2048
    v_smfmac_f32_16x16x64_bf16 v[20:23], v[16:19], a[112:119], v0
    buffer_load_dwordx4 v2, s[4:7], s50 offen offset:1024 sc1 lds
    v_smfmac_f32_16x16x64_bf16 v[28:31], v[32:35], a[248:255], v0
    s_waitcnt lgkmcnt(1)
    v_bitop3_b32 v60, v60, v16, v18 bitop3:0xfe
    v_smfmac_f32_16x16x64_bf16 v[52:55], v[12:15], v[36:43], v0
    buffer_store_dwordx4 v[44:47], v2, s[4:7], s70 offen sc1
    ds_read_b128 v[40:43], v1 offset:13312
    ds_read_b128 v[36:39], v1 offset:12288
    v_bitop3_b32 v60, v60, v12, v14 bitop3:0xfe
    v_smfmac_f32_16x16x64_bf16 v[28:31], v[16:19], a[240:247], v0
    ds_read_b128 v[16:19], v2 offset:3072
    v_smfmac_f32_16x16x64_bf16 v[20:23], v[12:15], a[128:135], v0
    ds_read_b128 v[44:47], v1 offset:10240
    buffer_store_dwordx2 v[48:49], v50, s[4:7], s83 offen sc1
    ds_read_b128 v[48:51], v1 offset:11264
    v_smfmac_f32_16x16x64_bf16 v[28:31], v[12:15], v[64:71], v0
    v_smfmac_f32_16x16x64_bf16 v[20:23], v[32:35], a[120:127], v0
    ds_read_b128 v[32:35], v11 offset:3072
    s_waitcnt lgkmcnt(6)
    v_smfmac_f32_16x16x64_bf16 v[28:31], v[24:27], v[72:79], v0
    s_waitcnt lgkmcnt(1)
    v_smfmac_f32_16x16x64_bf16 v[56:59], v[12:15], v[44:51], v0
    ds_read_b128 v[48:51], v1 offset:15360
    ds_read_b128 v[44:47], v1 offset:14336
    v_smfmac_f32_16x16x64_bf16 v[20:23], v[24:27], a[136:143], v0
    v_smfmac_f32_16x16x64_bf16 v[52:55], v[16:19], v[36:43], v0
    s_waitcnt lgkmcnt(0)
    v_smfmac_f32_16x16x64_bf16 v[56:59], v[16:19], v[44:51], v0
    s_waitcnt vmcnt(4)
    ds_read_b128 v[44:47], v1 offset:30720
    v_and_b32 v63, 1, v61
    v_cmp_ne_u32 vcc, 0, v63
    v_smfmac_f32_16x16x64_bf16 v[20:23], v[16:19], a[144:151], v0
    ds_read_b128 v[36:39], v1 offset:28672
    ds_read_b128 v[40:43], v1 offset:29696
    v_smfmac_f32_16x16x64_bf16 v[28:31], v[16:19], v[80:87], v0
    s_cbranch_vccnz L_rb0
L_rbk0:
    s_barrier
    ds_read_b128 v[12:15], v2 offset:4096
    ds_read_b128 v[48:51], v1 offset:31744
    v_smfmac_f32_16x16x64_bf16 v[20:23], v[32:35], a[152:159], v0
    ds_read_b128 v[24:27], v11 offset:4096
    v_bitop3_b32 v60, v60, v16, v18 bitop3:0xfe
    v_smfmac_f32_16x16x64_bf16 v[28:31], v[32:35], v[88:95], v0
    ds_read_b128 v[32:35], v11 offset:5120
    s_waitcnt lgkmcnt(3)
    v_smfmac_f32_16x16x64_bf16 v[20:23], v[12:15], a[160:167], v0
    ds_read_b128 v[16:19], v2 offset:5120
    v_smfmac_f32_16x16x64_bf16 v[28:31], v[12:15], v[96:103], v0
    s_mov_b32 m0, 161344
    ds_read_b128 v[12:15], v2 offset:6144
    s_waitcnt lgkmcnt(3)
    v_smfmac_f32_16x16x64_bf16 v[28:31], v[24:27], v[104:111], v0
    v_smfmac_f32_16x16x64_bf16 v[20:23], v[24:27], a[168:175], v0
    ds_read_b128 v[24:27], v11 offset:6144
    s_waitcnt lgkmcnt(2)
    v_smfmac_f32_16x16x64_bf16 v[20:23], v[16:19], v[36:43], v0
    ds_read_b128 v[40:43], v1 offset:1024
    v_smfmac_f32_16x16x64_bf16 v[28:31], v[16:19], v[112:119], v0
    ds_read_b128 v[36:39], v1 offset:0
    v_smfmac_f32_16x16x64_bf16 v[20:23], v[32:35], v[44:51], v0
    ds_read_b128 v[44:47], v1 offset:2048
    v_smfmac_f32_16x16x64_bf16 v[28:31], v[32:35], v[120:127], v0
    s_waitcnt lgkmcnt(4)
    ds_read_b128 v[48:51], v1 offset:3072
    ds_read_b128 v[16:19], v2 offset:7168
    v_bitop3_b32 v60, v60, v12, v14 bitop3:0xfe
    v_smfmac_f32_16x16x64_bf16 v[20:23], v[12:15], a[176:183], v0
    ds_read_b128 v[32:35], v11 offset:7168
    s_waitcnt lgkmcnt(4)
    v_smfmac_f32_16x16x64_bf16 v[28:31], v[12:15], v[36:43], v0
    ds_read_b128 v[36:39], v1 offset:4096
    buffer_load_dword v62, s[4:7], s64 offen sc1 lds
    v_smfmac_f32_16x16x64_bf16 v[20:23], v[24:27], a[184:191], v0
    ds_read_b128 v[40:43], v1 offset:5120
    s_waitcnt lgkmcnt(4)
    v_smfmac_f32_16x16x64_bf16 v[28:31], v[24:27], v[44:51], v0
    s_waitcnt lgkmcnt(3)
    v_smfmac_f32_16x16x64_bf16 v[20:23], v[16:19], a[192:199], v0
    ds_read_b128 v[12:15], v2 offset:8192
    ds_read_b128 v[44:47], v1 offset:6144
    v_smfmac_f32_16x16x64_bf16 v[28:31], v[16:19], v[128:135], v0
    s_waitcnt lgkmcnt(4)
    v_bitop3_b32 v60, v60, v16, v18 bitop3:0xfe
    v_smfmac_f32_16x16x64_bf16 v[20:23], v[32:35], a[200:207], v0
    ds_read_b128 v[24:27], v11 offset:8192
    ds_read_b128 v[16:19], v2 offset:4096
    v_smfmac_f32_16x16x64_bf16 v[28:31], v[32:35], v[136:143], v0
    s_waitcnt lgkmcnt(3)
    v_smfmac_f32_16x16x64_bf16 v[28:31], v[12:15], v[36:43], v0
    ds_read_b128 v[48:51], v1 offset:7168
    v_bitop3_b32 v60, v60, v12, v14 bitop3:0xfe
    v_smfmac_f32_16x16x64_bf16 v[20:23], v[12:15], a[208:215], v0
    ds_read_b128 v[12:15], v2 offset:5120
    s_waitcnt lgkmcnt(3)
    v_smfmac_f32_16x16x64_bf16 v[20:23], v[24:27], a[216:223], v0
    s_waitcnt lgkmcnt(2)
    v_smfmac_f32_16x16x64_bf16 v[52:55], v[16:19], v[176:183], v0
    ds_read_b128 v[36:39], v2 offset:9216
    v_bitop3_b32 v60, v60, v16, v18 bitop3:0xfe
    v_smfmac_f32_16x16x64_bf16 v[56:59], v[16:19], v[184:191], v0
    ds_read_b128 v[40:43], v2 offset:10240
    s_waitcnt lgkmcnt(2)
    v_mul_f32 v20, s28, v20
    v_bitop3_b32 v60, v60, v12, v14 bitop3:0xfe
    v_smfmac_f32_16x16x64_bf16 v[28:31], v[24:27], v[44:51], v0
    ds_read_b128 v[44:47], v2 offset:11264
    v_mul_f32 v21, s28, v21
    v_smfmac_f32_16x16x64_bf16 v[52:55], v[12:15], v[192:199], v0
    ds_read_b128 v[16:19], v2 offset:6144
    v_mul_f32 v23, s28, v23
    v_mul_f32 v22, s28, v22
    v_cvt_pk_bf16_f32 v20, v20, v21
    v_cvt_pk_bf16_f32 v21, v22, v23
    v_smfmac_f32_16x16x64_bf16 v[56:59], v[12:15], v[200:207], v0
    ds_read_b128 v[12:15], v2 offset:7168
    ds_write2_b32 v4, v20, v21 offset0:0 offset1:80
    v_cvt_pk_bf16_f32 v28, v28, v29
    v_cvt_pk_bf16_f32 v29, v30, v31
    s_waitcnt lgkmcnt(2)
    v_smfmac_f32_16x16x64_bf16 v[56:59], v[16:19], v[216:223], v0
    ds_write2_b32 v4, v28, v29 offset0:144 offset1:224
    v_and_b32 v60, 1, v60
    v_smfmac_f32_16x16x64_bf16 v[52:55], v[16:19], v[208:215], v0
    ds_read_b128 v[16:19], v2 offset:8192
    s_waitcnt lgkmcnt(3)
    v_cmp_ne_u32 vcc, 0, v60
    v_smfmac_f32_16x16x64_bf16 v[52:55], v[12:15], v[224:231], v0
    v_smfmac_f32_16x16x64_bf16 v[56:59], v[12:15], v[232:239], v0
    s_cbranch_vccz L_ok0
    s_cmp_eq_u32 s14, 0
    s_cbranch_scc1 L_ok0
    s_branch L_redo0
L_ok0:
    s_waitcnt lgkmcnt(0)
    s_barrier
    ds_read_b64_tr_b16 v[20:21], v5 offset:21504
    ds_read_b64_tr_b16 v[22:23], v5 offset:21520
    v_smfmac_f32_16x16x64_bf16 v[52:55], v[16:19], v[240:247], v0
    ds_read_b64_tr_b16 v[24:25], v5 offset:22664
    s_add_u32 s50, s50, 262144
    ds_read_b128 v[48:51], v2 offset:12288
    v_smfmac_f32_16x16x64_bf16 v[56:59], v[16:19], v[248:255], v0
    ds_read_b64_tr_b16 v[26:27], v5 offset:22680
    ds_read_b64_tr_b16 v[32:33], v5 offset:23824
    ds_read_b64_tr_b16 v[28:29], v5 offset:24984
    s_waitcnt lgkmcnt(5)
    v_mfma_f32_16x16x32_bf16 v[12:15], v[36:39], v[20:23], 0
    ds_read_b64_tr_b16 v[34:35], v5 offset:23840
    ds_read_b128 v[36:39], v2 offset:13312
    v_mfma_f32_16x16x32_bf16 v[16:19], v[40:43], v[20:23], 0
    ds_read_b128 v[40:43], v2 offset:14336
    s_waitcnt lgkmcnt(5)
    v_mfma_f32_16x16x32_bf16 v[12:15], v[44:47], v[24:27], v[12:15]
    ds_read_b128 v[44:47], v2 offset:15360
    v_mfma_f32_16x16x32_bf16 v[16:19], v[48:51], v[24:27], v[16:19]
    ds_read_b64_tr_b16 v[30:31], v5 offset:25000
    ds_read_b128 v[48:51], v2 offset:16384
    s_waitcnt lgkmcnt(4)
    v_mfma_f32_16x16x32_bf16 v[12:15], v[36:39], v[32:35], v[12:15]
    s_add_u32 s64, s64, 262144
    ds_read_b64_tr_b16 v[36:37], v6 offset:0
    v_cvt_pk_bf16_f32 v52, v52, v56
    v_cvt_pk_bf16_f32 v56, v54, v58
    s_waitcnt lgkmcnt(4)
    v_mfma_f32_16x16x32_bf16 v[16:19], v[40:43], v[32:35], v[16:19]
    ds_read_b64_tr_b16 v[42:43], v6 offset:1176
    ds_read_b64_tr_b16 v[40:41], v6 offset:1160
    s_waitcnt lgkmcnt(4)
    v_cvt_pk_bf16_f32 v53, v53, v57
    v_mfma_f32_16x16x32_bf16 v[12:15], v[44:47], v[28:31], v[12:15]
    ds_read_b64_tr_b16 v[38:39], v6 offset:16
    ds_read_b64_tr_b16 v[44:45], v6 offset:2320
    s_waitcnt lgkmcnt(5)
    v_mov_b32 v54, 0
    v_mfma_f32_16x16x32_bf16 v[16:19], v[48:51], v[28:31], v[16:19]
    ds_read_b64_tr_b16 v[48:49], v6 offset:3480
    ds_read_b64_tr_b16 v[50:51], v6 offset:3496
    ds_read_b64_tr_b16 v[46:47], v6 offset:2336
    v_cvt_pk_bf16_f32 v57, v55, v59
    v_mov_b32 v59, 0
    v_mov_b32 v58, 0
    s_waitcnt lgkmcnt(4)
    v_mfma_f32_16x16x32_bf16 v[60:63], v[36:39], v[20:23], 0
    s_waitcnt vmcnt(3)
    ds_read2st64_b32 v[38:39], v8 offset0:2 offset1:3
    v_mov_b32 v55, 0
    v_mfma_f32_16x16x32_bf16 v[60:63], v[40:43], v[24:27], v[60:63]
    ds_read2st64_b32 v[40:41], v8 offset0:4 offset1:5
    s_waitcnt lgkmcnt(2)
    v_exp_f32 v20, v12
    v_mfma_f32_16x16x32_bf16 v[60:63], v[44:47], v[32:35], v[60:63]
    ds_read_b128 v[44:47], v2 offset:30720
    ds_read2st64_b32 v[42:43], v8 offset0:6 offset1:7
    v_exp_f32 v21, v13
    v_mfma_f32_16x16x32_bf16 v[60:63], v[48:51], v[28:31], v[60:63]
    ds_read_b128 v[28:31], v2 offset:31744
    ds_read2st64_b32 v[36:37], v8 offset0:0 offset1:1
    ds_read_b128 v[48:51], v2 offset:31744
    v_exp_f32 v22, v14
    v_max3_f32 v32, |v12|, |v13|, |v14|
    v_max3_f32 v32, v32, |v15|, |v16|
    v_cvt_pk_bf16_f32 v20, v20, v21
    v_max3_f32 v32, v32, |v17|, |v18|
    v_max3_f32 v33, |v61|, |v62|, |v63|
    v_exp_f32 v23, v15
    v_exp_f32 v24, v16
    v_exp_f32 v25, v17
    v_exp_f32 v27, v19
    v_max3_f32 v32, v32, |v19|, |v60|
    v_max_f32 v33, v32, v33
    v_cmp_nge_f32 vcc, 0x42800000, v33
    v_exp_f32 v26, v18
    v_cvt_pk_bf16_f32 v21, v22, v23
    v_cvt_pk_bf16_f32 v22, v24, v25
    v_cvt_pk_bf16_f32 v23, v26, v27
    s_cbranch_vccnz L_mx0
L_mxk0:
    v_exp_f32 v60, v60
    s_waitcnt lgkmcnt(1)
    v_smfmac_f32_16x16x64_bf16 v[28:31], v[20:23], v[36:43], v0
    ds_read_b128 v[32:35], v2 offset:31744
    v_exp_f32 v61, v61
    v_exp_f32 v62, v62
    v_exp_f32 v63, v63
    v_mfma_f32_16x16x32_bf16 v[16:19], v[20:23], v[44:47], 0
    s_waitcnt lgkmcnt(1)
    v_cvt_pk_bf16_f32 v50, v62, v63
    v_cvt_pk_bf16_f32 v48, v60, v61
    v_mfma_f32_16x16x32_bf16 v[16:19], v[20:23], v[44:47], v[16:19]
    ds_read_b128 v[12:15], v2 offset:31744
    ds_read_b128 v[20:23], v1 offset:24576
    v_mfma_f32_16x16x32_bf16 v[16:19], v[48:51], v[44:47], v[16:19]
    v_smfmac_f32_16x16x64_bf16 v[28:31], v[48:51], v[52:59], v0
    ds_read_b128 v[24:27], v1 offset:25600
    ds_read_b128 v[60:63], v2 offset:31744
    ds_write2st64_b32 v8, v52, v53 offset0:0 offset1:1
    v_subrev_u32 v44, 21504, v4
    s_nop 0
    v_rcp_f32 v17, v17
    v_rcp_f32 v18, v18
    v_rcp_f32 v16, v16
    v_rcp_f32 v19, v19
    v_mul_f32 v30, v30, v18
    v_mul_f32 v28, v28, v16
    v_mul_f32 v29, v29, v17
    v_cvt_pk_bf16_f32 v28, v28, v29
    v_mul_f32 v31, v31, v19
    v_cvt_pk_bf16_f32 v29, v30, v31
    ds_write2_b32 v44, v28, v29 offset0:0 offset1:80
    ds_write2st64_b32 v8, v56, v57 offset0:2 offset1:3
    v_mov_b32 v28, 0
    v_mov_b32 v31, 0
    s_mov_b32 m0, s65
    ds_read_b128 v[16:19], v2 offset:31744
    v_mov_b32 v30, 0
    ds_read_b128 v[56:59], v1 offset:27648
    v_mov_b32 v29, 0
    s_waitcnt lgkmcnt(2)
    s_barrier
    ds_read_b64_tr_b16 v[36:37], v7 offset:0
    ds_read_b64_tr_b16 v[38:39], v7 offset:16
    ds_read_b64_tr_b16 v[42:43], v7 offset:1176
    ds_read_b64_tr_b16 v[40:41], v7 offset:1160
    ds_read_b64_tr_b16 v[46:47], v3 offset:16
    ds_read_b64_tr_b16 v[48:49], v3 offset:1160
    ds_read_b64_tr_b16 v[44:45], v3 offset:0
    s_waitcnt lgkmcnt(5)
    v_smfmac_f32_16x16x64_bf16 v[12:15], v[36:39], a[0:7], v0
    ds_read_b64_tr_b16 v[50:51], v3 offset:1176
    s_waitcnt lgkmcnt(4)
    v_smfmac_f32_16x16x64_bf16 v[12:15], v[40:43], a[16:23], v0
    buffer_load_dwordx4 v2, s[4:7], s49 offen offset:0 sc1 lds
    s_waitcnt lgkmcnt(1)
    v_smfmac_f32_16x16x64_bf16 v[12:15], v[44:47], a[32:39], v0
    s_waitcnt lgkmcnt(0)
    v_smfmac_f32_16x16x64_bf16 v[12:15], v[48:51], a[48:55], v0
    v_smfmac_f32_16x16x64_bf16 v[32:35], v[36:39], a[8:15], v0
    buffer_load_dwordx4 v2, s[4:7], s49 offen offset:1024 sc1 lds
    v_smfmac_f32_16x16x64_bf16 v[32:35], v[40:43], a[24:31], v0
    s_add_u32 s49, s49, 262144
    ds_read_b128 v[52:55], v1 offset:26624
    v_cvt_pk_bf16_f32 v12, v12, v13
    v_cvt_pk_bf16_f32 v13, v14, v15
    v_or_b32 v12, 1, v12
    v_smfmac_f32_16x16x64_bf16 v[32:35], v[44:47], a[40:47], v0
    buffer_store_dwordx2 v[12:13], v9, s[4:7], s20 offen offset:0
    v_smfmac_f32_16x16x64_bf16 v[32:35], v[48:51], a[56:63], v0
    v_smfmac_f32_16x16x64_bf16 v[60:63], v[36:39], v[20:27], v0
    ds_read_b128 v[20:23], v1 offset:16384
    ds_read_b128 v[24:27], v1 offset:17408
    s_waitcnt lgkmcnt(2)
    v_smfmac_f32_16x16x64_bf16 v[60:63], v[40:43], v[52:59], v0
    ds_read_b128 v[56:59], v1 offset:21504
    ds_read_b128 v[52:55], v1 offset:20480
    v_cvt_pk_bf16_f32 v32, v32, v33
    v_or_b32 v32, 1, v32
    v_cvt_pk_bf16_f32 v33, v34, v35
    v_smfmac_f32_16x16x64_bf16 v[28:31], v[36:39], a[64:71], v0
    buffer_store_dwordx2 v[32:33], v9, s[4:7], s20 offen offset:512
    v_smfmac_f32_16x16x64_bf16 v[28:31], v[44:47], a[80:87], v0
    s_waitcnt lgkmcnt(2)
    v_cvt_pk_bf16_f32 v60, v60, v61
    v_smfmac_f32_16x16x64_bf16 v[28:31], v[40:43], v[20:27], v0
    ds_read_b128 v[20:23], v1 offset:18432
    ds_read_b128 v[24:27], v1 offset:19456
    v_or_b32 v60, 1, v60
    v_cvt_pk_bf16_f32 v61, v62, v63
    s_waitcnt lgkmcnt(2)
    v_smfmac_f32_16x16x64_bf16 v[28:31], v[48:51], v[52:59], v0
    s_mov_b32 s29, 0
    ds_read_b128 v[56:59], v1 offset:23552
    ds_read_b128 v[52:55], v1 offset:22528
    v_smfmac_f32_16x16x64_bf16 v[16:19], v[36:39], a[72:79], v0
    buffer_store_dwordx2 v[60:61], v9, s[4:7], s3 offen offset:0
    v_smfmac_f32_16x16x64_bf16 v[16:19], v[44:47], a[88:95], v0
    s_waitcnt lgkmcnt(2)
    s_nop 0
    v_cvt_pk_bf16_f32 v28, v28, v29
    v_smfmac_f32_16x16x64_bf16 v[16:19], v[40:43], v[20:27], v0
    s_mov_b32 s70, s52
    v_cvt_pk_bf16_f32 v29, v30, v31
    v_or_b32 v28, 1, v28
    s_waitcnt lgkmcnt(0)
    v_smfmac_f32_16x16x64_bf16 v[16:19], v[48:51], v[52:59], v0
    s_mov_b32 s83, s51
    buffer_store_dwordx2 v[28:29], v9, s[4:7], s20 offen offset:1024
    s_add_u32 s52, s52, 131072
    s_nop 4
    v_cvt_pk_bf16_f32 v16, v16, v17
    v_or_b32 v16, 1, v16
    v_cvt_pk_bf16_f32 v17, v18, v19
    s_add_u32 s51, s51, 65536
    buffer_store_dwordx2 v[16:17], v9, s[4:7], s20 offen offset:1536
    s_cmp_eq_u32 s13, 0
    s_cbranch_scc0 L_nw00
    s_nop 15
    buffer_load_dwordx4 v[36:39], v10, s[4:7], s16 offen offset:0 sc1
    buffer_load_dwordx4 v[40:43], v10, s[4:7], s17 offen offset:0 sc1
    buffer_load_dwordx4 v[44:47], v10, s[4:7], s18 offen offset:0 sc1
    buffer_load_dwordx4 v[48:51], v10, s[4:7], s19 offen offset:0 sc1
    v_mov_b32 v31, 0x3f80
    v_and_b32 v30, 16, v2
    v_lshlrev_b32 v30, v30, v31
    v_cndmask_b32 v20, 0, v30, s[72:73]
    v_cndmask_b32 v21, 0, v30, s[74:75]
    v_cndmask_b32 v22, 0, v30, s[76:77]
    v_cndmask_b32 v23, 0, v30, s[78:79]
    s_barrier
    s_branch L_rgo0
L_nw00:
    s_cmp_eq_u32 s23, 0
    s_cbranch_scc0 L_rd10
    s_barrier
    s_branch L_mre0
L_rd10:
    v_mov_b32 v31, 0x3f80
    v_and_b32 v30, 16, v2
    v_lshlrev_b32 v30, v30, v31
    v_cndmask_b32 v20, 0, v30, s[72:73]
    v_cndmask_b32 v21, 0, v30, s[74:75]
    v_cndmask_b32 v22, 0, v30, s[76:77]
    v_cndmask_b32 v23, 0, v30, s[78:79]
    s_barrier
    s_cmp_eq_u32 s13, 2
    s_cbranch_scc1 L_r80
    s_nop 15
    s_nop 15
    s_nop 7
    buffer_load_dwordx4 v[36:39], v10, s[4:7], s16 offen offset:0 sc1
    buffer_load_dwordx4 v[40:43], v10, s[4:7], s17 offen offset:0 sc1
    buffer_load_dwordx4 v[44:47], v10, s[4:7], s18 offen offset:0 sc1
    buffer_load_dwordx4 v[48:51], v10, s[4:7], s19 offen offset:0 sc1
L_rgo0:
    s_nop 15
    s_nop 15
    s_nop 7
    buffer_load_dwordx4 v[12:15], v10, s[4:7], s16 offen offset:0 sc1
    buffer_load_dwordx4 v[32:35], v10, s[4:7], s17 offen offset:0 sc1
    buffer_load_dwordx4 v[52:55], v10, s[4:7], s18 offen offset:0 sc1
    buffer_load_dwordx4 v[56:59], v10, s[4:7], s19 offen offset:0 sc1
L_rpoll0:
    s_waitcnt vmcnt(7)
    v_mfma_f32_16x16x32_bf16 v[24:27], v[36:39], v[20:23], 0
    v_bitop3_b32 v30, v36, v38, 1 bitop3:0x2a
    v_cmp_ne_u32 s[32:33], 0, v30
    s_waitcnt vmcnt(6)
    v_mfma_f32_16x16x32_bf16 v[24:27], v[40:43], v[20:23], v[24:27]
    v_bitop3_b32 v31, v40, v42, 1 bitop3:0x2a
    v_cmp_ne_u32 s[34:35], 0, v31
    s_waitcnt vmcnt(5)
    v_mfma_f32_16x16x32_bf16 v[24:27], v[44:47], v[20:23], v[24:27]
    v_bitop3_b32 v30, v44, v46, 1 bitop3:0x2a
    v_cmp_ne_u32 s[36:37], 0, v30
    s_waitcnt vmcnt(4)
    v_mfma_f32_16x16x32_bf16 v[24:27], v[48:51], v[20:23], v[24:27]
    v_bitop3_b32 v31, v48, v50, 1 bitop3:0x2a
    v_cmp_ne_u32 s[38:39], 0, v31
    s_or_b64 vcc, s[32:33], s[34:35]
    s_or_b64 vcc, vcc, s[36:37]
    s_or_b64 vcc, vcc, s[38:39]
    s_cbranch_scc0 L_rgot0
    s_mov_b64 exec, s[32:33]
    buffer_load_dwordx4 v[36:39], v10, s[4:7], s16 offen offset:0 sc1
    s_mov_b64 exec, s[34:35]
    buffer_load_dwordx4 v[40:43], v10, s[4:7], s17 offen offset:0 sc1
    s_mov_b64 exec, s[36:37]
    buffer_load_dwordx4 v[44:47], v10, s[4:7], s18 offen offset:0 sc1
    s_mov_b64 exec, s[38:39]
    buffer_load_dwordx4 v[48:51], v10, s[4:7], s19 offen offset:0 sc1
    s_mov_b64 exec, -1
    s_waitcnt vmcnt(7)
    v_mfma_f32_16x16x32_bf16 v[24:27], v[12:15], v[20:23], 0
    v_bitop3_b32 v30, v12, v14, 1 bitop3:0x2a
    v_cmp_ne_u32 s[40:41], 0, v30
    s_waitcnt vmcnt(6)
    v_mfma_f32_16x16x32_bf16 v[24:27], v[32:35], v[20:23], v[24:27]
    v_bitop3_b32 v31, v32, v34, 1 bitop3:0x2a
    v_cmp_ne_u32 s[42:43], 0, v31
    s_waitcnt vmcnt(5)
    v_mfma_f32_16x16x32_bf16 v[24:27], v[52:55], v[20:23], v[24:27]
    v_bitop3_b32 v30, v52, v54, 1 bitop3:0x2a
    v_cmp_ne_u32 s[44:45], 0, v30
    s_waitcnt vmcnt(4)
    v_mfma_f32_16x16x32_bf16 v[24:27], v[56:59], v[20:23], v[24:27]
    v_bitop3_b32 v31, v56, v58, 1 bitop3:0x2a
    v_cmp_ne_u32 s[46:47], 0, v31
    s_or_b64 vcc, s[40:41], s[42:43]
    s_or_b64 vcc, vcc, s[44:45]
    s_or_b64 vcc, vcc, s[46:47]
    s_cbranch_scc0 L_rgot0
    s_mov_b64 exec, s[40:41]
    buffer_load_dwordx4 v[12:15], v10, s[4:7], s16 offen offset:0 sc1
    s_mov_b64 exec, s[42:43]
    buffer_load_dwordx4 v[32:35], v10, s[4:7], s17 offen offset:0 sc1
    s_mov_b64 exec, s[44:45]
    buffer_load_dwordx4 v[52:55], v10, s[4:7], s18 offen offset:0 sc1
    s_mov_b64 exec, s[46:47]
    buffer_load_dwordx4 v[56:59], v10, s[4:7], s19 offen offset:0 sc1
    s_mov_b64 exec, -1
    s_add_u32 s29, s29, 1
    s_cmp_gt_u32 s29, 0x40000
    s_cbranch_scc0 L_rpoll0
    s_branch L_chain_fail
L_r80:
    s_nop 15
    buffer_load_dwordx4 v[36:39], v10, s[4:7], s16 offen offset:0 sc1
    buffer_load_dwordx4 v[40:43], v10, s[4:7], s17 offen offset:0 sc1
    buffer_load_dwordx4 v[44:47], v10, s[4:7], s18 offen offset:0 sc1
    buffer_load_dwordx4 v[48:51], v10, s[4:7], s19 offen offset:0 sc1
    buffer_load_dwordx4 v[12:15], v10, s[4:7], s16 offen offset:1024 sc1
    buffer_load_dwordx4 v[32:35], v10, s[4:7], s17 offen offset:1024 sc1
    buffer_load_dwordx4 v[52:55], v10, s[4:7], s18 offen offset:1024 sc1
    buffer_load_dwordx4 v[56:59], v10, s[4:7], s19 offen offset:1024 sc1
L_r8p0:
    s_waitcnt vmcnt(7)
    v_mfma_f32_16x16x32_bf16 v[24:27], v[36:39], v[20:23], 0
    s_waitcnt vmcnt(6)
    v_bitop3_b32 v30, v36, v38, 1 bitop3:0x2a
    v_mfma_f32_16x16x32_bf16 v[24:27], v[40:43], v[20:23], v[24:27]
    v_bitop3_b32 v31, v40, v42, 1 bitop3:0x2a
    v_or3_b32 v63, v30, v31, 0
    s_waitcnt vmcnt(5)
    v_mfma_f32_16x16x32_bf16 v[24:27], v[44:47], v[20:23], v[24:27]
    s_waitcnt vmcnt(4)
    v_bitop3_b32 v30, v44, v46, 1 bitop3:0x2a
    v_mfma_f32_16x16x32_bf16 v[24:27], v[48:51], v[20:23], v[24:27]
    v_bitop3_b32 v31, v48, v50, 1 bitop3:0x2a
    v_or3_b32 v63, v30, v31, v63
    s_waitcnt vmcnt(3)
    v_mfma_f32_16x16x32_bf16 v[24:27], v[12:15], v[20:23], v[24:27]
    s_waitcnt vmcnt(2)
    v_bitop3_b32 v30, v12, v14, 1 bitop3:0x2a
    v_mfma_f32_16x16x32_bf16 v[24:27], v[32:35], v[20:23], v[24:27]
    v_bitop3_b32 v31, v32, v34, 1 bitop3:0x2a
    v_or3_b32 v63, v30, v31, v63
    s_waitcnt vmcnt(1)
    v_mfma_f32_16x16x32_bf16 v[24:27], v[52:55], v[20:23], v[24:27]
    s_waitcnt vmcnt(0)
    v_bitop3_b32 v30, v52, v54, 1 bitop3:0x2a
    v_mfma_f32_16x16x32_bf16 v[24:27], v[56:59], v[20:23], v[24:27]
    v_bitop3_b32 v31, v56, v58, 1 bitop3:0x2a
    v_or3_b32 v63, v30, v31, v63
    v_cmp_ne_u32 vcc, 0, v63
    s_cbranch_vccz L_rgot0
    buffer_load_dwordx4 v[36:39], v10, s[4:7], s16 offen offset:0 sc1
    buffer_load_dwordx4 v[40:43], v10, s[4:7], s17 offen offset:0 sc1
    buffer_load_dwordx4 v[44:47], v10, s[4:7], s18 offen offset:0 sc1
    buffer_load_dwordx4 v[48:51], v10, s[4:7], s19 offen offset:0 sc1
    buffer_load_dwordx4 v[12:15], v10, s[4:7], s16 offen offset:1024 sc1
    buffer_load_dwordx4 v[32:35], v10, s[4:7], s17 offen offset:1024 sc1
    buffer_load_dwordx4 v[52:55], v10, s[4:7], s18 offen offset:1024 sc1
    buffer_load_dwordx4 v[56:59], v10, s[4:7], s19 offen offset:1024 sc1
    s_add_u32 s29, s29, 1
    s_cmp_gt_u32 s29, 0x40000
    s_cbranch_scc0 L_r8p0
    s_branch L_chain_fail
L_rb0:
    s_add_u32 s69, s69, 0x10000
    s_mov_b32 s29, 0
    s_mov_b32 s31, m0
L_rbl0:
    v_min_u32 v63, s87, v2
    v_lshlrev_b32 v63, 3, v63
    buffer_load_dword v61, v63, s[4:7], s67 offen sc1
    s_mov_b32 m0, s53
    s_add_u32 s30, s21, 4096
    buffer_load_dwordx4 v2, s[4:7], s21 offen offset:0 sc1 lds
    buffer_load_dwordx4 v2, s[4:7], s21 offen offset:1024 sc1 lds
    buffer_load_dwordx4 v2, s[4:7], s21 offen offset:2048 sc1 lds
    buffer_load_dwordx4 v2, s[4:7], s21 offen offset:3072 sc1 lds
    s_add_u32 m0, s53, 4096
    s_nop 0
    buffer_load_dwordx4 v2, s[4:7], s30 offen sc1 lds
    s_add_u32 s69, s69, 0x1000000
    s_add_u32 s29, s29, 1
    s_cmp_gt_u32 s29, 0x40000
    s_cbranch_scc1 L_chain_fail
    s_waitcnt vmcnt(0)
    v_and_b32 v63, 1, v61
    v_cmp_ne_u32 vcc, 0, v63
    s_cbranch_vccnz L_rbl0
    s_mov_b32 m0, s31
    s_branch L_rbk0
L_mx0:
    v_max3_f32 v32, v12, v13, v14
    v_max3_f32 v32, v32, v15, v16
    v_max3_f32 v32, v32, v17, v18
    v_max3_f32 v32, v32, v19, v60
    v_max3_f32 v32, v32, v61, v62
    v_max_f32 v32, v32, v63
    v_mov_b32 v33, v32
    s_nop 1
    v_permlane16_swap_b32 v32, v33
    v_max_f32 v32, v32, v33
    v_mov_b32 v33, v32
    s_nop 1
    v_permlane32_swap_b32 v32, v33
    v_max_f32 v32, v32, v33
    v_sub_f32 v12, v12, v32
    v_sub_f32 v13, v13, v32
    v_sub_f32 v14, v14, v32
    v_sub_f32 v15, v15, v32
    v_sub_f32 v16, v16, v32
    v_sub_f32 v17, v17, v32
    v_sub_f32 v18, v18, v32
    v_sub_f32 v19, v19, v32
    v_sub_f32 v60, v60, v32
    v_sub_f32 v61, v61, v32
    v_sub_f32 v62, v62, v32
    v_sub_f32 v63, v63, v32
    v_exp_f32 v20, v12
    v_exp_f32 v21, v13
    v_exp_f32 v22, v14
    v_exp_f32 v23, v15
    v_exp_f32 v24, v16
    v_exp_f32 v25, v17
    v_exp_f32 v26, v18
    v_exp_f32 v27, v19
    v_cvt_pk_bf16_f32 v20, v20, v21
    v_cvt_pk_bf16_f32 v21, v22, v23
    v_cvt_pk_bf16_f32 v22, v24, v25
    v_cvt_pk_bf16_f32 v23, v26, v27
    s_branch L_mxk0
L_redo1:
    s_waitcnt vmcnt(0) lgkmcnt(0)
    s_barrier
    s_add_u32 s85, s85, 1
    s_cmp_gt_u32 s85, 0x4000
    s_cbranch_scc1 L_chain_fail
    s_sub_u32 s14, s14, 1
    s_sub_u32 s56, s56, 9216
    s_mov_b32 s29, 0
    s_mov_b32 s70, 0xf0000000
    s_mov_b32 s83, 0xf0000000
    s_branch L_mre0
L_rgot0:
    v_permlane32_swap_b32 v24, v26
    v_permlane32_swap_b32 v25, v27
    v_add_f32 v24, v24, v26
    v_add_f32 v25, v25, v27
    v_cvt_pk_bf16_f32 v24, v24, v25
    v_mov_b32 v25, v24
    s_add_u32 s68, s68, s29
    s_mov_b32 s29, 0
    v_permlane32_swap_b32 v24, v25
    v_or_b32 v24, 1, v24
    s_mov_b64 exec, s[24:25]
    buffer_store_dwordx2 v[24:25], v9, s[4:7], s22 offen
    s_mov_b64 exec, -1
L_mre0:
    v_mov_b32 v20, 0
    v_mov_b32 v21, 0
    v_mov_b32 v22, 0
    v_mov_b32 v23, 0
    v_mov_b32 v28, 0
    v_mov_b32 v29, 0
    v_mov_b32 v30, 0
    v_mov_b32 v31, 0
    v_mov_b32 v60, -1
    v_mov_b32 v61, 1
    v_and_b32 v62, 0x1f0, v2
    v_lshlrev_b32 v62, 3, v62
    s_cmp_eq_u32 s13, 0
    s_cbranch_scc1 L_ma0
    s_waitcnt vmcnt(1)
    v_add_u32 v44, s71, v2
    v_mov_b32 v52, 0
    v_mov_b32 v53, 0
    v_mov_b32 v54, 0
    v_mov_b32 v55, 0
    v_mov_b32 v56, 0
    v_mov_b32 v57, 0
    v_mov_b32 v58, 0
    v_mov_b32 v59, 0
    ds_read_b128 v[44:47], v44
    v_lshrrev_b32 v50, 1, v2
    v_and_b32 v51, 0x100, v50
    v_lshrrev_b32 v51, 2, v51
    v_add3_u32 v51, v51, v50, s84
    ds_read_b64 v[48:49], v51
    v_mov_b32 v51, s14
    v_min_u32 v18, s87, v2
    v_lshlrev_b32 v18, 3, v18
    s_cmp_eq_u32 s13, 1
    s_cbranch_scc1 L_mb0
    s_waitcnt vmcnt(0)
    s_branch L_next0
L_mb0:
    s_nop 15
    s_nop 15
    s_nop 15
    s_nop 15
    s_nop 15
    s_nop 7
    buffer_load_dword v61, v18, s[4:7], s67 offen sc1
    s_mov_b32 m0, s53
    s_add_u32 s30, s21, 4096
    buffer_load_dwordx4 v2, s[4:7], s21 offen offset:0 sc1 lds
    buffer_load_dwordx4 v2, s[4:7], s21 offen offset:1024 sc1 lds
    buffer_load_dwordx4 v2, s[4:7], s21 offen offset:2048 sc1 lds
    buffer_load_dwordx4 v2, s[4:7], s21 offen offset:3072 sc1 lds
    s_add_u32 m0, s53, 4096
    s_nop 0
    buffer_load_dwordx4 v2, s[4:7], s30 offen sc1 lds
    s_branch L_next0
L_ma0:
    s_waitcnt vmcnt(1)
    v_add_u32 v44, s71, v2
    v_mov_b32 v52, 0
    v_mov_b32 v53, 0
    v_mov_b32 v54, 0
    v_mov_b32 v55, 0
    v_mov_b32 v56, 0
    v_mov_b32 v57, 0
    v_mov_b32 v58, 0
    v_mov_b32 v59, 0
    ds_read_b128 v[44:47], v44
    v_lshrrev_b32 v50, 1, v2
    v_and_b32 v51, 0x100, v50
    v_lshrrev_b32 v51, 2, v51
    v_add3_u32 v51, v51, v50, s84
    ds_read_b64 v[48:49], v51
    v_mov_b32 v51, s14
    v_min_u32 v18, s87, v2
    v_lshlrev_b32 v18, 3, v18
    s_nop 15
    s_nop 15
    s_nop 15
    s_nop 7
    buffer_load_dword v61, v18, s[4:7], s67 offen sc1
    s_mov_b32 m0, s53
    s_add_u32 s30, s21, 4096
    buffer_load_dwordx4 v2, s[4:7], s21 offen offset:0 sc1 lds
    buffer_load_dwordx4 v2, s[4:7], s21 offen offset:1024 sc1 lds
    buffer_load_dwordx4 v2, s[4:7], s21 offen offset:2048 sc1 lds
    buffer_load_dwordx4 v2, s[4:7], s21 offen offset:3072 sc1 lds
    s_waitcnt vmcnt(4)
    v_and_b32 v16, 1, v61
    v_cmp_ne_u32 vcc, 1, v16
    s_cbranch_vccz L_mgot0
    s_add_u32 s69, s69, 1
L_mloop0:
    buffer_load_dword v12, v18, s[4:7], s67 offen sc1
    s_waitcnt vmcnt(0)
    v_and_b32 v16, 1, v12
    v_cmp_ne_u32 vcc, 1, v16
    s_cbranch_vccz L_msee0
    s_add_u32 s29, s29, 1
    s_cmp_gt_u32 s29, 0x40000
    s_cbranch_scc0 L_mloop0
    s_branch L_chain_fail
L_msee0:
    buffer_load_dword v61, v18, s[4:7], s67 offen sc1
    s_mov_b32 m0, s53
    s_add_u32 s30, s21, 4096
    buffer_load_dwordx4 v2, s[4:7], s21 offen offset:0 sc1 lds
    buffer_load_dwordx4 v2, s[4:7], s21 offen offset:1024 sc1 lds
    buffer_load_dwordx4 v2, s[4:7], s21 offen offset:2048 sc1 lds
    buffer_load_dwordx4 v2, s[4:7], s21 offen offset:3072 sc1 lds
L_mgot0:
    s_waitcnt vmcnt(0)
L_next0:
    s_add_u32 s14, s14, 1
    s_add_u32 s56, s56, 9216
    s_waitcnt lgkmcnt(0)
L_b11:
    s_barrier
    ds_read_b128 v[12:15], v2 offset:0
    s_mov_b32 m0, s66
    ds_read_b128 v[16:19], v2 offset:1024
    ds_read_b128 v[32:35], v11 offset:1024
    s_waitcnt lgkmcnt(2)
    v_smfmac_f32_16x16x64_bf16 v[56:59], v[12:15], v[152:159], v0
    v_smfmac_f32_16x16x64_bf16 v[28:31], v[12:15], a[224:231], v0
    s_waitcnt lgkmcnt(1)
    v_smfmac_f32_16x16x64_bf16 v[52:55], v[16:19], v[160:167], v0
    ds_read_b128 v[24:27], v11 offset:0
    v_smfmac_f32_16x16x64_bf16 v[52:55], v[12:15], v[144:151], v0
    ds_read_b128 v[40:43], v1 offset:9216
    v_smfmac_f32_16x16x64_bf16 v[20:23], v[12:15], a[96:103], v0
    ds_read_b128 v[36:39], v1 offset:8192
    v_bitop3_b32 v60, v60, v12, v14 bitop3:0x80
    v_smfmac_f32_16x16x64_bf16 v[56:59], v[16:19], v[168:175], v0
    ds_read_b128 v[12:15], v2 offset:2048
    s_waitcnt lgkmcnt(3)
    v_smfmac_f32_16x16x64_bf16 v[28:31], v[24:27], a[232:239], v0
    buffer_load_dwordx4 v2, s[4:7], s50 offen sc1 lds
    v_smfmac_f32_16x16x64_bf16 v[20:23], v[24:27], a[104:111], v0
    ds_read_b128 v[24:27], v11 offset:2048
    v_smfmac_f32_16x16x64_bf16 v[20:23], v[16:19], a[112:119], v0
    buffer_load_dwordx4 v2, s[4:7], s50 offen offset:1024 sc1 lds
    v_smfmac_f32_16x16x64_bf16 v[28:31], v[32:35], a[248:255], v0
    s_waitcnt lgkmcnt(1)
    v_bitop3_b32 v60, v60, v16, v18 bitop3:0x80
    v_smfmac_f32_16x16x64_bf16 v[52:55], v[12:15], v[36:43], v0
    buffer_store_dwordx4 v[44:47], v2, s[4:7], s70 offen sc1
    ds_read_b128 v[40:43], v1 offset:13312
    ds_read_b128 v[36:39], v1 offset:12288
    v_bitop3_b32 v60, v60, v12, v14 bitop3:0x80
    v_smfmac_f32_16x16x64_bf16 v[28:31], v[16:19], a[240:247], v0
    ds_read_b128 v[16:19], v2 offset:3072
    v_smfmac_f32_16x16x64_bf16 v[20:23], v[12:15], a[128:135], v0
    ds_read_b128 v[44:47], v1 offset:10240
    buffer_store_dwordx2 v[48:49], v50, s[4:7], s83 offen sc1
    buffer_store_dword v51, off, s[4:7], s62 sc1
    ds_read_b128 v[48:51], v1 offset:11264
    v_smfmac_f32_16x16x64_bf16 v[28:31], v[12:15], v[64:71], v0
    v_smfmac_f32_16x16x64_bf16 v[20:23], v[32:35], a[120:127], v0
    ds_read_b128 v[32:35], v11 offset:3072
    s_waitcnt lgkmcnt(6)
    v_smfmac_f32_16x16x64_bf16 v[28:31], v[24:27], v[72:79], v0
    s_waitcnt lgkmcnt(1)
    v_smfmac_f32_16x16x64_bf16 v[56:59], v[12:15], v[44:51], v0
    ds_read_b128 v[48:51], v1 offset:15360
    ds_read_b128 v[44:47], v1 offset:14336
    v_smfmac_f32_16x16x64_bf16 v[20:23], v[24:27], a[136:143], v0
    v_smfmac_f32_16x16x64_bf16 v[52:55], v[16:19], v[36:43], v0
    s_waitcnt lgkmcnt(0)
    v_smfmac_f32_16x16x64_bf16 v[56:59], v[16:19], v[44:51], v0
    s_waitcnt vmcnt(5)
    ds_read_b128 v[44:47], v1 offset:30720
    v_and_b32 v63, 1, v61
    v_cmp_ne_u32 vcc, 1, v63
    v_smfmac_f32_16x16x64_bf16 v[20:23], v[16:19], a[144:151], v0
    ds_read_b128 v[36:39], v1 offset:28672
    ds_read_b128 v[40:43], v1 offset:29696
    v_smfmac_f32_16x16x64_bf16 v[28:31], v[16:19], v[80:87], v0
    s_cbranch_vccnz L_rb1
L_rbk1:
    s_barrier
    ds_read_b128 v[12:15], v2 offset:4096
    ds_read_b128 v[48:51], v1 offset:31744
    v_smfmac_f32_16x16x64_bf16 v[20:23], v[32:35], a[152:159], v0
    ds_read_b128 v[24:27], v11 offset:4096
    v_bitop3_b32 v60, v60, v16, v18 bitop3:0x80
    v_smfmac_f32_16x16x64_bf16 v[28:31], v[32:35], v[88:95], v0
    ds_read_b128 v[32:35], v11 offset:5120
    s_waitcnt lgkmcnt(3)
    v_smfmac_f32_16x16x64_bf16 v[20:23], v[12:15], a[160:167], v0
    ds_read_b128 v[16:19], v2 offset:5120
    v_smfmac_f32_16x16x64_bf16 v[28:31], v[12:15], v[96:103], v0
    s_mov_b32 m0, 161344
    ds_read_b128 v[12:15], v2 offset:6144
    s_waitcnt lgkmcnt(3)
    v_smfmac_f32_16x16x64_bf16 v[28:31], v[24:27], v[104:111], v0
    v_smfmac_f32_16x16x64_bf16 v[20:23], v[24:27], a[168:175], v0
    ds_read_b128 v[24:27], v11 offset:6144
    s_waitcnt lgkmcnt(2)
    v_smfmac_f32_16x16x64_bf16 v[20:23], v[16:19], v[36:43], v0
    ds_read_b128 v[40:43], v1 offset:1024
    v_smfmac_f32_16x16x64_bf16 v[28:31], v[16:19], v[112:119], v0
    ds_read_b128 v[36:39], v1 offset:0
    v_smfmac_f32_16x16x64_bf16 v[20:23], v[32:35], v[44:51], v0
    ds_read_b128 v[44:47], v1 offset:2048
    v_smfmac_f32_16x16x64_bf16 v[28:31], v[32:35], v[120:127], v0
    s_waitcnt lgkmcnt(4)
    ds_read_b128 v[48:51], v1 offset:3072
    ds_read_b128 v[16:19], v2 offset:7168
    v_bitop3_b32 v60, v60, v12, v14 bitop3:0x80
    v_smfmac_f32_16x16x64_bf16 v[20:23], v[12:15], a[176:183], v0
    ds_read_b128 v[32:35], v11 offset:7168
    s_waitcnt lgkmcnt(4)
    v_smfmac_f32_16x16x64_bf16 v[28:31], v[12:15], v[36:43], v0
    ds_read_b128 v[36:39], v1 offset:4096
    buffer_load_dword v62, s[4:7], s64 offen sc1 lds
    v_smfmac_f32_16x16x64_bf16 v[20:23], v[24:27], a[184:191], v0
    ds_read_b128 v[40:43], v1 offset:5120
    s_waitcnt lgkmcnt(4)
    v_smfmac_f32_16x16x64_bf16 v[28:31], v[24:27], v[44:51], v0
    s_waitcnt lgkmcnt(3)
    v_smfmac_f32_16x16x64_bf16 v[20:23], v[16:19], a[192:199], v0
    ds_read_b128 v[12:15], v2 offset:8192
    ds_read_b128 v[44:47], v1 offset:6144
    v_smfmac_f32_16x16x64_bf16 v[28:31], v[16:19], v[128:135], v0
    s_waitcnt lgkmcnt(4)
    v_bitop3_b32 v60, v60, v16, v18 bitop3:0x80
    v_smfmac_f32_16x16x64_bf16 v[20:23], v[32:35], a[200:207], v0
    ds_read_b128 v[24:27], v11 offset:8192
    ds_read_b128 v[16:19], v2 offset:4096
    v_smfmac_f32_16x16x64_bf16 v[28:31], v[32:35], v[136:143], v0
    s_waitcnt lgkmcnt(3)
    v_smfmac_f32_16x16x64_bf16 v[28:31], v[12:15], v[36:43], v0
    ds_read_b128 v[48:51], v1 offset:7168
    v_bitop3_b32 v60, v60, v12, v14 bitop3:0x80
    v_smfmac_f32_16x16x64_bf16 v[20:23], v[12:15], a[208:215], v0
    ds_read_b128 v[12:15], v2 offset:5120
    s_waitcnt lgkmcnt(3)
    v_smfmac_f32_16x16x64_bf16 v[20:23], v[24:27], a[216:223], v0
    s_waitcnt lgkmcnt(2)
    v_smfmac_f32_16x16x64_bf16 v[52:55], v[16:19], v[176:183], v0
    ds_read_b128 v[36:39], v2 offset:9216
    v_bitop3_b32 v60, v60, v16, v18 bitop3:0x80
    v_smfmac_f32_16x16x64_bf16 v[56:59], v[16:19], v[184:191], v0
    ds_read_b128 v[40:43], v2 offset:10240
    s_waitcnt lgkmcnt(2)
    v_mul_f32 v20, s28, v20
    v_bitop3_b32 v60, v60, v12, v14 bitop3:0x80
    v_smfmac_f32_16x16x64_bf16 v[28:31], v[24:27], v[44:51], v0
    ds_read_b128 v[44:47], v2 offset:11264
    v_mul_f32 v21, s28, v21
    v_smfmac_f32_16x16x64_bf16 v[52:55], v[12:15], v[192:199], v0
    ds_read_b128 v[16:19], v2 offset:6144
    v_mul_f32 v23, s28, v23
    v_mul_f32 v22, s28, v22
    v_cvt_pk_bf16_f32 v20, v20, v21
    v_cvt_pk_bf16_f32 v21, v22, v23
    v_smfmac_f32_16x16x64_bf16 v[56:59], v[12:15], v[200:207], v0
    ds_read_b128 v[12:15], v2 offset:7168
    ds_write2_b32 v4, v20, v21 offset0:0 offset1:80
    v_cvt_pk_bf16_f32 v28, v28, v29
    v_cvt_pk_bf16_f32 v29, v30, v31
    s_waitcnt lgkmcnt(2)
    v_smfmac_f32_16x16x64_bf16 v[56:59], v[16:19], v[216:223], v0
    ds_write2_b32 v4, v28, v29 offset0:144 offset1:224
    v_and_b32 v60, 1, v60
    v_smfmac_f32_16x16x64_bf16 v[52:55], v[16:19], v[208:215], v0
    ds_read_b128 v[16:19], v2 offset:8192
    s_waitcnt lgkmcnt(3)
    v_cmp_ne_u32 vcc, 1, v60
    v_smfmac_f32_16x16x64_bf16 v[52:55], v[12:15], v[224:231], v0
    v_smfmac_f32_16x16x64_bf16 v[56:59], v[12:15], v[232:239], v0
    s_cbranch_vccz L_ok1
    s_branch L_redo1
L_ok1:
    s_waitcnt lgkmcnt(0)
    s_barrier
    ds_read_b64_tr_b16 v[20:21], v5 offset:21504
    ds_read_b64_tr_b16 v[22:23], v5 offset:21520
    v_smfmac_f32_16x16x64_bf16 v[52:55], v[16:19], v[240:247], v0
    ds_read_b64_tr_b16 v[24:25], v5 offset:22664
    s_add_u32 s50, s50, 262144
    ds_read_b128 v[48:51], v2 offset:12288
    v_smfmac_f32_16x16x64_bf16 v[56:59], v[16:19], v[248:255], v0
    ds_read_b64_tr_b16 v[26:27], v5 offset:22680
    ds_read_b64_tr_b16 v[32:33], v5 offset:23824
    ds_read_b64_tr_b16 v[28:29], v5 offset:24984
    s_waitcnt lgkmcnt(5)
    v_mfma_f32_16x16x32_bf16 v[12:15], v[36:39], v[20:23], 0
    ds_read_b64_tr_b16 v[34:35], v5 offset:23840
    ds_read_b128 v[36:39], v2 offset:13312
    v_mfma_f32_16x16x32_bf16 v[16:19], v[40:43], v[20:23], 0
    ds_read_b128 v[40:43], v2 offset:14336
    s_waitcnt lgkmcnt(5)
    v_mfma_f32_16x16x32_bf16 v[12:15], v[44:47], v[24:27], v[12:15]
    ds_read_b128 v[44:47], v2 offset:15360
    v_mfma_f32_16x16x32_bf16 v[16:19], v[48:51], v[24:27], v[16:19]
    ds_read_b64_tr_b16 v[30:31], v5 offset:25000
    ds_read_b128 v[48:51], v2 offset:16384
    s_waitcnt lgkmcnt(4)
    v_mfma_f32_16x16x32_bf16 v[12:15], v[36:39], v[32:35], v[12:15]
    s_add_u32 s64, s64, 262144
    ds_read_b64_tr_b16 v[36:37], v6 offset:0
    v_cvt_pk_bf16_f32 v52, v52, v56
    v_cvt_pk_bf16_f32 v56, v54, v58
    s_waitcnt lgkmcnt(4)
    v_mfma_f32_16x16x32_bf16 v[16:19], v[40:43], v[32:35], v[16:19]
    ds_read_b64_tr_b16 v[42:43], v6 offset:1176
    ds_read_b64_tr_b16 v[40:41], v6 offset:1160
    s_waitcnt lgkmcnt(4)
    v_cvt_pk_bf16_f32 v53, v53, v57
    v_mfma_f32_16x16x32_bf16 v[12:15], v[44:47], v[28:31], v[12:15]
    ds_read_b64_tr_b16 v[38:39], v6 offset:16
    ds_read_b64_tr_b16 v[44:45], v6 offset:2320
    s_waitcnt lgkmcnt(5)
    v_mov_b32 v54, 0
    v_mfma_f32_16x16x32_bf16 v[16:19], v[48:51], v[28:31], v[16:19]
    ds_read_b64_tr_b16 v[48:49], v6 offset:3480
    ds_read_b64_tr_b16 v[50:51], v6 offset:3496
    ds_read_b64_tr_b16 v[46:47], v6 offset:2336
    v_cvt_pk_bf16_f32 v57, v55, v59
    v_mov_b32 v59, 0
    v_mov_b32 v58, 0
    s_waitcnt lgkmcnt(4)
    v_mfma_f32_16x16x32_bf16 v[60:63], v[36:39], v[20:23], 0
    s_waitcnt vmcnt(4)
    ds_read2st64_b32 v[38:39], v8 offset0:2 offset1:3
    v_mov_b32 v55, 0
    v_mfma_f32_16x16x32_bf16 v[60:63], v[40:43], v[24:27], v[60:63]
    ds_read2st64_b32 v[40:41], v8 offset0:4 offset1:5
    s_waitcnt lgkmcnt(2)
    v_exp_f32 v20, v12
    v_mfma_f32_16x16x32_bf16 v[60:63], v[44:47], v[32:35], v[60:63]
    ds_read_b128 v[44:47], v2 offset:30720
    ds_read2st64_b32 v[42:43], v8 offset0:6 offset1:7
    v_exp_f32 v21, v13
    v_mfma_f32_16x16x32_bf16 v[60:63], v[48:51], v[28:31], v[60:63]
    ds_read_b128 v[28:31], v2 offset:31744
    ds_read2st64_b32 v[36:37], v8 offset0:0 offset1:1
    ds_read_b128 v[48:51], v2 offset:31744
    v_exp_f32 v22, v14
    v_max3_f32 v32, |v12|, |v13|, |v14|
    v_max3_f32 v32, v32, |v15|, |v16|
    v_cvt_pk_bf16_f32 v20, v20, v21
    v_max3_f32 v32, v32, |v17|, |v18|
    v_max3_f32 v33, |v61|, |v62|, |v63|
    v_exp_f32 v23, v15
    v_exp_f32 v24, v16
    v_exp_f32 v25, v17
    v_exp_f32 v27, v19
    v_max3_f32 v32, v32, |v19|, |v60|
    v_max_f32 v33, v32, v33
    v_cmp_nge_f32 vcc, 0x42800000, v33
    v_exp_f32 v26, v18
    v_cvt_pk_bf16_f32 v21, v22, v23
    v_cvt_pk_bf16_f32 v22, v24, v25
    v_cvt_pk_bf16_f32 v23, v26, v27
    s_cbranch_vccnz L_mx1
L_mxk1:
    v_exp_f32 v60, v60
    s_waitcnt lgkmcnt(1)
    v_smfmac_f32_16x16x64_bf16 v[28:31], v[20:23], v[36:43], v0
    ds_read_b128 v[32:35], v2 offset:31744
    v_exp_f32 v61, v61
    v_exp_f32 v62, v62
    v_exp_f32 v63, v63
    v_mfma_f32_16x16x32_bf16 v[16:19], v[20:23], v[44:47], 0
    s_waitcnt lgkmcnt(1)
    v_cvt_pk_bf16_f32 v50, v62, v63
    v_cvt_pk_bf16_f32 v48, v60, v61
    v_mfma_f32_16x16x32_bf16 v[16:19], v[20:23], v[44:47], v[16:19]
    ds_read_b128 v[12:15], v2 offset:31744
    ds_read_b128 v[20:23], v1 offset:24576
    v_mfma_f32_16x16x32_bf16 v[16:19], v[48:51], v[44:47], v[16:19]
    v_smfmac_f32_16x16x64_bf16 v[28:31], v[48:51], v[52:59], v0
    ds_read_b128 v[24:27], v1 offset:25600
    ds_read_b128 v[60:63], v2 offset:31744
    ds_write2st64_b32 v8, v52, v53 offset0:0 offset1:1
    v_subrev_u32 v44, 21504, v4
    s_nop 0
    v_rcp_f32 v17, v17
    v_rcp_f32 v18, v18
    v_rcp_f32 v16, v16
    v_rcp_f32 v19, v19
    v_mul_f32 v30, v30, v18
    v_mul_f32 v28, v28, v16
    v_mul_f32 v29, v29, v17
    v_cvt_pk_bf16_f32 v28, v28, v29
    v_mul_f32 v31, v31, v19
    v_cvt_pk_bf16_f32 v29, v30, v31
    ds_write2_b32 v44, v28, v29 offset0:0 offset1:80
    ds_write2st64_b32 v8, v56, v57 offset0:2 offset1:3
    v_mov_b32 v28, 0
    v_mov_b32 v31, 0
    s_mov_b32 m0, s65
    ds_read_b128 v[16:19], v2 offset:31744
    v_mov_b32 v30, 0
    ds_read_b128 v[56:59], v1 offset:27648
    v_mov_b32 v29, 0
    s_waitcnt lgkmcnt(2)
    s_barrier
    s_cmp_eq_u32 s14, 63
    s_cbranch_scc1 L_chain_last
    ds_read_b64_tr_b16 v[36:37], v7 offset:0
    ds_read_b64_tr_b16 v[38:39], v7 offset:16
    ds_read_b64_tr_b16 v[42:43], v7 offset:1176
    ds_read_b64_tr_b16 v[40:41], v7 offset:1160
    ds_read_b64_tr_b16 v[46:47], v3 offset:16
    ds_read_b64_tr_b16 v[48:49], v3 offset:1160
    ds_read_b64_tr_b16 v[44:45], v3 offset:0
    s_waitcnt lgkmcnt(5)
    v_smfmac_f32_16x16x64_bf16 v[12:15], v[36:39], a[0:7], v0
    ds_read_b64_tr_b16 v[50:51], v3 offset:1176
    s_waitcnt lgkmcnt(4)
    v_smfmac_f32_16x16x64_bf16 v[12:15], v[40:43], a[16:23], v0
    buffer_load_dwordx4 v2, s[4:7], s49 offen offset:0 sc1 lds
    s_waitcnt lgkmcnt(1)
    v_smfmac_f32_16x16x64_bf16 v[12:15], v[44:47], a[32:39], v0
    s_waitcnt lgkmcnt(0)
    v_smfmac_f32_16x16x64_bf16 v[12:15], v[48:51], a[48:55], v0
    v_smfmac_f32_16x16x64_bf16 v[32:35], v[36:39], a[8:15], v0
    buffer_load_dwordx4 v2, s[4:7], s49 offen offset:1024 sc1 lds
    v_smfmac_f32_16x16x64_bf16 v[32:35], v[40:43], a[24:31], v0
    s_add_u32 s49, s49, 262144
    ds_read_b128 v[52:55], v1 offset:26624
    v_cvt_pk_bf16_f32 v12, v12, v13
    v_cvt_pk_bf16_f32 v13, v14, v15
    v_and_b32 v12, -2, v12
    v_smfmac_f32_16x16x64_bf16 v[32:35], v[44:47], a[40:47], v0
    buffer_store_dwordx2 v[12:13], v9, s[4:7], s20 offen offset:0
    v_smfmac_f32_16x16x64_bf16 v[32:35], v[48:51], a[56:63], v0
    v_smfmac_f32_16x16x64_bf16 v[60:63], v[36:39], v[20:27], v0
    ds_read_b128 v[20:23], v1 offset:16384
    ds_read_b128 v[24:27], v1 offset:17408
    s_waitcnt lgkmcnt(2)
    v_smfmac_f32_16x16x64_bf16 v[60:63], v[40:43], v[52:59], v0
    ds_read_b128 v[56:59], v1 offset:21504
    ds_read_b128 v[52:55], v1 offset:20480
    v_cvt_pk_bf16_f32 v32, v32, v33
    v_and_b32 v32, -2, v32
    v_cvt_pk_bf16_f32 v33, v34, v35
    v_smfmac_f32_16x16x64_bf16 v[28:31], v[36:39], a[64:71], v0
    buffer_store_dwordx2 v[32:33], v9, s[4:7], s20 offen offset:512
    v_smfmac_f32_16x16x64_bf16 v[28:31], v[44:47], a[80:87], v0
    s_waitcnt lgkmcnt(2)
    v_cvt_pk_bf16_f32 v60, v60, v61
    v_smfmac_f32_16x16x64_bf16 v[28:31], v[40:43], v[20:27], v0
    ds_read_b128 v[20:23], v1 offset:18432
    ds_read_b128 v[24:27], v1 offset:19456
    v_and_b32 v60, -2, v60
    v_cvt_pk_bf16_f32 v61, v62, v63
    s_waitcnt lgkmcnt(2)
    v_smfmac_f32_16x16x64_bf16 v[28:31], v[48:51], v[52:59], v0
    s_mov_b32 s29, 0
    ds_read_b128 v[56:59], v1 offset:23552
    ds_read_b128 v[52:55], v1 offset:22528
    v_smfmac_f32_16x16x64_bf16 v[16:19], v[36:39], a[72:79], v0
    buffer_store_dwordx2 v[60:61], v9, s[4:7], s3 offen offset:0
    v_smfmac_f32_16x16x64_bf16 v[16:19], v[44:47], a[88:95], v0
    s_waitcnt lgkmcnt(2)
    s_nop 0
    v_cvt_pk_bf16_f32 v28, v28, v29
    v_smfmac_f32_16x16x64_bf16 v[16:19], v[40:43], v[20:27], v0
    s_mov_b32 s70, s52
    v_cvt_pk_bf16_f32 v29, v30, v31
    v_and_b32 v28, -2, v28
    s_waitcnt lgkmcnt(0)
    v_smfmac_f32_16x16x64_bf16 v[16:19], v[48:51], v[52:59], v0
    s_mov_b32 s83, s51
    buffer_store_dwordx2 v[28:29], v9, s[4:7], s20 offen offset:1024
    s_add_u32 s52, s52, 131072
    s_nop 4
    v_cvt_pk_bf16_f32 v16, v16, v17
    v_and_b32 v16, -2, v16
    v_cvt_pk_bf16_f32 v17, v18, v19
    s_add_u32 s51, s51, 65536
    buffer_store_dwordx2 v[16:17], v9, s[4:7], s20 offen offset:1536
    s_cmp_eq_u32 s13, 0
    s_cbranch_scc0 L_nw01
    s_nop 15
    buffer_load_dwordx4 v[36:39], v10, s[4:7], s16 offen offset:0 sc1
    buffer_load_dwordx4 v[40:43], v10, s[4:7], s17 offen offset:0 sc1
    buffer_load_dwordx4 v[44:47], v10, s[4:7], s18 offen offset:0 sc1
    buffer_load_dwordx4 v[48:51], v10, s[4:7], s19 offen offset:0 sc1
    v_mov_b32 v31, 0x3f80
    v_and_b32 v30, 16, v2
    v_lshlrev_b32 v30, v30, v31
    v_cndmask_b32 v20, 0, v30, s[72:73]
    v_cndmask_b32 v21, 0, v30, s[74:75]
    v_cndmask_b32 v22, 0, v30, s[76:77]
    v_cndmask_b32 v23, 0, v30, s[78:79]
    s_barrier
    s_branch L_rgo1
L_nw01:
    s_cmp_eq_u32 s23, 0
    s_cbranch_scc0 L_rd11
    s_barrier
    s_branch L_mre1
L_rd11:
    v_mov_b32 v31, 0x3f80
    v_and_b32 v30, 16, v2
    v_lshlrev_b32 v30, v30, v31
    v_cndmask_b32 v20, 0, v30, s[72:73]
    v_cndmask_b32 v21, 0, v30, s[74:75]
    v_cndmask_b32 v22, 0, v30, s[76:77]
    v_cndmask_b32 v23, 0, v30, s[78:79]
    s_barrier
    s_cmp_eq_u32 s13, 2
    s_cbranch_scc1 L_r81
    s_nop 15
    s_nop 15
    s_nop 7
    buffer_load_dwordx4 v[36:39], v10, s[4:7], s16 offen offset:0 sc1
    buffer_load_dwordx4 v[40:43], v10, s[4:7], s17 offen offset:0 sc1
    buffer_load_dwordx4 v[44:47], v10, s[4:7], s18 offen offset:0 sc1
    buffer_load_dwordx4 v[48:51], v10, s[4:7], s19 offen offset:0 sc1
L_rgo1:
    s_nop 15
    s_nop 15
    s_nop 7
    buffer_load_dwordx4 v[12:15], v10, s[4:7], s16 offen offset:0 sc1
    buffer_load_dwordx4 v[32:35], v10, s[4:7], s17 offen offset:0 sc1
    buffer_load_dwordx4 v[52:55], v10, s[4:7], s18 offen offset:0 sc1
    buffer_load_dwordx4 v[56:59], v10, s[4:7], s19 offen offset:0 sc1
L_rpoll1:
    s_waitcnt vmcnt(7)
    v_mfma_f32_16x16x32_bf16 v[24:27], v[36:39], v[20:23], 0
    v_bitop3_b32 v30, v36, v38, 1 bitop3:0xa8
    v_cmp_ne_u32 s[32:33], 0, v30
    s_waitcnt vmcnt(6)
    v_mfma_f32_16x16x32_bf16 v[24:27], v[40:43], v[20:23], v[24:27]
    v_bitop3_b32 v31, v40, v42, 1 bitop3:0xa8
    v_cmp_ne_u32 s[34:35], 0, v31
    s_waitcnt vmcnt(5)
    v_mfma_f32_16x16x32_bf16 v[24:27], v[44:47], v[20:23], v[24:27]
    v_bitop3_b32 v30, v44, v46, 1 bitop3:0xa8
    v_cmp_ne_u32 s[36:37], 0, v30
    s_waitcnt vmcnt(4)
    v_mfma_f32_16x16x32_bf16 v[24:27], v[48:51], v[20:23], v[24:27]
    v_bitop3_b32 v31, v48, v50, 1 bitop3:0xa8
    v_cmp_ne_u32 s[38:39], 0, v31
    s_or_b64 vcc, s[32:33], s[34:35]
    s_or_b64 vcc, vcc, s[36:37]
    s_or_b64 vcc, vcc, s[38:39]
    s_cbranch_scc0 L_rgot1
    s_mov_b64 exec, s[32:33]
    buffer_load_dwordx4 v[36:39], v10, s[4:7], s16 offen offset:0 sc1
    s_mov_b64 exec, s[34:35]
    buffer_load_dwordx4 v[40:43], v10, s[4:7], s17 offen offset:0 sc1
    s_mov_b64 exec, s[36:37]
    buffer_load_dwordx4 v[44:47], v10, s[4:7], s18 offen offset:0 sc1
    s_mov_b64 exec, s[38:39]
    buffer_load_dwordx4 v[48:51], v10, s[4:7], s19 offen offset:0 sc1
    s_mov_b64 exec, -1
    s_waitcnt vmcnt(7)
    v_mfma_f32_16x16x32_bf16 v[24:27], v[12:15], v[20:23], 0
    v_bitop3_b32 v30, v12, v14, 1 bitop3:0xa8
    v_cmp_ne_u32 s[40:41], 0, v30
    s_waitcnt vmcnt(6)
    v_mfma_f32_16x16x32_bf16 v[24:27], v[32:35], v[20:23], v[24:27]
    v_bitop3_b32 v31, v32, v34, 1 bitop3:0xa8
    v_cmp_ne_u32 s[42:43], 0, v31
    s_waitcnt vmcnt(5)
    v_mfma_f32_16x16x32_bf16 v[24:27], v[52:55], v[20:23], v[24:27]
    v_bitop3_b32 v30, v52, v54, 1 bitop3:0xa8
    v_cmp_ne_u32 s[44:45], 0, v30
    s_waitcnt vmcnt(4)
    v_mfma_f32_16x16x32_bf16 v[24:27], v[56:59], v[20:23], v[24:27]
    v_bitop3_b32 v31, v56, v58, 1 bitop3:0xa8
    v_cmp_ne_u32 s[46:47], 0, v31
    s_or_b64 vcc, s[40:41], s[42:43]
    s_or_b64 vcc, vcc, s[44:45]
    s_or_b64 vcc, vcc, s[46:47]
    s_cbranch_scc0 L_rgot1
    s_mov_b64 exec, s[40:41]
    buffer_load_dwordx4 v[12:15], v10, s[4:7], s16 offen offset:0 sc1
    s_mov_b64 exec, s[42:43]
    buffer_load_dwordx4 v[32:35], v10, s[4:7], s17 offen offset:0 sc1
    s_mov_b64 exec, s[44:45]
    buffer_load_dwordx4 v[52:55], v10, s[4:7], s18 offen offset:0 sc1
    s_mov_b64 exec, s[46:47]
    buffer_load_dwordx4 v[56:59], v10, s[4:7], s19 offen offset:0 sc1
    s_mov_b64 exec, -1
    s_add_u32 s29, s29, 1
    s_cmp_gt_u32 s29, 0x40000
    s_cbranch_scc0 L_rpoll1
    s_branch L_chain_fail
L_r81:
    s_nop 15
    buffer_load_dwordx4 v[36:39], v10, s[4:7], s16 offen offset:0 sc1
    buffer_load_dwordx4 v[40:43], v10, s[4:7], s17 offen offset:0 sc1
    buffer_load_dwordx4 v[44:47], v10, s[4:7], s18 offen offset:0 sc1
    buffer_load_dwordx4 v[48:51], v10, s[4:7], s19 offen offset:0 sc1
    buffer_load_dwordx4 v[12:15], v10, s[4:7], s16 offen offset:1024 sc1
    buffer_load_dwordx4 v[32:35], v10, s[4:7], s17 offen offset:1024 sc1
    buffer_load_dwordx4 v[52:55], v10, s[4:7], s18 offen offset:1024 sc1
    buffer_load_dwordx4 v[56:59], v10, s[4:7], s19 offen offset:1024 sc1
L_r8p1:
    s_waitcnt vmcnt(7)
    v_mfma_f32_16x16x32_bf16 v[24:27], v[36:39], v[20:23], 0
    s_waitcnt vmcnt(6)
    v_bitop3_b32 v30, v36, v38, 1 bitop3:0xa8
    v_mfma_f32_16x16x32_bf16 v[24:27], v[40:43], v[20:23], v[24:27]
    v_bitop3_b32 v31, v40, v42, 1 bitop3:0xa8
    v_or3_b32 v63, v30, v31, 0
    s_waitcnt vmcnt(5)
    v_mfma_f32_16x16x32_bf16 v[24:27], v[44:47], v[20:23], v[24:27]
    s_waitcnt vmcnt(4)
    v_bitop3_b32 v30, v44, v46, 1 bitop3:0xa8
    v_mfma_f32_16x16x32_bf16 v[24:27], v[48:51], v[20:23], v[24:27]
    v_bitop3_b32 v31, v48, v50, 1 bitop3:0xa8
    v_or3_b32 v63, v30, v31, v63
    s_waitcnt vmcnt(3)
    v_mfma_f32_16x16x32_bf16 v[24:27], v[12:15], v[20:23], v[24:27]
    s_waitcnt vmcnt(2)
    v_bitop3_b32 v30, v12, v14, 1 bitop3:0xa8
    v_mfma_f32_16x16x32_bf16 v[24:27], v[32:35], v[20:23], v[24:27]
    v_bitop3_b32 v31, v32, v34, 1 bitop3:0xa8
    v_or3_b32 v63, v30, v31, v63
    s_waitcnt vmcnt(1)
    v_mfma_f32_16x16x32_bf16 v[24:27], v[52:55], v[20:23], v[24:27]
    s_waitcnt vmcnt(0)
    v_bitop3_b32 v30, v52, v54, 1 bitop3:0xa8
    v_mfma_f32_16x16x32_bf16 v[24:27], v[56:59], v[20:23], v[24:27]
    v_bitop3_b32 v31, v56, v58, 1 bitop3:0xa8
    v_or3_b32 v63, v30, v31, v63
    v_cmp_ne_u32 vcc, 0, v63
    s_cbranch_vccz L_rgot1
    buffer_load_dwordx4 v[36:39], v10, s[4:7], s16 offen offset:0 sc1
    buffer_load_dwordx4 v[40:43], v10, s[4:7], s17 offen offset:0 sc1
    buffer_load_dwordx4 v[44:47], v10, s[4:7], s18 offen offset:0 sc1
    buffer_load_dwordx4 v[48:51], v10, s[4:7], s19 offen offset:0 sc1
    buffer_load_dwordx4 v[12:15], v10, s[4:7], s16 offen offset:1024 sc1
    buffer_load_dwordx4 v[32:35], v10, s[4:7], s17 offen offset:1024 sc1
    buffer_load_dwordx4 v[52:55], v10, s[4:7], s18 offen offset:1024 sc1
    buffer_load_dwordx4 v[56:59], v10, s[4:7], s19 offen offset:1024 sc1
    s_add_u32 s29, s29, 1
    s_cmp_gt_u32 s29, 0x40000
    s_cbranch_scc0 L_r8p1
    s_branch L_chain_fail
L_rb1:
    s_add_u32 s69, s69, 0x10000
    s_mov_b32 s29, 0
    s_mov_b32 s31, m0
L_rbl1:
    v_min_u32 v63, s87, v2
    v_lshlrev_b32 v63, 3, v63
    buffer_load_dword v61, v63, s[4:7], s67 offen sc1
    s_mov_b32 m0, s53
    s_add_u32 s30, s21, 4096
    buffer_load_dwordx4 v2, s[4:7], s21 offen offset:0 sc1 lds
    buffer_load_dwordx4 v2, s[4:7], s21 offen offset:1024 sc1 lds
    buffer_load_dwordx4 v2, s[4:7], s21 offen offset:2048 sc1 lds
    buffer_load_dwordx4 v2, s[4:7], s21 offen offset:3072 sc1 lds
    s_add_u32 m0, s53, 4096
    s_nop 0
    buffer_load_dwordx4 v2, s[4:7], s30 offen sc1 lds
    s_add_u32 s69, s69, 0x1000000
    s_add_u32 s29, s29, 1
    s_cmp_gt_u32 s29, 0x40000
    s_cbranch_scc1 L_chain_fail
    s_waitcnt vmcnt(0)
    v_and_b32 v63, 1, v61
    v_cmp_ne_u32 vcc, 1, v63
    s_cbranch_vccnz L_rbl1
    s_mov_b32 m0, s31
    s_branch L_rbk1
L_mx1:
    v_max3_f32 v32, v12, v13, v14
    v_max3_f32 v32, v32, v15, v16
    v_max3_f32 v32, v32, v17, v18
    v_max3_f32 v32, v32, v19, v60
    v_max3_f32 v32, v32, v61, v62
    v_max_f32 v32, v32, v63
    v_mov_b32 v33, v32
    s_nop 1
    v_permlane16_swap_b32 v32, v33
    v_max_f32 v32, v32, v33
    v_mov_b32 v33, v32
    s_nop 1
    v_permlane32_swap_b32 v32, v33
    v_max_f32 v32, v32, v33
    v_sub_f32 v12, v12, v32
    v_sub_f32 v13, v13, v32
    v_sub_f32 v14, v14, v32
    v_sub_f32 v15, v15, v32
    v_sub_f32 v16, v16, v32
    v_sub_f32 v17, v17, v32
    v_sub_f32 v18, v18, v32
    v_sub_f32 v19, v19, v32
    v_sub_f32 v60, v60, v32
    v_sub_f32 v61, v61, v32
    v_sub_f32 v62, v62, v32
    v_sub_f32 v63, v63, v32
    v_exp_f32 v20, v12
    v_exp_f32 v21, v13
    v_exp_f32 v22, v14
    v_exp_f32 v23, v15
    v_exp_f32 v24, v16
    v_exp_f32 v25, v17
    v_exp_f32 v26, v18
    v_exp_f32 v27, v19
    v_cvt_pk_bf16_f32 v20, v20, v21
    v_cvt_pk_bf16_f32 v21, v22, v23
    v_cvt_pk_bf16_f32 v22, v24, v25
    v_cvt_pk_bf16_f32 v23, v26, v27
    s_branch L_mxk1
L_redo0:
    s_waitcnt vmcnt(0) lgkmcnt(0)
    s_barrier
    s_add_u32 s85, s85, 1
    s_cmp_gt_u32 s85, 0x4000
    s_cbranch_scc1 L_chain_fail
    s_sub_u32 s14, s14, 1
    s_sub_u32 s56, s56, 9216
    s_mov_b32 s29, 0
    s_mov_b32 s70, 0xf0000000
    s_mov_b32 s83, 0xf0000000
    s_branch L_mre1
L_rgot1:
    v_permlane32_swap_b32 v24, v26
    v_permlane32_swap_b32 v25, v27
    v_add_f32 v24, v24, v26
    v_add_f32 v25, v25, v27
    v_cvt_pk_bf16_f32 v24, v24, v25
    v_mov_b32 v25, v24
    s_add_u32 s68, s68, s29
    s_mov_b32 s29, 0
    v_permlane32_swap_b32 v24, v25
    v_and_b32 v24, -2, v24
    s_mov_b64 exec, s[24:25]
    buffer_store_dwordx2 v[24:25], v9, s[4:7], s22 offen
    s_mov_b64 exec, -1
L_mre1:
    v_mov_b32 v20, 0
    v_mov_b32 v21, 0
    v_mov_b32 v22, 0
    v_mov_b32 v23, 0
    v_mov_b32 v28, 0
    v_mov_b32 v29, 0
    v_mov_b32 v30, 0
    v_mov_b32 v31, 0
    v_mov_b32 v60, 0
    v_mov_b32 v61, 0
    v_and_b32 v62, 0x1f0, v2
    v_lshlrev_b32 v62, 3, v62
    s_cmp_eq_u32 s13, 0
    s_cbranch_scc1 L_ma1
    s_waitcnt vmcnt(1)
    v_add_u32 v44, s71, v2
    v_mov_b32 v52, 0
    v_mov_b32 v53, 0
    v_mov_b32 v54, 0
    v_mov_b32 v55, 0
    v_mov_b32 v56, 0
    v_mov_b32 v57, 0
    v_mov_b32 v58, 0
    v_mov_b32 v59, 0
    ds_read_b128 v[44:47], v44
    v_lshrrev_b32 v50, 1, v2
    v_and_b32 v51, 0x100, v50
    v_lshrrev_b32 v51, 2, v51
    v_add3_u32 v51, v51, v50, s84
    ds_read_b64 v[48:49], v51
    v_mov_b32 v51, s14
    v_min_u32 v18, s87, v2
    v_lshlrev_b32 v18, 3, v18
    s_cmp_eq_u32 s13, 1
    s_cbranch_scc1 L_mb1
    s_add_u32 s30, s14, 3
    s_and_b32 s31, s30, 7
    s_lshl_b32 s58, s13, 3
    s_add_u32 s31, s31, s58
    s_cmp_eq_u32 s31, 24
    s_cbranch_scc0 L_nk1
    s_cmp_lt_u32 s30, 64
    s_cbranch_scc0 L_nk1
    s_mul_i32 s30, s30, 1536
    s_add_u32 s30, s30, 117785600
    v_subrev_u32 v13, 131072, v2
    v_lshlrev_b32 v13, 2, v13
    s_mov_b32 s31, 0
Lkv_4:
    buffer_load_dword v12, v13, s[4:7], s30 offen sc1
    s_add_u32 s31, s31, 1
    s_cmp_gt_u32 s31, 0x40000
    s_cbranch_scc1 L_chain_fail
    s_waitcnt vmcnt(0)
    v_cmp_ne_u32 vcc, 1, v12
    s_cbranch_vccz Lkv_4_ok
    s_sleep 4
    s_branch Lkv_4
Lkv_4_ok:
L_nk1:
    s_waitcnt vmcnt(0)
    s_branch L_next1
L_mb1:
    s_nop 15
    s_nop 15
    s_nop 15
    s_nop 15
    s_nop 15
    s_nop 7
    buffer_load_dword v61, v18, s[4:7], s67 offen sc1
    s_mov_b32 m0, s53
    s_add_u32 s30, s21, 4096
    buffer_load_dwordx4 v2, s[4:7], s21 offen offset:0 sc1 lds
    buffer_load_dwordx4 v2, s[4:7], s21 offen offset:1024 sc1 lds
    buffer_load_dwordx4 v2, s[4:7], s21 offen offset:2048 sc1 lds
    buffer_load_dwordx4 v2, s[4:7], s21 offen offset:3072 sc1 lds
    s_add_u32 m0, s53, 4096
    s_nop 0
    buffer_load_dwordx4 v2, s[4:7], s30 offen sc1 lds
    s_branch L_next1
L_ma1:
    s_waitcnt vmcnt(1)
    v_add_u32 v44, s71, v2
    v_mov_b32 v52, 0
    v_mov_b32 v53, 0
    v_mov_b32 v54, 0
    v_mov_b32 v55, 0
    v_mov_b32 v56, 0
    v_mov_b32 v57, 0
    v_mov_b32 v58, 0
    v_mov_b32 v59, 0
    ds_read_b128 v[44:47], v44
    v_lshrrev_b32 v50, 1, v2
    v_and_b32 v51, 0x100, v50
    v_lshrrev_b32 v51, 2, v51
    v_add3_u32 v51, v51, v50, s84
    ds_read_b64 v[48:49], v51
    v_mov_b32 v51, s14
    v_min_u32 v18, s87, v2
    v_lshlrev_b32 v18, 3, v18
    s_nop 15
    s_nop 15
    s_nop 15
    s_nop 7
    buffer_load_dword v61, v18, s[4:7], s67 offen sc1
    s_mov_b32 m0, s53
    s_add_u32 s30, s21, 4096
    buffer_load_dwordx4 v2, s[4:7], s21 offen offset:0 sc1 lds
    buffer_load_dwordx4 v2, s[4:7], s21 offen offset:1024 sc1 lds
    buffer_load_dwordx4 v2, s[4:7], s21 offen offset:2048 sc1 lds
    buffer_load_dwordx4 v2, s[4:7], s21 offen offset:3072 sc1 lds
    s_waitcnt vmcnt(4)
    v_and_b32 v16, 1, v61
    v_cmp_ne_u32 vcc, 0, v16
    s_cbranch_vccz L_mgot1
    s_add_u32 s69, s69, 1
L_mloop1:
    buffer_load_dword v12, v18, s[4:7], s67 offen sc1
    s_waitcnt vmcnt(0)
    v_and_b32 v16, 1, v12
    v_cmp_ne_u32 vcc, 0, v16
    s_cbranch_vccz L_msee1
    s_add_u32 s29, s29, 1
    s_cmp_gt_u32 s29, 0x40000
    s_cbranch_scc0 L_mloop1
    s_branch L_chain_fail
L_msee1:
    buffer_load_dword v61, v18, s[4:7], s67 offen sc1
    s_mov_b32 m0, s53
    s_add_u32 s30, s21, 4096
    buffer_load_dwordx4 v2, s[4:7], s21 offen offset:0 sc1 lds
    buffer_load_dwordx4 v2, s[4:7], s21 offen offset:1024 sc1 lds
    buffer_load_dwordx4 v2, s[4:7], s21 offen offset:2048 sc1 lds
    buffer_load_dwordx4 v2, s[4:7], s21 offen offset:3072 sc1 lds
L_mgot1:
    s_waitcnt vmcnt(0)
L_next1:
    s_add_u32 s14, s14, 1
    s_add_u32 s56, s56, 9216
    s_waitcnt lgkmcnt(0)
    s_branch L_step
L_chain_last:
    v_add_u32 v44, s71, v2
    ds_read_b128 v[44:47], v44
    v_lshrrev_b32 v50, 1, v2
    v_and_b32 v51, 0x100, v50
    v_lshrrev_b32 v51, 2, v51
    v_add3_u32 v51, v51, v50, s84
    ds_read_b64 v[48:49], v51
    v_mov_b32 v51, s14
    s_waitcnt lgkmcnt(0)
    buffer_store_dwordx4 v[44:47], v2, s[4:7], s52 offen sc1
    buffer_store_dwordx2 v[48:49], v50, s[4:7], s51 offen sc1
    s_waitcnt vmcnt(0)
    s_barrier
    v_mov_b32 v44, 64
    s_cmp_eq_u32 s13, 3
    s_cbranch_scc0 L_chain_done
    s_mov_b64 exec, 1
    buffer_store_dword v44, off, s[4:7], s15 sc1
    s_waitcnt vmcnt(0)
    s_branch L_chain_done
L_stepsc1:
L_b1sc10:
    s_barrier
    ds_read_b128 v[12:15], v2 offset:0
    s_mov_b32 m0, s66
    ds_read_b128 v[16:19], v2 offset:1024
    ds_read_b128 v[32:35], v11 offset:1024
    s_waitcnt lgkmcnt(2)
    v_smfmac_f32_16x16x64_bf16 v[56:59], v[12:15], v[152:159], v0
    v_smfmac_f32_16x16x64_bf16 v[28:31], v[12:15], a[224:231], v0
    s_waitcnt lgkmcnt(1)
    v_smfmac_f32_16x16x64_bf16 v[52:55], v[16:19], v[160:167], v0
    ds_read_b128 v[24:27], v11 offset:0
    v_smfmac_f32_16x16x64_bf16 v[52:55], v[12:15], v[144:151], v0
    ds_read_b128 v[40:43], v1 offset:9216
    v_smfmac_f32_16x16x64_bf16 v[20:23], v[12:15], a[96:103], v0
    ds_read_b128 v[36:39], v1 offset:8192
    v_bitop3_b32 v60, v60, v12, v14 bitop3:0xfe
    v_smfmac_f32_16x16x64_bf16 v[56:59], v[16:19], v[168:175], v0
    ds_read_b128 v[12:15], v2 offset:2048
    s_waitcnt lgkmcnt(3)
    v_smfmac_f32_16x16x64_bf16 v[28:31], v[24:27], a[232:239], v0
    buffer_load_dwordx4 v2, s[4:7], s50 offen sc1 lds
    v_smfmac_f32_16x16x64_bf16 v[20:23], v[24:27], a[104:111], v0
    ds_read_b128 v[24:27], v11 offset:2048
    v_smfmac_f32_16x16x64_bf16 v[20:23], v[16:19], a[112:119], v0
    buffer_load_dwordx4 v2, s[4:7], s50 offen offset:1024 sc1 lds
    v_smfmac_f32_16x16x64_bf16 v[28:31], v[32:35], a[248:255], v0
    s_waitcnt lgkmcnt(1)
    v_bitop3_b32 v60, v60, v16, v18 bitop3:0xfe
    v_smfmac_f32_16x16x64_bf16 v[52:55], v[12:15], v[36:43], v0
    buffer_store_dwordx4 v[44:47], v2, s[4:7], s70 offen sc1
    ds_read_b128 v[40:43], v1 offset:13312
    ds_read_b128 v[36:39], v1 offset:12288
    v_bitop3_b32 v60, v60, v12, v14 bitop3:0xfe
    v_smfmac_f32_16x16x64_bf16 v[28:31], v[16:19], a[240:247], v0
    ds_read_b128 v[16:19], v2 offset:3072
    v_smfmac_f32_16x16x64_bf16 v[20:23], v[12:15], a[128:135], v0
    ds_read_b128 v[44:47], v1 offset:10240
    buffer_store_dwordx2 v[48:49], v50, s[4:7], s83 offen sc1
    ds_read_b128 v[48:51], v1 offset:11264
    v_smfmac_f32_16x16x64_bf16 v[28:31], v[12:15], v[64:71], v0
    v_smfmac_f32_16x16x64_bf16 v[20:23], v[32:35], a[120:127], v0
    ds_read_b128 v[32:35], v11 offset:3072
    s_waitcnt lgkmcnt(6)
    v_smfmac_f32_16x16x64_bf16 v[28:31], v[24:27], v[72:79], v0
    s_waitcnt lgkmcnt(1)
    v_smfmac_f32_16x16x64_bf16 v[56:59], v[12:15], v[44:51], v0
    ds_read_b128 v[48:51], v1 offset:15360
    ds_read_b128 v[44:47], v1 offset:14336
    v_smfmac_f32_16x16x64_bf16 v[20:23], v[24:27], a[136:143], v0
    v_smfmac_f32_16x16x64_bf16 v[52:55], v[16:19], v[36:43], v0
    s_waitcnt lgkmcnt(0)
    v_smfmac_f32_16x16x64_bf16 v[56:59], v[16:19], v[44:51], v0
    s_waitcnt vmcnt(4)
    ds_read_b128 v[44:47], v1 offset:30720
    v_and_b32 v63, 1, v61
    v_cmp_ne_u32 vcc, 0, v63
    v_smfmac_f32_16x16x64_bf16 v[20:23], v[16:19], a[144:151], v0
    ds_read_b128 v[36:39], v1 offset:28672
    ds_read_b128 v[40:43], v1 offset:29696
    v_smfmac_f32_16x16x64_bf16 v[28:31], v[16:19], v[80:87], v0
    s_cbranch_vccnz L_rbsc10
L_rbksc10:
    s_barrier
    ds_read_b128 v[12:15], v2 offset:4096
    ds_read_b128 v[48:51], v1 offset:31744
    v_smfmac_f32_16x16x64_bf16 v[20:23], v[32:35], a[152:159], v0
    ds_read_b128 v[24:27], v11 offset:4096
    v_bitop3_b32 v60, v60, v16, v18 bitop3:0xfe
    v_smfmac_f32_16x16x64_bf16 v[28:31], v[32:35], v[88:95], v0
    ds_read_b128 v[32:35], v11 offset:5120
    s_waitcnt lgkmcnt(3)
    v_smfmac_f32_16x16x64_bf16 v[20:23], v[12:15], a[160:167], v0
    ds_read_b128 v[16:19], v2 offset:5120
    v_smfmac_f32_16x16x64_bf16 v[28:31], v[12:15], v[96:103], v0
    s_mov_b32 m0, 161344
    ds_read_b128 v[12:15], v2 offset:6144
    s_waitcnt lgkmcnt(3)
    v_smfmac_f32_16x16x64_bf16 v[28:31], v[24:27], v[104:111], v0
    v_smfmac_f32_16x16x64_bf16 v[20:23], v[24:27], a[168:175], v0
    ds_read_b128 v[24:27], v11 offset:6144
    s_waitcnt lgkmcnt(2)
    v_smfmac_f32_16x16x64_bf16 v[20:23], v[16:19], v[36:43], v0
    ds_read_b128 v[40:43], v1 offset:1024
    v_smfmac_f32_16x16x64_bf16 v[28:31], v[16:19], v[112:119], v0
    ds_read_b128 v[36:39], v1 offset:0
    v_smfmac_f32_16x16x64_bf16 v[20:23], v[32:35], v[44:51], v0
    ds_read_b128 v[44:47], v1 offset:2048
    v_smfmac_f32_16x16x64_bf16 v[28:31], v[32:35], v[120:127], v0
    s_waitcnt lgkmcnt(4)
    ds_read_b128 v[48:51], v1 offset:3072
    ds_read_b128 v[16:19], v2 offset:7168
    v_bitop3_b32 v60, v60, v12, v14 bitop3:0xfe
    v_smfmac_f32_16x16x64_bf16 v[20:23], v[12:15], a[176:183], v0
    ds_read_b128 v[32:35], v11 offset:7168
    s_waitcnt lgkmcnt(4)
    v_smfmac_f32_16x16x64_bf16 v[28:31], v[12:15], v[36:43], v0
    ds_read_b128 v[36:39], v1 offset:4096
    buffer_load_dword v62, s[4:7], s64 offen sc1 lds
    v_smfmac_f32_16x16x64_bf16 v[20:23], v[24:27], a[184:191], v0
    ds_read_b128 v[40:43], v1 offset:5120
    s_waitcnt lgkmcnt(4)
    v_smfmac_f32_16x16x64_bf16 v[28:31], v[24:27], v[44:51], v0
    s_waitcnt lgkmcnt(3)
    v_smfmac_f32_16x16x64_bf16 v[20:23], v[16:19], a[192:199], v0
    ds_read_b128 v[12:15], v2 offset:8192
    ds_read_b128 v[44:47], v1 offset:6144
    v_smfmac_f32_16x16x64_bf16 v[28:31], v[16:19], v[128:135], v0
    s_waitcnt lgkmcnt(4)
    v_bitop3_b32 v60, v60, v16, v18 bitop3:0xfe
    v_smfmac_f32_16x16x64_bf16 v[20:23], v[32:35], a[200:207], v0
    ds_read_b128 v[24:27], v11 offset:8192
    ds_read_b128 v[16:19], v2 offset:4096
    v_smfmac_f32_16x16x64_bf16 v[28:31], v[32:35], v[136:143], v0
    s_waitcnt lgkmcnt(3)
    v_smfmac_f32_16x16x64_bf16 v[28:31], v[12:15], v[36:43], v0
    ds_read_b128 v[48:51], v1 offset:7168
    v_bitop3_b32 v60, v60, v12, v14 bitop3:0xfe
    v_smfmac_f32_16x16x64_bf16 v[20:23], v[12:15], a[208:215], v0
    ds_read_b128 v[12:15], v2 offset:5120
    s_waitcnt lgkmcnt(3)
    v_smfmac_f32_16x16x64_bf16 v[20:23], v[24:27], a[216:223], v0
    s_waitcnt lgkmcnt(2)
    v_smfmac_f32_16x16x64_bf16 v[52:55], v[16:19], v[176:183], v0
    ds_read_b128 v[36:39], v2 offset:9216
    v_bitop3_b32 v60, v60, v16, v18 bitop3:0xfe
    v_smfmac_f32_16x16x64_bf16 v[56:59], v[16:19], v[184:191], v0
    ds_read_b128 v[40:43], v2 offset:10240
    s_waitcnt lgkmcnt(2)
    v_mul_f32 v20, s28, v20
    v_bitop3_b32 v60, v60, v12, v14 bitop3:0xfe
    v_smfmac_f32_16x16x64_bf16 v[28:31], v[24:27], v[44:51], v0
    ds_read_b128 v[44:47], v2 offset:11264
    v_mul_f32 v21, s28, v21
    v_smfmac_f32_16x16x64_bf16 v[52:55], v[12:15], v[192:199], v0
    ds_read_b128 v[16:19], v2 offset:6144
    v_mul_f32 v23, s28, v23
    v_mul_f32 v22, s28, v22
    v_cvt_pk_bf16_f32 v20, v20, v21
    v_cvt_pk_bf16_f32 v21, v22, v23
    v_smfmac_f32_16x16x64_bf16 v[56:59], v[12:15], v[200:207], v0
    ds_read_b128 v[12:15], v2 offset:7168
    ds_write2_b32 v4, v20, v21 offset0:0 offset1:80
    v_cvt_pk_bf16_f32 v28, v28, v29
    v_cvt_pk_bf16_f32 v29, v30, v31
    s_waitcnt lgkmcnt(2)
    v_smfmac_f32_16x16x64_bf16 v[56:59], v[16:19], v[216:223], v0
    ds_write2_b32 v4, v28, v29 offset0:144 offset1:224
    v_and_b32 v60, 1, v60
    v_smfmac_f32_16x16x64_bf16 v[52:55], v[16:19], v[208:215], v0
    ds_read_b128 v[16:19], v2 offset:8192
    s_waitcnt lgkmcnt(3)
    v_cmp_ne_u32 vcc, 0, v60
    v_smfmac_f32_16x16x64_bf16 v[52:55], v[12:15], v[224:231], v0
    v_smfmac_f32_16x16x64_bf16 v[56:59], v[12:15], v[232:239], v0
    s_cbranch_vccz L_oksc10
    s_cmp_eq_u32 s14, 0
    s_cbranch_scc1 L_oksc10
    s_branch L_redosc10
L_oksc10:
    s_waitcnt lgkmcnt(0)
    s_barrier
    ds_read_b64_tr_b16 v[20:21], v5 offset:21504
    ds_read_b64_tr_b16 v[22:23], v5 offset:21520
    v_smfmac_f32_16x16x64_bf16 v[52:55], v[16:19], v[240:247], v0
    ds_read_b64_tr_b16 v[24:25], v5 offset:22664
    s_add_u32 s50, s50, 262144
    ds_read_b128 v[48:51], v2 offset:12288
    v_smfmac_f32_16x16x64_bf16 v[56:59], v[16:19], v[248:255], v0
    ds_read_b64_tr_b16 v[26:27], v5 offset:22680
    ds_read_b64_tr_b16 v[32:33], v5 offset:23824
    ds_read_b64_tr_b16 v[28:29], v5 offset:24984
    s_waitcnt lgkmcnt(5)
    v_mfma_f32_16x16x32_bf16 v[12:15], v[36:39], v[20:23], 0
    ds_read_b64_tr_b16 v[34:35], v5 offset:23840
    ds_read_b128 v[36:39], v2 offset:13312
    v_mfma_f32_16x16x32_bf16 v[16:19], v[40:43], v[20:23], 0
    ds_read_b128 v[40:43], v2 offset:14336
    s_waitcnt lgkmcnt(5)
    v_mfma_f32_16x16x32_bf16 v[12:15], v[44:47], v[24:27], v[12:15]
    ds_read_b128 v[44:47], v2 offset:15360
    v_mfma_f32_16x16x32_bf16 v[16:19], v[48:51], v[24:27], v[16:19]
    ds_read_b64_tr_b16 v[30:31], v5 offset:25000
    ds_read_b128 v[48:51], v2 offset:16384
    s_waitcnt lgkmcnt(4)
    v_mfma_f32_16x16x32_bf16 v[12:15], v[36:39], v[32:35], v[12:15]
    s_add_u32 s64, s64, 262144
    ds_read_b64_tr_b16 v[36:37], v6 offset:0
    v_cvt_pk_bf16_f32 v52, v52, v56
    v_cvt_pk_bf16_f32 v56, v54, v58
    s_waitcnt lgkmcnt(4)
    v_mfma_f32_16x16x32_bf16 v[16:19], v[40:43], v[32:35], v[16:19]
    ds_read_b64_tr_b16 v[42:43], v6 offset:1176
    ds_read_b64_tr_b16 v[40:41], v6 offset:1160
    s_waitcnt lgkmcnt(4)
    v_cvt_pk_bf16_f32 v53, v53, v57
    v_mfma_f32_16x16x32_bf16 v[12:15], v[44:47], v[28:31], v[12:15]
    ds_read_b64_tr_b16 v[38:39], v6 offset:16
    ds_read_b64_tr_b16 v[44:45], v6 offset:2320
    s_waitcnt lgkmcnt(5)
    v_mov_b32 v54, 0
    v_mfma_f32_16x16x32_bf16 v[16:19], v[48:51], v[28:31], v[16:19]
    ds_read_b64_tr_b16 v[48:49], v6 offset:3480
    ds_read_b64_tr_b16 v[50:51], v6 offset:3496
    ds_read_b64_tr_b16 v[46:47], v6 offset:2336
    v_cvt_pk_bf16_f32 v57, v55, v59
    v_mov_b32 v59, 0
    v_mov_b32 v58, 0
    s_waitcnt lgkmcnt(4)
    v_mfma_f32_16x16x32_bf16 v[60:63], v[36:39], v[20:23], 0
    s_waitcnt vmcnt(3)
    ds_read2st64_b32 v[38:39], v8 offset0:2 offset1:3
    v_mov_b32 v55, 0
    v_mfma_f32_16x16x32_bf16 v[60:63], v[40:43], v[24:27], v[60:63]
    ds_read2st64_b32 v[40:41], v8 offset0:4 offset1:5
    s_waitcnt lgkmcnt(2)
    v_exp_f32 v20, v12
    v_mfma_f32_16x16x32_bf16 v[60:63], v[44:47], v[32:35], v[60:63]
    ds_read_b128 v[44:47], v2 offset:30720
    ds_read2st64_b32 v[42:43], v8 offset0:6 offset1:7
    v_exp_f32 v21, v13
    v_mfma_f32_16x16x32_bf16 v[60:63], v[48:51], v[28:31], v[60:63]
    ds_read_b128 v[28:31], v2 offset:31744
    ds_read2st64_b32 v[36:37], v8 offset0:0 offset1:1
    ds_read_b128 v[48:51], v2 offset:31744
    v_exp_f32 v22, v14
    v_max3_f32 v32, |v12|, |v13|, |v14|
    v_max3_f32 v32, v32, |v15|, |v16|
    v_cvt_pk_bf16_f32 v20, v20, v21
    v_max3_f32 v32, v32, |v17|, |v18|
    v_max3_f32 v33, |v61|, |v62|, |v63|
    v_exp_f32 v23, v15
    v_exp_f32 v24, v16
    v_exp_f32 v25, v17
    v_exp_f32 v27, v19
    v_max3_f32 v32, v32, |v19|, |v60|
    v_max_f32 v33, v32, v33
    v_cmp_nge_f32 vcc, 0x42800000, v33
    v_exp_f32 v26, v18
    v_cvt_pk_bf16_f32 v21, v22, v23
    v_cvt_pk_bf16_f32 v22, v24, v25
    v_cvt_pk_bf16_f32 v23, v26, v27
    s_cbranch_vccnz L_mxsc10
L_mxksc10:
    v_exp_f32 v60, v60
    s_waitcnt lgkmcnt(1)
    v_smfmac_f32_16x16x64_bf16 v[28:31], v[20:23], v[36:43], v0
    ds_read_b128 v[32:35], v2 offset:31744
    v_exp_f32 v61, v61
    v_exp_f32 v62, v62
    v_exp_f32 v63, v63
    v_mfma_f32_16x16x32_bf16 v[16:19], v[20:23], v[44:47], 0
    s_waitcnt lgkmcnt(1)
    v_cvt_pk_bf16_f32 v50, v62, v63
    v_cvt_pk_bf16_f32 v48, v60, v61
    v_mfma_f32_16x16x32_bf16 v[16:19], v[20:23], v[44:47], v[16:19]
    ds_read_b128 v[12:15], v2 offset:31744
    ds_read_b128 v[20:23], v1 offset:24576
    v_mfma_f32_16x16x32_bf16 v[16:19], v[48:51], v[44:47], v[16:19]
    v_smfmac_f32_16x16x64_bf16 v[28:31], v[48:51], v[52:59], v0
    ds_read_b128 v[24:27], v1 offset:25600
    ds_read_b128 v[60:63], v2 offset:31744
    ds_write2st64_b32 v8, v52, v53 offset0:0 offset1:1
    v_subrev_u32 v44, 21504, v4
    s_nop 0
    v_rcp_f32 v17, v17
    v_rcp_f32 v18, v18
    v_rcp_f32 v16, v16
    v_rcp_f32 v19, v19
    v_mul_f32 v30, v30, v18
    v_mul_f32 v28, v28, v16
    v_mul_f32 v29, v29, v17
    v_cvt_pk_bf16_f32 v28, v28, v29
    v_mul_f32 v31, v31, v19
    v_cvt_pk_bf16_f32 v29, v30, v31
    ds_write2_b32 v44, v28, v29 offset0:0 offset1:80
    ds_write2st64_b32 v8, v56, v57 offset0:2 offset1:3
    v_mov_b32 v28, 0
    v_mov_b32 v31, 0
    s_mov_b32 m0, s65
    ds_read_b128 v[16:19], v2 offset:31744
    v_mov_b32 v30, 0
    ds_read_b128 v[56:59], v1 offset:27648
    v_mov_b32 v29, 0
    s_waitcnt lgkmcnt(2)
    s_barrier
    ds_read_b64_tr_b16 v[36:37], v7 offset:0
    ds_read_b64_tr_b16 v[38:39], v7 offset:16
    ds_read_b64_tr_b16 v[42:43], v7 offset:1176
    ds_read_b64_tr_b16 v[40:41], v7 offset:1160
    ds_read_b64_tr_b16 v[46:47], v3 offset:16
    ds_read_b64_tr_b16 v[48:49], v3 offset:1160
    ds_read_b64_tr_b16 v[44:45], v3 offset:0
    s_waitcnt lgkmcnt(5)
    v_smfmac_f32_16x16x64_bf16 v[12:15], v[36:39], a[0:7], v0
    ds_read_b64_tr_b16 v[50:51], v3 offset:1176
    s_waitcnt lgkmcnt(4)
    v_smfmac_f32_16x16x64_bf16 v[12:15], v[40:43], a[16:23], v0
    buffer_load_dwordx4 v2, s[4:7], s49 offen offset:0 sc1 lds
    s_waitcnt lgkmcnt(1)
    v_smfmac_f32_16x16x64_bf16 v[12:15], v[44:47], a[32:39], v0
    s_waitcnt lgkmcnt(0)
    v_smfmac_f32_16x16x64_bf16 v[12:15], v[48:51], a[48:55], v0
    v_smfmac_f32_16x16x64_bf16 v[32:35], v[36:39], a[8:15], v0
    buffer_load_dwordx4 v2, s[4:7], s49 offen offset:1024 sc1 lds
    v_smfmac_f32_16x16x64_bf16 v[32:35], v[40:43], a[24:31], v0
    s_add_u32 s49, s49, 262144
    ds_read_b128 v[52:55], v1 offset:26624
    v_cvt_pk_bf16_f32 v12, v12, v13
    v_cvt_pk_bf16_f32 v13, v14, v15
    v_or_b32 v12, 1, v12
    v_smfmac_f32_16x16x64_bf16 v[32:35], v[44:47], a[40:47], v0
    buffer_store_dwordx2 v[12:13], v9, s[4:7], s20 offen offset:0 sc1
    v_smfmac_f32_16x16x64_bf16 v[32:35], v[48:51], a[56:63], v0
    v_smfmac_f32_16x16x64_bf16 v[60:63], v[36:39], v[20:27], v0
    ds_read_b128 v[20:23], v1 offset:16384
    ds_read_b128 v[24:27], v1 offset:17408
    s_waitcnt lgkmcnt(2)
    v_smfmac_f32_16x16x64_bf16 v[60:63], v[40:43], v[52:59], v0
    ds_read_b128 v[56:59], v1 offset:21504
    ds_read_b128 v[52:55], v1 offset:20480
    v_cvt_pk_bf16_f32 v32, v32, v33
    v_or_b32 v32, 1, v32
    v_cvt_pk_bf16_f32 v33, v34, v35
    v_smfmac_f32_16x16x64_bf16 v[28:31], v[36:39], a[64:71], v0
    buffer_store_dwordx2 v[32:33], v9, s[4:7], s20 offen offset:512 sc1
    v_smfmac_f32_16x16x64_bf16 v[28:31], v[44:47], a[80:87], v0
    s_waitcnt lgkmcnt(2)
    v_cvt_pk_bf16_f32 v60, v60, v61
    v_smfmac_f32_16x16x64_bf16 v[28:31], v[40:43], v[20:27], v0
    ds_read_b128 v[20:23], v1 offset:18432
    ds_read_b128 v[24:27], v1 offset:19456
    v_or_b32 v60, 1, v60
    v_cvt_pk_bf16_f32 v61, v62, v63
    s_waitcnt lgkmcnt(2)
    v_smfmac_f32_16x16x64_bf16 v[28:31], v[48:51], v[52:59], v0
    s_mov_b32 s29, 0
    ds_read_b128 v[56:59], v1 offset:23552
    ds_read_b128 v[52:55], v1 offset:22528
    v_smfmac_f32_16x16x64_bf16 v[16:19], v[36:39], a[72:79], v0
    buffer_store_dwordx2 v[60:61], v9, s[4:7], s3 offen offset:0 sc1
    v_smfmac_f32_16x16x64_bf16 v[16:19], v[44:47], a[88:95], v0
    s_waitcnt lgkmcnt(2)
    s_nop 0
    v_cvt_pk_bf16_f32 v28, v28, v29
    v_smfmac_f32_16x16x64_bf16 v[16:19], v[40:43], v[20:27], v0
    s_mov_b32 s70, s52
    v_cvt_pk_bf16_f32 v29, v30, v31
    v_or_b32 v28, 1, v28
    s_waitcnt lgkmcnt(0)
    v_smfmac_f32_16x16x64_bf16 v[16:19], v[48:51], v[52:59], v0
    s_mov_b32 s83, s51
    buffer_store_dwordx2 v[28:29], v9, s[4:7], s20 offen offset:1024 sc1
    s_add_u32 s52, s52, 131072
    s_nop 4
    v_cvt_pk_bf16_f32 v16, v16, v17
    v_or_b32 v16, 1, v16
    v_cvt_pk_bf16_f32 v17, v18, v19
    s_add_u32 s51, s51, 65536
    buffer_store_dwordx2 v[16:17], v9, s[4:7], s20 offen offset:1536 sc1
    s_cmp_eq_u32 s13, 0
    s_cbranch_scc0 L_nw0sc10
    s_nop 15
    buffer_load_dwordx4 v[36:39], v10, s[4:7], s16 offen offset:0 sc1
    buffer_load_dwordx4 v[40:43], v10, s[4:7], s17 offen offset:0 sc1
    buffer_load_dwordx4 v[44:47], v10, s[4:7], s18 offen offset:0 sc1
    buffer_load_dwordx4 v[48:51], v10, s[4:7], s19 offen offset:0 sc1
    v_mov_b32 v31, 0x3f80
    v_and_b32 v30, 16, v2
    v_lshlrev_b32 v30, v30, v31
    v_cndmask_b32 v20, 0, v30, s[72:73]
    v_cndmask_b32 v21, 0, v30, s[74:75]
    v_cndmask_b32 v22, 0, v30, s[76:77]
    v_cndmask_b32 v23, 0, v30, s[78:79]
    s_barrier
    s_branch L_rgosc10
L_nw0sc10:
    s_cmp_eq_u32 s23, 0
    s_cbranch_scc0 L_rd1sc10
    s_barrier
    s_branch L_mresc10
L_rd1sc10:
    v_mov_b32 v31, 0x3f80
    v_and_b32 v30, 16, v2
    v_lshlrev_b32 v30, v30, v31
    v_cndmask_b32 v20, 0, v30, s[72:73]
    v_cndmask_b32 v21, 0, v30, s[74:75]
    v_cndmask_b32 v22, 0, v30, s[76:77]
    v_cndmask_b32 v23, 0, v30, s[78:79]
    s_barrier
    s_cmp_eq_u32 s13, 2
    s_cbranch_scc1 L_r8sc10
    s_nop 15
    s_nop 15
    s_nop 7
    buffer_load_dwordx4 v[36:39], v10, s[4:7], s16 offen offset:0 sc1
    buffer_load_dwordx4 v[40:43], v10, s[4:7], s17 offen offset:0 sc1
    buffer_load_dwordx4 v[44:47], v10, s[4:7], s18 offen offset:0 sc1
    buffer_load_dwordx4 v[48:51], v10, s[4:7], s19 offen offset:0 sc1
L_rgosc10:
    s_nop 15
    s_nop 15
    s_nop 7
    buffer_load_dwordx4 v[12:15], v10, s[4:7], s16 offen offset:0 sc1
    buffer_load_dwordx4 v[32:35], v10, s[4:7], s17 offen offset:0 sc1
    buffer_load_dwordx4 v[52:55], v10, s[4:7], s18 offen offset:0 sc1
    buffer_load_dwordx4 v[56:59], v10, s[4:7], s19 offen offset:0 sc1
L_rpollsc10:
    s_waitcnt vmcnt(7)
    v_mfma_f32_16x16x32_bf16 v[24:27], v[36:39], v[20:23], 0
    v_bitop3_b32 v30, v36, v38, 1 bitop3:0x2a
    v_cmp_ne_u32 s[32:33], 0, v30
    s_waitcnt vmcnt(6)
    v_mfma_f32_16x16x32_bf16 v[24:27], v[40:43], v[20:23], v[24:27]
    v_bitop3_b32 v31, v40, v42, 1 bitop3:0x2a
    v_cmp_ne_u32 s[34:35], 0, v31
    s_waitcnt vmcnt(5)
    v_mfma_f32_16x16x32_bf16 v[24:27], v[44:47], v[20:23], v[24:27]
    v_bitop3_b32 v30, v44, v46, 1 bitop3:0x2a
    v_cmp_ne_u32 s[36:37], 0, v30
    s_waitcnt vmcnt(4)
    v_mfma_f32_16x16x32_bf16 v[24:27], v[48:51], v[20:23], v[24:27]
    v_bitop3_b32 v31, v48, v50, 1 bitop3:0x2a
    v_cmp_ne_u32 s[38:39], 0, v31
    s_or_b64 vcc, s[32:33], s[34:35]
    s_or_b64 vcc, vcc, s[36:37]
    s_or_b64 vcc, vcc, s[38:39]
    s_cbranch_scc0 L_rgotsc10
    s_mov_b64 exec, s[32:33]
    buffer_load_dwordx4 v[36:39], v10, s[4:7], s16 offen offset:0 sc1
    s_mov_b64 exec, s[34:35]
    buffer_load_dwordx4 v[40:43], v10, s[4:7], s17 offen offset:0 sc1
    s_mov_b64 exec, s[36:37]
    buffer_load_dwordx4 v[44:47], v10, s[4:7], s18 offen offset:0 sc1
    s_mov_b64 exec, s[38:39]
    buffer_load_dwordx4 v[48:51], v10, s[4:7], s19 offen offset:0 sc1
    s_mov_b64 exec, -1
    s_waitcnt vmcnt(7)
    v_mfma_f32_16x16x32_bf16 v[24:27], v[12:15], v[20:23], 0
    v_bitop3_b32 v30, v12, v14, 1 bitop3:0x2a
    v_cmp_ne_u32 s[40:41], 0, v30
    s_waitcnt vmcnt(6)
    v_mfma_f32_16x16x32_bf16 v[24:27], v[32:35], v[20:23], v[24:27]
    v_bitop3_b32 v31, v32, v34, 1 bitop3:0x2a
    v_cmp_ne_u32 s[42:43], 0, v31
    s_waitcnt vmcnt(5)
    v_mfma_f32_16x16x32_bf16 v[24:27], v[52:55], v[20:23], v[24:27]
    v_bitop3_b32 v30, v52, v54, 1 bitop3:0x2a
    v_cmp_ne_u32 s[44:45], 0, v30
    s_waitcnt vmcnt(4)
    v_mfma_f32_16x16x32_bf16 v[24:27], v[56:59], v[20:23], v[24:27]
    v_bitop3_b32 v31, v56, v58, 1 bitop3:0x2a
    v_cmp_ne_u32 s[46:47], 0, v31
    s_or_b64 vcc, s[40:41], s[42:43]
    s_or_b64 vcc, vcc, s[44:45]
    s_or_b64 vcc, vcc, s[46:47]
    s_cbranch_scc0 L_rgotsc10
    s_mov_b64 exec, s[40:41]
    buffer_load_dwordx4 v[12:15], v10, s[4:7], s16 offen offset:0 sc1
    s_mov_b64 exec, s[42:43]
    buffer_load_dwordx4 v[32:35], v10, s[4:7], s17 offen offset:0 sc1
    s_mov_b64 exec, s[44:45]
    buffer_load_dwordx4 v[52:55], v10, s[4:7], s18 offen offset:0 sc1
    s_mov_b64 exec, s[46:47]
    buffer_load_dwordx4 v[56:59], v10, s[4:7], s19 offen offset:0 sc1
    s_mov_b64 exec, -1
    s_add_u32 s29, s29, 1
    s_cmp_gt_u32 s29, 0x40000
    s_cbranch_scc0 L_rpollsc10
    s_branch L_chain_fail
L_r8sc10:
    s_nop 15
    buffer_load_dwordx4 v[36:39], v10, s[4:7], s16 offen offset:0 sc1
    buffer_load_dwordx4 v[40:43], v10, s[4:7], s17 offen offset:0 sc1
    buffer_load_dwordx4 v[44:47], v10, s[4:7], s18 offen offset:0 sc1
    buffer_load_dwordx4 v[48:51], v10, s[4:7], s19 offen offset:0 sc1
    buffer_load_dwordx4 v[12:15], v10, s[4:7], s16 offen offset:1024 sc1
    buffer_load_dwordx4 v[32:35], v10, s[4:7], s17 offen offset:1024 sc1
    buffer_load_dwordx4 v[52:55], v10, s[4:7], s18 offen offset:1024 sc1
    buffer_load_dwordx4 v[56:59], v10, s[4:7], s19 offen offset:1024 sc1
L_r8psc10:
    s_waitcnt vmcnt(7)
    v_mfma_f32_16x16x32_bf16 v[24:27], v[36:39], v[20:23], 0
    s_waitcnt vmcnt(6)
    v_bitop3_b32 v30, v36, v38, 1 bitop3:0x2a
    v_mfma_f32_16x16x32_bf16 v[24:27], v[40:43], v[20:23], v[24:27]
    v_bitop3_b32 v31, v40, v42, 1 bitop3:0x2a
    v_or3_b32 v63, v30, v31, 0
    s_waitcnt vmcnt(5)
    v_mfma_f32_16x16x32_bf16 v[24:27], v[44:47], v[20:23], v[24:27]
    s_waitcnt vmcnt(4)
    v_bitop3_b32 v30, v44, v46, 1 bitop3:0x2a
    v_mfma_f32_16x16x32_bf16 v[24:27], v[48:51], v[20:23], v[24:27]
    v_bitop3_b32 v31, v48, v50, 1 bitop3:0x2a
    v_or3_b32 v63, v30, v31, v63
    s_waitcnt vmcnt(3)
    v_mfma_f32_16x16x32_bf16 v[24:27], v[12:15], v[20:23], v[24:27]
    s_waitcnt vmcnt(2)
    v_bitop3_b32 v30, v12, v14, 1 bitop3:0x2a
    v_mfma_f32_16x16x32_bf16 v[24:27], v[32:35], v[20:23], v[24:27]
    v_bitop3_b32 v31, v32, v34, 1 bitop3:0x2a
    v_or3_b32 v63, v30, v31, v63
    s_waitcnt vmcnt(1)
    v_mfma_f32_16x16x32_bf16 v[24:27], v[52:55], v[20:23], v[24:27]
    s_waitcnt vmcnt(0)
    v_bitop3_b32 v30, v52, v54, 1 bitop3:0x2a
    v_mfma_f32_16x16x32_bf16 v[24:27], v[56:59], v[20:23], v[24:27]
    v_bitop3_b32 v31, v56, v58, 1 bitop3:0x2a
    v_or3_b32 v63, v30, v31, v63
    v_cmp_ne_u32 vcc, 0, v63
    s_cbranch_vccz L_rgotsc10
    buffer_load_dwordx4 v[36:39], v10, s[4:7], s16 offen offset:0 sc1
    buffer_load_dwordx4 v[40:43], v10, s[4:7], s17 offen offset:0 sc1
    buffer_load_dwordx4 v[44:47], v10, s[4:7], s18 offen offset:0 sc1
    buffer_load_dwordx4 v[48:51], v10, s[4:7], s19 offen offset:0 sc1
    buffer_load_dwordx4 v[12:15], v10, s[4:7], s16 offen offset:1024 sc1
    buffer_load_dwordx4 v[32:35], v10, s[4:7], s17 offen offset:1024 sc1
    buffer_load_dwordx4 v[52:55], v10, s[4:7], s18 offen offset:1024 sc1
    buffer_load_dwordx4 v[56:59], v10, s[4:7], s19 offen offset:1024 sc1
    s_add_u32 s29, s29, 1
    s_cmp_gt_u32 s29, 0x40000
    s_cbranch_scc0 L_r8psc10
    s_branch L_chain_fail
L_rbsc10:
    s_add_u32 s69, s69, 0x10000
    s_mov_b32 s29, 0
    s_mov_b32 s31, m0
L_rblsc10:
    v_min_u32 v63, s87, v2
    v_lshlrev_b32 v63, 3, v63
    buffer_load_dword v61, v63, s[4:7], s67 offen sc1
    s_mov_b32 m0, s53
    s_add_u32 s30, s21, 4096
    buffer_load_dwordx4 v2, s[4:7], s21 offen offset:0 sc1 lds
    buffer_load_dwordx4 v2, s[4:7], s21 offen offset:1024 sc1 lds
    buffer_load_dwordx4 v2, s[4:7], s21 offen offset:2048 sc1 lds
    buffer_load_dwordx4 v2, s[4:7], s21 offen offset:3072 sc1 lds
    s_add_u32 m0, s53, 4096
    s_nop 0
    buffer_load_dwordx4 v2, s[4:7], s30 offen sc1 lds
    s_add_u32 s69, s69, 0x1000000
    s_add_u32 s29, s29, 1
    s_cmp_gt_u32 s29, 0x40000
    s_cbranch_scc1 L_chain_fail
    s_waitcnt vmcnt(0)
    v_and_b32 v63, 1, v61
    v_cmp_ne_u32 vcc, 0, v63
    s_cbranch_vccnz L_rblsc10
    s_mov_b32 m0, s31
    s_branch L_rbksc10
L_mxsc10:
    v_max3_f32 v32, v12, v13, v14
    v_max3_f32 v32, v32, v15, v16
    v_max3_f32 v32, v32, v17, v18
    v_max3_f32 v32, v32, v19, v60
    v_max3_f32 v32, v32, v61, v62
    v_max_f32 v32, v32, v63
    v_mov_b32 v33, v32
    s_nop 1
    v_permlane16_swap_b32 v32, v33
    v_max_f32 v32, v32, v33
    v_mov_b32 v33, v32
    s_nop 1
    v_permlane32_swap_b32 v32, v33
    v_max_f32 v32, v32, v33
    v_sub_f32 v12, v12, v32
    v_sub_f32 v13, v13, v32
    v_sub_f32 v14, v14, v32
    v_sub_f32 v15, v15, v32
    v_sub_f32 v16, v16, v32
    v_sub_f32 v17, v17, v32
    v_sub_f32 v18, v18, v32
    v_sub_f32 v19, v19, v32
    v_sub_f32 v60, v60, v32
    v_sub_f32 v61, v61, v32
    v_sub_f32 v62, v62, v32
    v_sub_f32 v63, v63, v32
    v_exp_f32 v20, v12
    v_exp_f32 v21, v13
    v_exp_f32 v22, v14
    v_exp_f32 v23, v15
    v_exp_f32 v24, v16
    v_exp_f32 v25, v17
    v_exp_f32 v26, v18
    v_exp_f32 v27, v19
    v_cvt_pk_bf16_f32 v20, v20, v21
    v_cvt_pk_bf16_f32 v21, v22, v23
    v_cvt_pk_bf16_f32 v22, v24, v25
    v_cvt_pk_bf16_f32 v23, v26, v27
    s_branch L_mxksc10
L_redosc11:
    s_waitcnt vmcnt(0) lgkmcnt(0)
    s_barrier
    s_add_u32 s85, s85, 1
    s_cmp_gt_u32 s85, 0x4000
    s_cbranch_scc1 L_chain_fail
    s_sub_u32 s14, s14, 1
    s_sub_u32 s56, s56, 9216
    s_mov_b32 s29, 0
    s_mov_b32 s70, 0xf0000000
    s_mov_b32 s83, 0xf0000000
    s_branch L_mresc10
L_rgotsc10:
    v_permlane32_swap_b32 v24, v26
    v_permlane32_swap_b32 v25, v27
    v_add_f32 v24, v24, v26
    v_add_f32 v25, v25, v27
    v_cvt_pk_bf16_f32 v24, v24, v25
    v_mov_b32 v25, v24
    s_add_u32 s68, s68, s29
    s_mov_b32 s29, 0
    v_permlane32_swap_b32 v24, v25
    v_or_b32 v24, 1, v24
    s_mov_b64 exec, s[24:25]
    buffer_store_dwordx2 v[24:25], v9, s[4:7], s22 offen sc1
    s_mov_b64 exec, -1
L_mresc10:
    v_mov_b32 v20, 0
    v_mov_b32 v21, 0
    v_mov_b32 v22, 0
    v_mov_b32 v23, 0
    v_mov_b32 v28, 0
    v_mov_b32 v29, 0
    v_mov_b32 v30, 0
    v_mov_b32 v31, 0
    v_mov_b32 v60, -1
    v_mov_b32 v61, 1
    v_and_b32 v62, 0x1f0, v2
    v_lshlrev_b32 v62, 3, v62
    s_cmp_eq_u32 s13, 0
    s_cbranch_scc1 L_masc10
    s_waitcnt vmcnt(1)
    v_add_u32 v44, s71, v2
    v_mov_b32 v52, 0
    v_mov_b32 v53, 0
    v_mov_b32 v54, 0
    v_mov_b32 v55, 0
    v_mov_b32 v56, 0
    v_mov_b32 v57, 0
    v_mov_b32 v58, 0
    v_mov_b32 v59, 0
    ds_read_b128 v[44:47], v44
    v_lshrrev_b32 v50, 1, v2
    v_and_b32 v51, 0x100, v50
    v_lshrrev_b32 v51, 2, v51
    v_add3_u32 v51, v51, v50, s84
    ds_read_b64 v[48:49], v51
    v_mov_b32 v51, s14
    v_min_u32 v18, s87, v2
    v_lshlrev_b32 v18, 3, v18
    s_cmp_eq_u32 s13, 1
    s_cbranch_scc1 L_mbsc10
    s_waitcnt vmcnt(0)
    s_branch L_nextsc10
L_mbsc10:
    s_nop 15
    s_nop 15
    s_nop 15
    s_nop 15
    s_nop 15
    s_nop 7
    buffer_load_dword v61, v18, s[4:7], s67 offen sc1
    s_mov_b32 m0, s53
    s_add_u32 s30, s21, 4096
    buffer_load_dwordx4 v2, s[4:7], s21 offen offset:0 sc1 lds
    buffer_load_dwordx4 v2, s[4:7], s21 offen offset:1024 sc1 lds
    buffer_load_dwordx4 v2, s[4:7], s21 offen offset:2048 sc1 lds
    buffer_load_dwordx4 v2, s[4:7], s21 offen offset:3072 sc1 lds
    s_add_u32 m0, s53, 4096
    s_nop 0
    buffer_load_dwordx4 v2, s[4:7], s30 offen sc1 lds
    s_branch L_nextsc10
L_masc10:
    s_waitcnt vmcnt(1)
    v_add_u32 v44, s71, v2
    v_mov_b32 v52, 0
    v_mov_b32 v53, 0
    v_mov_b32 v54, 0
    v_mov_b32 v55, 0
    v_mov_b32 v56, 0
    v_mov_b32 v57, 0
    v_mov_b32 v58, 0
    v_mov_b32 v59, 0
    ds_read_b128 v[44:47], v44
    v_lshrrev_b32 v50, 1, v2
    v_and_b32 v51, 0x100, v50
    v_lshrrev_b32 v51, 2, v51
    v_add3_u32 v51, v51, v50, s84
    ds_read_b64 v[48:49], v51
    v_mov_b32 v51, s14
    v_min_u32 v18, s87, v2
    v_lshlrev_b32 v18, 3, v18
    s_nop 15
    s_nop 15
    s_nop 15
    s_nop 7
    buffer_load_dword v61, v18, s[4:7], s67 offen sc1
    s_mov_b32 m0, s53
    s_add_u32 s30, s21, 4096
    buffer_load_dwordx4 v2, s[4:7], s21 offen offset:0 sc1 lds
    buffer_load_dwordx4 v2, s[4:7], s21 offen offset:1024 sc1 lds
    buffer_load_dwordx4 v2, s[4:7], s21 offen offset:2048 sc1 lds
    buffer_load_dwordx4 v2, s[4:7], s21 offen offset:3072 sc1 lds
    s_waitcnt vmcnt(4)
    v_and_b32 v16, 1, v61
    v_cmp_ne_u32 vcc, 1, v16
    s_cbranch_vccz L_mgotsc10
    s_add_u32 s69, s69, 1
L_mloopsc10:
    buffer_load_dword v12, v18, s[4:7], s67 offen sc1
    s_waitcnt vmcnt(0)
    v_and_b32 v16, 1, v12
    v_cmp_ne_u32 vcc, 1, v16
    s_cbranch_vccz L_mseesc10
    s_add_u32 s29, s29, 1
    s_cmp_gt_u32 s29, 0x40000
    s_cbranch_scc0 L_mloopsc10
    s_branch L_chain_fail
L_mseesc10:
    buffer_load_dword v61, v18, s[4:7], s67 offen sc1
    s_mov_b32 m0, s53
    s_add_u32 s30, s21, 4096
    buffer_load_dwordx4 v2, s[4:7], s21 offen offset:0 sc1 lds
    buffer_load_dwordx4 v2, s[4:7], s21 offen offset:1024 sc1 lds
    buffer_load_dwordx4 v2, s[4:7], s21 offen offset:2048 sc1 lds
    buffer_load_dwordx4 v2, s[4:7], s21 offen offset:3072 sc1 lds
L_mgotsc10:
    s_waitcnt vmcnt(0)
L_nextsc10:
    s_add_u32 s14, s14, 1
    s_add_u32 s56, s56, 9216
    s_waitcnt lgkmcnt(0)
L_b1sc11:
    s_barrier
    ds_read_b128 v[12:15], v2 offset:0
    s_mov_b32 m0, s66
    ds_read_b128 v[16:19], v2 offset:1024
    ds_read_b128 v[32:35], v11 offset:1024
    s_waitcnt lgkmcnt(2)
    v_smfmac_f32_16x16x64_bf16 v[56:59], v[12:15], v[152:159], v0
    v_smfmac_f32_16x16x64_bf16 v[28:31], v[12:15], a[224:231], v0
    s_waitcnt lgkmcnt(1)
    v_smfmac_f32_16x16x64_bf16 v[52:55], v[16:19], v[160:167], v0
    ds_read_b128 v[24:27], v11 offset:0
    v_smfmac_f32_16x16x64_bf16 v[52:55], v[12:15], v[144:151], v0
    ds_read_b128 v[40:43], v1 offset:9216
    v_smfmac_f32_16x16x64_bf16 v[20:23], v[12:15], a[96:103], v0
    ds_read_b128 v[36:39], v1 offset:8192
    v_bitop3_b32 v60, v60, v12, v14 bitop3:0x80
    v_smfmac_f32_16x16x64_bf16 v[56:59], v[16:19], v[168:175], v0
    ds_read_b128 v[12:15], v2 offset:2048
    s_waitcnt lgkmcnt(3)
    v_smfmac_f32_16x16x64_bf16 v[28:31], v[24:27], a[232:239], v0
    buffer_load_dwordx4 v2, s[4:7], s50 offen sc1 lds
    v_smfmac_f32_16x16x64_bf16 v[20:23], v[24:27], a[104:111], v0
    ds_read_b128 v[24:27], v11 offset:2048
    v_smfmac_f32_16x16x64_bf16 v[20:23], v[16:19], a[112:119], v0
    buffer_load_dwordx4 v2, s[4:7], s50 offen offset:1024 sc1 lds
    v_smfmac_f32_16x16x64_bf16 v[28:31], v[32:35], a[248:255], v0
    s_waitcnt lgkmcnt(1)
    v_bitop3_b32 v60, v60, v16, v18 bitop3:0x80
    v_smfmac_f32_16x16x64_bf16 v[52:55], v[12:15], v[36:43], v0
    buffer_store_dwordx4 v[44:47], v2, s[4:7], s70 offen sc1
    ds_read_b128 v[40:43], v1 offset:13312
    ds_read_b128 v[36:39], v1 offset:12288
    v_bitop3_b32 v60, v60, v12, v14 bitop3:0x80
    v_smfmac_f32_16x16x64_bf16 v[28:31], v[16:19], a[240:247], v0
    ds_read_b128 v[16:19], v2 offset:3072
    v_smfmac_f32_16x16x64_bf16 v[20:23], v[12:15], a[128:135], v0
    ds_read_b128 v[44:47], v1 offset:10240
    buffer_store_dwordx2 v[48:49], v50, s[4:7], s83 offen sc1
    buffer_store_dword v51, off, s[4:7], s62 sc1
    ds_read_b128 v[48:51], v1 offset:11264
    v_smfmac_f32_16x16x64_bf16 v[28:31], v[12:15], v[64:71], v0
    v_smfmac_f32_16x16x64_bf16 v[20:23], v[32:35], a[120:127], v0
    ds_read_b128 v[32:35], v11 offset:3072
    s_waitcnt lgkmcnt(6)
    v_smfmac_f32_16x16x64_bf16 v[28:31], v[24:27], v[72:79], v0
    s_waitcnt lgkmcnt(1)
    v_smfmac_f32_16x16x64_bf16 v[56:59], v[12:15], v[44:51], v0
    ds_read_b128 v[48:51], v1 offset:15360
    ds_read_b128 v[44:47], v1 offset:14336
    v_smfmac_f32_16x16x64_bf16 v[20:23], v[24:27], a[136:143], v0
    v_smfmac_f32_16x16x64_bf16 v[52:55], v[16:19], v[36:43], v0
    s_waitcnt lgkmcnt(0)
    v_smfmac_f32_16x16x64_bf16 v[56:59], v[16:19], v[44:51], v0
    s_waitcnt vmcnt(5)
    ds_read_b128 v[44:47], v1 offset:30720
    v_and_b32 v63, 1, v61
    v_cmp_ne_u32 vcc, 1, v63
    v_smfmac_f32_16x16x64_bf16 v[20:23], v[16:19], a[144:151], v0
    ds_read_b128 v[36:39], v1 offset:28672
    ds_read_b128 v[40:43], v1 offset:29696
    v_smfmac_f32_16x16x64_bf16 v[28:31], v[16:19], v[80:87], v0
    s_cbranch_vccnz L_rbsc11
L_rbksc11:
    s_barrier
    ds_read_b128 v[12:15], v2 offset:4096
    ds_read_b128 v[48:51], v1 offset:31744
    v_smfmac_f32_16x16x64_bf16 v[20:23], v[32:35], a[152:159], v0
    ds_read_b128 v[24:27], v11 offset:4096
    v_bitop3_b32 v60, v60, v16, v18 bitop3:0x80
    v_smfmac_f32_16x16x64_bf16 v[28:31], v[32:35], v[88:95], v0
    ds_read_b128 v[32:35], v11 offset:5120
    s_waitcnt lgkmcnt(3)
    v_smfmac_f32_16x16x64_bf16 v[20:23], v[12:15], a[160:167], v0
    ds_read_b128 v[16:19], v2 offset:5120
    v_smfmac_f32_16x16x64_bf16 v[28:31], v[12:15], v[96:103], v0
    s_mov_b32 m0, 161344
    ds_read_b128 v[12:15], v2 offset:6144
    s_waitcnt lgkmcnt(3)
    v_smfmac_f32_16x16x64_bf16 v[28:31], v[24:27], v[104:111], v0
    v_smfmac_f32_16x16x64_bf16 v[20:23], v[24:27], a[168:175], v0
    ds_read_b128 v[24:27], v11 offset:6144
    s_waitcnt lgkmcnt(2)
    v_smfmac_f32_16x16x64_bf16 v[20:23], v[16:19], v[36:43], v0
    ds_read_b128 v[40:43], v1 offset:1024
    v_smfmac_f32_16x16x64_bf16 v[28:31], v[16:19], v[112:119], v0
    ds_read_b128 v[36:39], v1 offset:0
    v_smfmac_f32_16x16x64_bf16 v[20:23], v[32:35], v[44:51], v0
    ds_read_b128 v[44:47], v1 offset:2048
    v_smfmac_f32_16x16x64_bf16 v[28:31], v[32:35], v[120:127], v0
    s_waitcnt lgkmcnt(4)
    ds_read_b128 v[48:51], v1 offset:3072
    ds_read_b128 v[16:19], v2 offset:7168
    v_bitop3_b32 v60, v60, v12, v14 bitop3:0x80
    v_smfmac_f32_16x16x64_bf16 v[20:23], v[12:15], a[176:183], v0
    ds_read_b128 v[32:35], v11 offset:7168
    s_waitcnt lgkmcnt(4)
    v_smfmac_f32_16x16x64_bf16 v[28:31], v[12:15], v[36:43], v0
    ds_read_b128 v[36:39], v1 offset:4096
    buffer_load_dword v62, s[4:7], s64 offen sc1 lds
    v_smfmac_f32_16x16x64_bf16 v[20:23], v[24:27], a[184:191], v0
    ds_read_b128 v[40:43], v1 offset:5120
    s_waitcnt lgkmcnt(4)
    v_smfmac_f32_16x16x64_bf16 v[28:31], v[24:27], v[44:51], v0
    s_waitcnt lgkmcnt(3)
    v_smfmac_f32_16x16x64_bf16 v[20:23], v[16:19], a[192:199], v0
    ds_read_b128 v[12:15], v2 offset:8192
    ds_read_b128 v[44:47], v1 offset:6144
    v_smfmac_f32_16x16x64_bf16 v[28:31], v[16:19], v[128:135], v0
    s_waitcnt lgkmcnt(4)
    v_bitop3_b32 v60, v60, v16, v18 bitop3:0x80
    v_smfmac_f32_16x16x64_bf16 v[20:23], v[32:35], a[200:207], v0
    ds_read_b128 v[24:27], v11 offset:8192
    ds_read_b128 v[16:19], v2 offset:4096
    v_smfmac_f32_16x16x64_bf16 v[28:31], v[32:35], v[136:143], v0
    s_waitcnt lgkmcnt(3)
    v_smfmac_f32_16x16x64_bf16 v[28:31], v[12:15], v[36:43], v0
    ds_read_b128 v[48:51], v1 offset:7168
    v_bitop3_b32 v60, v60, v12, v14 bitop3:0x80
    v_smfmac_f32_16x16x64_bf16 v[20:23], v[12:15], a[208:215], v0
    ds_read_b128 v[12:15], v2 offset:5120
    s_waitcnt lgkmcnt(3)
    v_smfmac_f32_16x16x64_bf16 v[20:23], v[24:27], a[216:223], v0
    s_waitcnt lgkmcnt(2)
    v_smfmac_f32_16x16x64_bf16 v[52:55], v[16:19], v[176:183], v0
    ds_read_b128 v[36:39], v2 offset:9216
    v_bitop3_b32 v60, v60, v16, v18 bitop3:0x80
    v_smfmac_f32_16x16x64_bf16 v[56:59], v[16:19], v[184:191], v0
    ds_read_b128 v[40:43], v2 offset:10240
    s_waitcnt lgkmcnt(2)
    v_mul_f32 v20, s28, v20
    v_bitop3_b32 v60, v60, v12, v14 bitop3:0x80
    v_smfmac_f32_16x16x64_bf16 v[28:31], v[24:27], v[44:51], v0
    ds_read_b128 v[44:47], v2 offset:11264
    v_mul_f32 v21, s28, v21
    v_smfmac_f32_16x16x64_bf16 v[52:55], v[12:15], v[192:199], v0
    ds_read_b128 v[16:19], v2 offset:6144
    v_mul_f32 v23, s28, v23
    v_mul_f32 v22, s28, v22
    v_cvt_pk_bf16_f32 v20, v20, v21
    v_cvt_pk_bf16_f32 v21, v22, v23
    v_smfmac_f32_16x16x64_bf16 v[56:59], v[12:15], v[200:207], v0
    ds_read_b128 v[12:15], v2 offset:7168
    ds_write2_b32 v4, v20, v21 offset0:0 offset1:80
    v_cvt_pk_bf16_f32 v28, v28, v29
    v_cvt_pk_bf16_f32 v29, v30, v31
    s_waitcnt lgkmcnt(2)
    v_smfmac_f32_16x16x64_bf16 v[56:59], v[16:19], v[216:223], v0
    ds_write2_b32 v4, v28, v29 offset0:144 offset1:224
    v_and_b32 v60, 1, v60
    v_smfmac_f32_16x16x64_bf16 v[52:55], v[16:19], v[208:215], v0
    ds_read_b128 v[16:19], v2 offset:8192
    s_waitcnt lgkmcnt(3)
    v_cmp_ne_u32 vcc, 1, v60
    v_smfmac_f32_16x16x64_bf16 v[52:55], v[12:15], v[224:231], v0
    v_smfmac_f32_16x16x64_bf16 v[56:59], v[12:15], v[232:239], v0
    s_cbranch_vccz L_oksc11
    s_branch L_redosc11
L_oksc11:
    s_waitcnt lgkmcnt(0)
    s_barrier
    ds_read_b64_tr_b16 v[20:21], v5 offset:21504
    ds_read_b64_tr_b16 v[22:23], v5 offset:21520
    v_smfmac_f32_16x16x64_bf16 v[52:55], v[16:19], v[240:247], v0
    ds_read_b64_tr_b16 v[24:25], v5 offset:22664
    s_add_u32 s50, s50, 262144
    ds_read_b128 v[48:51], v2 offset:12288
    v_smfmac_f32_16x16x64_bf16 v[56:59], v[16:19], v[248:255], v0
    ds_read_b64_tr_b16 v[26:27], v5 offset:22680
    ds_read_b64_tr_b16 v[32:33], v5 offset:23824
    ds_read_b64_tr_b16 v[28:29], v5 offset:24984
    s_waitcnt lgkmcnt(5)
    v_mfma_f32_16x16x32_bf16 v[12:15], v[36:39], v[20:23], 0
    ds_read_b64_tr_b16 v[34:35], v5 offset:23840
    ds_read_b128 v[36:39], v2 offset:13312
    v_mfma_f32_16x16x32_bf16 v[16:19], v[40:43], v[20:23], 0
    ds_read_b128 v[40:43], v2 offset:14336
    s_waitcnt lgkmcnt(5)
    v_mfma_f32_16x16x32_bf16 v[12:15], v[44:47], v[24:27], v[12:15]
    ds_read_b128 v[44:47], v2 offset:15360
    v_mfma_f32_16x16x32_bf16 v[16:19], v[48:51], v[24:27], v[16:19]
    ds_read_b64_tr_b16 v[30:31], v5 offset:25000
    ds_read_b128 v[48:51], v2 offset:16384
    s_waitcnt lgkmcnt(4)
    v_mfma_f32_16x16x32_bf16 v[12:15], v[36:39], v[32:35], v[12:15]
    s_add_u32 s64, s64, 262144
    ds_read_b64_tr_b16 v[36:37], v6 offset:0
    v_cvt_pk_bf16_f32 v52, v52, v56
    v_cvt_pk_bf16_f32 v56, v54, v58
    s_waitcnt lgkmcnt(4)
    v_mfma_f32_16x16x32_bf16 v[16:19], v[40:43], v[32:35], v[16:19]
    ds_read_b64_tr_b16 v[42:43], v6 offset:1176
    ds_read_b64_tr_b16 v[40:41], v6 offset:1160
    s_waitcnt lgkmcnt(4)
    v_cvt_pk_bf16_f32 v53, v53, v57
    v_mfma_f32_16x16x32_bf16 v[12:15], v[44:47], v[28:31], v[12:15]
    ds_read_b64_tr_b16 v[38:39], v6 offset:16
    ds_read_b64_tr_b16 v[44:45], v6 offset:2320
    s_waitcnt lgkmcnt(5)
    v_mov_b32 v54, 0
    v_mfma_f32_16x16x32_bf16 v[16:19], v[48:51], v[28:31], v[16:19]
    ds_read_b64_tr_b16 v[48:49], v6 offset:3480
    ds_read_b64_tr_b16 v[50:51], v6 offset:3496
    ds_read_b64_tr_b16 v[46:47], v6 offset:2336
    v_cvt_pk_bf16_f32 v57, v55, v59
    v_mov_b32 v59, 0
    v_mov_b32 v58, 0
    s_waitcnt lgkmcnt(4)
    v_mfma_f32_16x16x32_bf16 v[60:63], v[36:39], v[20:23], 0
    s_waitcnt vmcnt(4)
    ds_read2st64_b32 v[38:39], v8 offset0:2 offset1:3
    v_mov_b32 v55, 0
    v_mfma_f32_16x16x32_bf16 v[60:63], v[40:43], v[24:27], v[60:63]
    ds_read2st64_b32 v[40:41], v8 offset0:4 offset1:5
    s_waitcnt lgkmcnt(2)
    v_exp_f32 v20, v12
    v_mfma_f32_16x16x32_bf16 v[60:63], v[44:47], v[32:35], v[60:63]
    ds_read_b128 v[44:47], v2 offset:30720
    ds_read2st64_b32 v[42:43], v8 offset0:6 offset1:7
    v_exp_f32 v21, v13
    v_mfma_f32_16x16x32_bf16 v[60:63], v[48:51], v[28:31], v[60:63]
    ds_read_b128 v[28:31], v2 offset:31744
    ds_read2st64_b32 v[36:37], v8 offset0:0 offset1:1
    ds_read_b128 v[48:51], v2 offset:31744
    v_exp_f32 v22, v14
    v_max3_f32 v32, |v12|, |v13|, |v14|
    v_max3_f32 v32, v32, |v15|, |v16|
    v_cvt_pk_bf16_f32 v20, v20, v21
    v_max3_f32 v32, v32, |v17|, |v18|
    v_max3_f32 v33, |v61|, |v62|, |v63|
    v_exp_f32 v23, v15
    v_exp_f32 v24, v16
    v_exp_f32 v25, v17
    v_exp_f32 v27, v19
    v_max3_f32 v32, v32, |v19|, |v60|
    v_max_f32 v33, v32, v33
    v_cmp_nge_f32 vcc, 0x42800000, v33
    v_exp_f32 v26, v18
    v_cvt_pk_bf16_f32 v21, v22, v23
    v_cvt_pk_bf16_f32 v22, v24, v25
    v_cvt_pk_bf16_f32 v23, v26, v27
    s_cbranch_vccnz L_mxsc11
L_mxksc11:
    v_exp_f32 v60, v60
    s_waitcnt lgkmcnt(1)
    v_smfmac_f32_16x16x64_bf16 v[28:31], v[20:23], v[36:43], v0
    ds_read_b128 v[32:35], v2 offset:31744
    v_exp_f32 v61, v61
    v_exp_f32 v62, v62
    v_exp_f32 v63, v63
    v_mfma_f32_16x16x32_bf16 v[16:19], v[20:23], v[44:47], 0
    s_waitcnt lgkmcnt(1)
    v_cvt_pk_bf16_f32 v50, v62, v63
    v_cvt_pk_bf16_f32 v48, v60, v61
    v_mfma_f32_16x16x32_bf16 v[16:19], v[20:23], v[44:47], v[16:19]
    ds_read_b128 v[12:15], v2 offset:31744
    ds_read_b128 v[20:23], v1 offset:24576
    v_mfma_f32_16x16x32_bf16 v[16:19], v[48:51], v[44:47], v[16:19]
    v_smfmac_f32_16x16x64_bf16 v[28:31], v[48:51], v[52:59], v0
    ds_read_b128 v[24:27], v1 offset:25600
    ds_read_b128 v[60:63], v2 offset:31744
    ds_write2st64_b32 v8, v52, v53 offset0:0 offset1:1
    v_subrev_u32 v44, 21504, v4
    s_nop 0
    v_rcp_f32 v17, v17
    v_rcp_f32 v18, v18
    v_rcp_f32 v16, v16
    v_rcp_f32 v19, v19
    v_mul_f32 v30, v30, v18
    v_mul_f32 v28, v28, v16
    v_mul_f32 v29, v29, v17
    v_cvt_pk_bf16_f32 v28, v28, v29
    v_mul_f32 v31, v31, v19
    v_cvt_pk_bf16_f32 v29, v30, v31
    ds_write2_b32 v44, v28, v29 offset0:0 offset1:80
    ds_write2st64_b32 v8, v56, v57 offset0:2 offset1:3
    v_mov_b32 v28, 0
    v_mov_b32 v31, 0
    s_mov_b32 m0, s65
    ds_read_b128 v[16:19], v2 offset:31744
    v_mov_b32 v30, 0
    ds_read_b128 v[56:59], v1 offset:27648
    v_mov_b32 v29, 0
    s_waitcnt lgkmcnt(2)
    s_barrier
    s_cmp_eq_u32 s14, 63
    s_cbranch_scc1 L_chain_lastsc1
    ds_read_b64_tr_b16 v[36:37], v7 offset:0
    ds_read_b64_tr_b16 v[38:39], v7 offset:16
    ds_read_b64_tr_b16 v[42:43], v7 offset:1176
    ds_read_b64_tr_b16 v[40:41], v7 offset:1160
    ds_read_b64_tr_b16 v[46:47], v3 offset:16
    ds_read_b64_tr_b16 v[48:49], v3 offset:1160
    ds_read_b64_tr_b16 v[44:45], v3 offset:0
    s_waitcnt lgkmcnt(5)
    v_smfmac_f32_16x16x64_bf16 v[12:15], v[36:39], a[0:7], v0
    ds_read_b64_tr_b16 v[50:51], v3 offset:1176
    s_waitcnt lgkmcnt(4)
    v_smfmac_f32_16x16x64_bf16 v[12:15], v[40:43], a[16:23], v0
    buffer_load_dwordx4 v2, s[4:7], s49 offen offset:0 sc1 lds
    s_waitcnt lgkmcnt(1)
    v_smfmac_f32_16x16x64_bf16 v[12:15], v[44:47], a[32:39], v0
    s_waitcnt lgkmcnt(0)
    v_smfmac_f32_16x16x64_bf16 v[12:15], v[48:51], a[48:55], v0
    v_smfmac_f32_16x16x64_bf16 v[32:35], v[36:39], a[8:15], v0
    buffer_load_dwordx4 v2, s[4:7], s49 offen offset:1024 sc1 lds
    v_smfmac_f32_16x16x64_bf16 v[32:35], v[40:43], a[24:31], v0
    s_add_u32 s49, s49, 262144
    ds_read_b128 v[52:55], v1 offset:26624
    v_cvt_pk_bf16_f32 v12, v12, v13
    v_cvt_pk_bf16_f32 v13, v14, v15
    v_and_b32 v12, -2, v12
    v_smfmac_f32_16x16x64_bf16 v[32:35], v[44:47], a[40:47], v0
    buffer_store_dwordx2 v[12:13], v9, s[4:7], s20 offen offset:0 sc1
    v_smfmac_f32_16x16x64_bf16 v[32:35], v[48:51], a[56:63], v0
    v_smfmac_f32_16x16x64_bf16 v[60:63], v[36:39], v[20:27], v0
    ds_read_b128 v[20:23], v1 offset:16384
    ds_read_b128 v[24:27], v1 offset:17408
    s_waitcnt lgkmcnt(2)
    v_smfmac_f32_16x16x64_bf16 v[60:63], v[40:43], v[52:59], v0
    ds_read_b128 v[56:59], v1 offset:21504
    ds_read_b128 v[52:55], v1 offset:20480
    v_cvt_pk_bf16_f32 v32, v32, v33
    v_and_b32 v32, -2, v32
    v_cvt_pk_bf16_f32 v33, v34, v35
    v_smfmac_f32_16x16x64_bf16 v[28:31], v[36:39], a[64:71], v0
    buffer_store_dwordx2 v[32:33], v9, s[4:7], s20 offen offset:512 sc1
    v_smfmac_f32_16x16x64_bf16 v[28:31], v[44:47], a[80:87], v0
    s_waitcnt lgkmcnt(2)
    v_cvt_pk_bf16_f32 v60, v60, v61
    v_smfmac_f32_16x16x64_bf16 v[28:31], v[40:43], v[20:27], v0
    ds_read_b128 v[20:23], v1 offset:18432
    ds_read_b128 v[24:27], v1 offset:19456
    v_and_b32 v60, -2, v60
    v_cvt_pk_bf16_f32 v61, v62, v63
    s_waitcnt lgkmcnt(2)
    v_smfmac_f32_16x16x64_bf16 v[28:31], v[48:51], v[52:59], v0
    s_mov_b32 s29, 0
    ds_read_b128 v[56:59], v1 offset:23552
    ds_read_b128 v[52:55], v1 offset:22528
    v_smfmac_f32_16x16x64_bf16 v[16:19], v[36:39], a[72:79], v0
    buffer_store_dwordx2 v[60:61], v9, s[4:7], s3 offen offset:0 sc1
    v_smfmac_f32_16x16x64_bf16 v[16:19], v[44:47], a[88:95], v0
    s_waitcnt lgkmcnt(2)
    s_nop 0
    v_cvt_pk_bf16_f32 v28, v28, v29
    v_smfmac_f32_16x16x64_bf16 v[16:19], v[40:43], v[20:27], v0
    s_mov_b32 s70, s52
    v_cvt_pk_bf16_f32 v29, v30, v31
    v_and_b32 v28, -2, v28
    s_waitcnt lgkmcnt(0)
    v_smfmac_f32_16x16x64_bf16 v[16:19], v[48:51], v[52:59], v0
    s_mov_b32 s83, s51
    buffer_store_dwordx2 v[28:29], v9, s[4:7], s20 offen offset:1024 sc1
    s_add_u32 s52, s52, 131072
    s_nop 4
    v_cvt_pk_bf16_f32 v16, v16, v17
    v_and_b32 v16, -2, v16
    v_cvt_pk_bf16_f32 v17, v18, v19
    s_add_u32 s51, s51, 65536
    buffer_store_dwordx2 v[16:17], v9, s[4:7], s20 offen offset:1536 sc1
    s_cmp_eq_u32 s13, 0
    s_cbranch_scc0 L_nw0sc11
    s_nop 15
    buffer_load_dwordx4 v[36:39], v10, s[4:7], s16 offen offset:0 sc1
    buffer_load_dwordx4 v[40:43], v10, s[4:7], s17 offen offset:0 sc1
    buffer_load_dwordx4 v[44:47], v10, s[4:7], s18 offen offset:0 sc1
    buffer_load_dwordx4 v[48:51], v10, s[4:7], s19 offen offset:0 sc1
    v_mov_b32 v31, 0x3f80
    v_and_b32 v30, 16, v2
    v_lshlrev_b32 v30, v30, v31
    v_cndmask_b32 v20, 0, v30, s[72:73]
    v_cndmask_b32 v21, 0, v30, s[74:75]
    v_cndmask_b32 v22, 0, v30, s[76:77]
    v_cndmask_b32 v23, 0, v30, s[78:79]
    s_barrier
    s_branch L_rgosc11
L_nw0sc11:
    s_cmp_eq_u32 s23, 0
    s_cbranch_scc0 L_rd1sc11
    s_barrier
    s_branch L_mresc11
L_rd1sc11:
    v_mov_b32 v31, 0x3f80
    v_and_b32 v30, 16, v2
    v_lshlrev_b32 v30, v30, v31
    v_cndmask_b32 v20, 0, v30, s[72:73]
    v_cndmask_b32 v21, 0, v30, s[74:75]
    v_cndmask_b32 v22, 0, v30, s[76:77]
    v_cndmask_b32 v23, 0, v30, s[78:79]
    s_barrier
    s_cmp_eq_u32 s13, 2
    s_cbranch_scc1 L_r8sc11
    s_nop 15
    s_nop 15
    s_nop 7
    buffer_load_dwordx4 v[36:39], v10, s[4:7], s16 offen offset:0 sc1
    buffer_load_dwordx4 v[40:43], v10, s[4:7], s17 offen offset:0 sc1
    buffer_load_dwordx4 v[44:47], v10, s[4:7], s18 offen offset:0 sc1
    buffer_load_dwordx4 v[48:51], v10, s[4:7], s19 offen offset:0 sc1
L_rgosc11:
    s_nop 15
    s_nop 15
    s_nop 7
    buffer_load_dwordx4 v[12:15], v10, s[4:7], s16 offen offset:0 sc1
    buffer_load_dwordx4 v[32:35], v10, s[4:7], s17 offen offset:0 sc1
    buffer_load_dwordx4 v[52:55], v10, s[4:7], s18 offen offset:0 sc1
    buffer_load_dwordx4 v[56:59], v10, s[4:7], s19 offen offset:0 sc1
L_rpollsc11:
    s_waitcnt vmcnt(7)
    v_mfma_f32_16x16x32_bf16 v[24:27], v[36:39], v[20:23], 0
    v_bitop3_b32 v30, v36, v38, 1 bitop3:0xa8
    v_cmp_ne_u32 s[32:33], 0, v30
    s_waitcnt vmcnt(6)
    v_mfma_f32_16x16x32_bf16 v[24:27], v[40:43], v[20:23], v[24:27]
    v_bitop3_b32 v31, v40, v42, 1 bitop3:0xa8
    v_cmp_ne_u32 s[34:35], 0, v31
    s_waitcnt vmcnt(5)
    v_mfma_f32_16x16x32_bf16 v[24:27], v[44:47], v[20:23], v[24:27]
    v_bitop3_b32 v30, v44, v46, 1 bitop3:0xa8
    v_cmp_ne_u32 s[36:37], 0, v30
    s_waitcnt vmcnt(4)
    v_mfma_f32_16x16x32_bf16 v[24:27], v[48:51], v[20:23], v[24:27]
    v_bitop3_b32 v31, v48, v50, 1 bitop3:0xa8
    v_cmp_ne_u32 s[38:39], 0, v31
    s_or_b64 vcc, s[32:33], s[34:35]
    s_or_b64 vcc, vcc, s[36:37]
    s_or_b64 vcc, vcc, s[38:39]
    s_cbranch_scc0 L_rgotsc11
    s_mov_b64 exec, s[32:33]
    buffer_load_dwordx4 v[36:39], v10, s[4:7], s16 offen offset:0 sc1
    s_mov_b64 exec, s[34:35]
    buffer_load_dwordx4 v[40:43], v10, s[4:7], s17 offen offset:0 sc1
    s_mov_b64 exec, s[36:37]
    buffer_load_dwordx4 v[44:47], v10, s[4:7], s18 offen offset:0 sc1
    s_mov_b64 exec, s[38:39]
    buffer_load_dwordx4 v[48:51], v10, s[4:7], s19 offen offset:0 sc1
    s_mov_b64 exec, -1
    s_waitcnt vmcnt(7)
    v_mfma_f32_16x16x32_bf16 v[24:27], v[12:15], v[20:23], 0
    v_bitop3_b32 v30, v12, v14, 1 bitop3:0xa8
    v_cmp_ne_u32 s[40:41], 0, v30
    s_waitcnt vmcnt(6)
    v_mfma_f32_16x16x32_bf16 v[24:27], v[32:35], v[20:23], v[24:27]
    v_bitop3_b32 v31, v32, v34, 1 bitop3:0xa8
    v_cmp_ne_u32 s[42:43], 0, v31
    s_waitcnt vmcnt(5)
    v_mfma_f32_16x16x32_bf16 v[24:27], v[52:55], v[20:23], v[24:27]
    v_bitop3_b32 v30, v52, v54, 1 bitop3:0xa8
    v_cmp_ne_u32 s[44:45], 0, v30
    s_waitcnt vmcnt(4)
    v_mfma_f32_16x16x32_bf16 v[24:27], v[56:59], v[20:23], v[24:27]
    v_bitop3_b32 v31, v56, v58, 1 bitop3:0xa8
    v_cmp_ne_u32 s[46:47], 0, v31
    s_or_b64 vcc, s[40:41], s[42:43]
    s_or_b64 vcc, vcc, s[44:45]
    s_or_b64 vcc, vcc, s[46:47]
    s_cbranch_scc0 L_rgotsc11
    s_mov_b64 exec, s[40:41]
    buffer_load_dwordx4 v[12:15], v10, s[4:7], s16 offen offset:0 sc1
    s_mov_b64 exec, s[42:43]
    buffer_load_dwordx4 v[32:35], v10, s[4:7], s17 offen offset:0 sc1
    s_mov_b64 exec, s[44:45]
    buffer_load_dwordx4 v[52:55], v10, s[4:7], s18 offen offset:0 sc1
    s_mov_b64 exec, s[46:47]
    buffer_load_dwordx4 v[56:59], v10, s[4:7], s19 offen offset:0 sc1
    s_mov_b64 exec, -1
    s_add_u32 s29, s29, 1
    s_cmp_gt_u32 s29, 0x40000
    s_cbranch_scc0 L_rpollsc11
    s_branch L_chain_fail
L_r8sc11:
    s_nop 15
    buffer_load_dwordx4 v[36:39], v10, s[4:7], s16 offen offset:0 sc1
    buffer_load_dwordx4 v[40:43], v10, s[4:7], s17 offen offset:0 sc1
    buffer_load_dwordx4 v[44:47], v10, s[4:7], s18 offen offset:0 sc1
    buffer_load_dwordx4 v[48:51], v10, s[4:7], s19 offen offset:0 sc1
    buffer_load_dwordx4 v[12:15], v10, s[4:7], s16 offen offset:1024 sc1
    buffer_load_dwordx4 v[32:35], v10, s[4:7], s17 offen offset:1024 sc1
    buffer_load_dwordx4 v[52:55], v10, s[4:7], s18 offen offset:1024 sc1
    buffer_load_dwordx4 v[56:59], v10, s[4:7], s19 offen offset:1024 sc1
L_r8psc11:
    s_waitcnt vmcnt(7)
    v_mfma_f32_16x16x32_bf16 v[24:27], v[36:39], v[20:23], 0
    s_waitcnt vmcnt(6)
    v_bitop3_b32 v30, v36, v38, 1 bitop3:0xa8
    v_mfma_f32_16x16x32_bf16 v[24:27], v[40:43], v[20:23], v[24:27]
    v_bitop3_b32 v31, v40, v42, 1 bitop3:0xa8
    v_or3_b32 v63, v30, v31, 0
    s_waitcnt vmcnt(5)
    v_mfma_f32_16x16x32_bf16 v[24:27], v[44:47], v[20:23], v[24:27]
    s_waitcnt vmcnt(4)
    v_bitop3_b32 v30, v44, v46, 1 bitop3:0xa8
    v_mfma_f32_16x16x32_bf16 v[24:27], v[48:51], v[20:23], v[24:27]
    v_bitop3_b32 v31, v48, v50, 1 bitop3:0xa8
    v_or3_b32 v63, v30, v31, v63
    s_waitcnt vmcnt(3)
    v_mfma_f32_16x16x32_bf16 v[24:27], v[12:15], v[20:23], v[24:27]
    s_waitcnt vmcnt(2)
    v_bitop3_b32 v30, v12, v14, 1 bitop3:0xa8
    v_mfma_f32_16x16x32_bf16 v[24:27], v[32:35], v[20:23], v[24:27]
    v_bitop3_b32 v31, v32, v34, 1 bitop3:0xa8
    v_or3_b32 v63, v30, v31, v63
    s_waitcnt vmcnt(1)
    v_mfma_f32_16x16x32_bf16 v[24:27], v[52:55], v[20:23], v[24:27]
    s_waitcnt vmcnt(0)
    v_bitop3_b32 v30, v52, v54, 1 bitop3:0xa8
    v_mfma_f32_16x16x32_bf16 v[24:27], v[56:59], v[20:23], v[24:27]
    v_bitop3_b32 v31, v56, v58, 1 bitop3:0xa8
    v_or3_b32 v63, v30, v31, v63
    v_cmp_ne_u32 vcc, 0, v63
    s_cbranch_vccz L_rgotsc11
    buffer_load_dwordx4 v[36:39], v10, s[4:7], s16 offen offset:0 sc1
    buffer_load_dwordx4 v[40:43], v10, s[4:7], s17 offen offset:0 sc1
    buffer_load_dwordx4 v[44:47], v10, s[4:7], s18 offen offset:0 sc1
    buffer_load_dwordx4 v[48:51], v10, s[4:7], s19 offen offset:0 sc1
    buffer_load_dwordx4 v[12:15], v10, s[4:7], s16 offen offset:1024 sc1
    buffer_load_dwordx4 v[32:35], v10, s[4:7], s17 offen offset:1024 sc1
    buffer_load_dwordx4 v[52:55], v10, s[4:7], s18 offen offset:1024 sc1
    buffer_load_dwordx4 v[56:59], v10, s[4:7], s19 offen offset:1024 sc1
    s_add_u32 s29, s29, 1
    s_cmp_gt_u32 s29, 0x40000
    s_cbranch_scc0 L_r8psc11
    s_branch L_chain_fail
L_rbsc11:
    s_add_u32 s69, s69, 0x10000
    s_mov_b32 s29, 0
    s_mov_b32 s31, m0
L_rblsc11:
    v_min_u32 v63, s87, v2
    v_lshlrev_b32 v63, 3, v63
    buffer_load_dword v61, v63, s[4:7], s67 offen sc1
    s_mov_b32 m0, s53
    s_add_u32 s30, s21, 4096
    buffer_load_dwordx4 v2, s[4:7], s21 offen offset:0 sc1 lds
    buffer_load_dwordx4 v2, s[4:7], s21 offen offset:1024 sc1 lds
    buffer_load_dwordx4 v2, s[4:7], s21 offen offset:2048 sc1 lds
    buffer_load_dwordx4 v2, s[4:7], s21 offen offset:3072 sc1 lds
    s_add_u32 m0, s53, 4096
    s_nop 0
    buffer_load_dwordx4 v2, s[4:7], s30 offen sc1 lds
    s_add_u32 s69, s69, 0x1000000
    s_add_u32 s29, s29, 1
    s_cmp_gt_u32 s29, 0x40000
    s_cbranch_scc1 L_chain_fail
    s_waitcnt vmcnt(0)
    v_and_b32 v63, 1, v61
    v_cmp_ne_u32 vcc, 1, v63
    s_cbranch_vccnz L_rblsc11
    s_mov_b32 m0, s31
    s_branch L_rbksc11
L_mxsc11:
    v_max3_f32 v32, v12, v13, v14
    v_max3_f32 v32, v32, v15, v16
    v_max3_f32 v32, v32, v17, v18
    v_max3_f32 v32, v32, v19, v60
    v_max3_f32 v32, v32, v61, v62
    v_max_f32 v32, v32, v63
    v_mov_b32 v33, v32
    s_nop 1
    v_permlane16_swap_b32 v32, v33
    v_max_f32 v32, v32, v33
    v_mov_b32 v33, v32
    s_nop 1
    v_permlane32_swap_b32 v32, v33
    v_max_f32 v32, v32, v33
    v_sub_f32 v12, v12, v32
    v_sub_f32 v13, v13, v32
    v_sub_f32 v14, v14, v32
    v_sub_f32 v15, v15, v32
    v_sub_f32 v16, v16, v32
    v_sub_f32 v17, v17, v32
    v_sub_f32 v18, v18, v32
    v_sub_f32 v19, v19, v32
    v_sub_f32 v60, v60, v32
    v_sub_f32 v61, v61, v32
    v_sub_f32 v62, v62, v32
    v_sub_f32 v63, v63, v32
    v_exp_f32 v20, v12
    v_exp_f32 v21, v13
    v_exp_f32 v22, v14
    v_exp_f32 v23, v15
    v_exp_f32 v24, v16
    v_exp_f32 v25, v17
    v_exp_f32 v26, v18
    v_exp_f32 v27, v19
    v_cvt_pk_bf16_f32 v20, v20, v21
    v_cvt_pk_bf16_f32 v21, v22, v23
    v_cvt_pk_bf16_f32 v22, v24, v25
    v_cvt_pk_bf16_f32 v23, v26, v27
    s_branch L_mxksc11
L_redosc10:
    s_waitcnt vmcnt(0) lgkmcnt(0)
    s_barrier
    s_add_u32 s85, s85, 1
    s_cmp_gt_u32 s85, 0x4000
    s_cbranch_scc1 L_chain_fail
    s_sub_u32 s14, s14, 1
    s_sub_u32 s56, s56, 9216
    s_mov_b32 s29, 0
    s_mov_b32 s70, 0xf0000000
    s_mov_b32 s83, 0xf0000000
    s_branch L_mresc11
L_rgotsc11:
    v_permlane32_swap_b32 v24, v26
    v_permlane32_swap_b32 v25, v27
    v_add_f32 v24, v24, v26
    v_add_f32 v25, v25, v27
    v_cvt_pk_bf16_f32 v24, v24, v25
    v_mov_b32 v25, v24
    s_add_u32 s68, s68, s29
    s_mov_b32 s29, 0
    v_permlane32_swap_b32 v24, v25
    v_and_b32 v24, -2, v24
    s_mov_b64 exec, s[24:25]
    buffer_store_dwordx2 v[24:25], v9, s[4:7], s22 offen sc1
    s_mov_b64 exec, -1
L_mresc11:
    v_mov_b32 v20, 0
    v_mov_b32 v21, 0
    v_mov_b32 v22, 0
    v_mov_b32 v23, 0
    v_mov_b32 v28, 0
    v_mov_b32 v29, 0
    v_mov_b32 v30, 0
    v_mov_b32 v31, 0
    v_mov_b32 v60, 0
    v_mov_b32 v61, 0
    v_and_b32 v62, 0x1f0, v2
    v_lshlrev_b32 v62, 3, v62
    s_cmp_eq_u32 s13, 0
    s_cbranch_scc1 L_masc11
    s_waitcnt vmcnt(1)
    v_add_u32 v44, s71, v2
    v_mov_b32 v52, 0
    v_mov_b32 v53, 0
    v_mov_b32 v54, 0
    v_mov_b32 v55, 0
    v_mov_b32 v56, 0
    v_mov_b32 v57, 0
    v_mov_b32 v58, 0
    v_mov_b32 v59, 0
    ds_read_b128 v[44:47], v44
    v_lshrrev_b32 v50, 1, v2
    v_and_b32 v51, 0x100, v50
    v_lshrrev_b32 v51, 2, v51
    v_add3_u32 v51, v51, v50, s84
    ds_read_b64 v[48:49], v51
    v_mov_b32 v51, s14
    v_min_u32 v18, s87, v2
    v_lshlrev_b32 v18, 3, v18
    s_cmp_eq_u32 s13, 1
    s_cbranch_scc1 L_mbsc11
    s_add_u32 s30, s14, 3
    s_and_b32 s31, s30, 7
    s_lshl_b32 s58, s13, 3
    s_add_u32 s31, s31, s58
    s_cmp_eq_u32 s31, 24
    s_cbranch_scc0 L_nksc11
    s_cmp_lt_u32 s30, 64
    s_cbranch_scc0 L_nksc11
    s_mul_i32 s30, s30, 1536
    s_add_u32 s30, s30, 117785600
    v_subrev_u32 v13, 131072, v2
    v_lshlrev_b32 v13, 2, v13
    s_mov_b32 s31, 0
Lkv_5:
    buffer_load_dword v12, v13, s[4:7], s30 offen sc1
    s_add_u32 s31, s31, 1
    s_cmp_gt_u32 s31, 0x40000
    s_cbranch_scc1 L_chain_fail
    s_waitcnt vmcnt(0)
    v_cmp_ne_u32 vcc, 1, v12
    s_cbranch_vccz Lkv_5_ok
    s_sleep 4
    s_branch Lkv_5
Lkv_5_ok:
L_nksc11:
    s_waitcnt vmcnt(0)
    s_branch L_nextsc11
L_mbsc11:
    s_nop 15
    s_nop 15
    s_nop 15
    s_nop 15
    s_nop 15
    s_nop 7
    buffer_load_dword v61, v18, s[4:7], s67 offen sc1
    s_mov_b32 m0, s53
    s_add_u32 s30, s21, 4096
    buffer_load_dwordx4 v2, s[4:7], s21 offen offset:0 sc1 lds
    buffer_load_dwordx4 v2, s[4:7], s21 offen offset:1024 sc1 lds
    buffer_load_dwordx4 v2, s[4:7], s21 offen offset:2048 sc1 lds
    buffer_load_dwordx4 v2, s[4:7], s21 offen offset:3072 sc1 lds
    s_add_u32 m0, s53, 4096
    s_nop 0
    buffer_load_dwordx4 v2, s[4:7], s30 offen sc1 lds
    s_branch L_nextsc11
L_masc11:
    s_waitcnt vmcnt(1)
    v_add_u32 v44, s71, v2
    v_mov_b32 v52, 0
    v_mov_b32 v53, 0
    v_mov_b32 v54, 0
    v_mov_b32 v55, 0
    v_mov_b32 v56, 0
    v_mov_b32 v57, 0
    v_mov_b32 v58, 0
    v_mov_b32 v59, 0
    ds_read_b128 v[44:47], v44
    v_lshrrev_b32 v50, 1, v2
    v_and_b32 v51, 0x100, v50
    v_lshrrev_b32 v51, 2, v51
    v_add3_u32 v51, v51, v50, s84
    ds_read_b64 v[48:49], v51
    v_mov_b32 v51, s14
    v_min_u32 v18, s87, v2
    v_lshlrev_b32 v18, 3, v18
    s_nop 15
    s_nop 15
    s_nop 15
    s_nop 7
    buffer_load_dword v61, v18, s[4:7], s67 offen sc1
    s_mov_b32 m0, s53
    s_add_u32 s30, s21, 4096
    buffer_load_dwordx4 v2, s[4:7], s21 offen offset:0 sc1 lds
    buffer_load_dwordx4 v2, s[4:7], s21 offen offset:1024 sc1 lds
    buffer_load_dwordx4 v2, s[4:7], s21 offen offset:2048 sc1 lds
    buffer_load_dwordx4 v2, s[4:7], s21 offen offset:3072 sc1 lds
    s_waitcnt vmcnt(4)
    v_and_b32 v16, 1, v61
    v_cmp_ne_u32 vcc, 0, v16
    s_cbranch_vccz L_mgotsc11
    s_add_u32 s69, s69, 1
L_mloopsc11:
    buffer_load_dword v12, v18, s[4:7], s67 offen sc1
    s_waitcnt vmcnt(0)
    v_and_b32 v16, 1, v12
    v_cmp_ne_u32 vcc, 0, v16
    s_cbranch_vccz L_mseesc11
    s_add_u32 s29, s29, 1
    s_cmp_gt_u32 s29, 0x40000
    s_cbranch_scc0 L_mloopsc11
    s_branch L_chain_fail
L_mseesc11:
    buffer_load_dword v61, v18, s[4:7], s67 offen sc1
    s_mov_b32 m0, s53
    s_add_u32 s30, s21, 4096
    buffer_load_dwordx4 v2, s[4:7], s21 offen offset:0 sc1 lds
    buffer_load_dwordx4 v2, s[4:7], s21 offen offset:1024 sc1 lds
    buffer_load_dwordx4 v2, s[4:7], s21 offen offset:2048 sc1 lds
    buffer_load_dwordx4 v2, s[4:7], s21 offen offset:3072 sc1 lds
L_mgotsc11:
    s_waitcnt vmcnt(0)
L_nextsc11:
    s_add_u32 s14, s14, 1
    s_add_u32 s56, s56, 9216
    s_waitcnt lgkmcnt(0)
    s_branch L_stepsc1
L_chain_lastsc1:
    v_add_u32 v44, s71, v2
    ds_read_b128 v[44:47], v44
    v_lshrrev_b32 v50, 1, v2
    v_and_b32 v51, 0x100, v50
    v_lshrrev_b32 v51, 2, v51
    v_add3_u32 v51, v51, v50, s84
    ds_read_b64 v[48:49], v51
    v_mov_b32 v51, s14
    s_waitcnt lgkmcnt(0)
    buffer_store_dwordx4 v[44:47], v2, s[4:7], s52 offen sc1
    buffer_store_dwordx2 v[48:49], v50, s[4:7], s51 offen sc1
    s_waitcnt vmcnt(0)
    s_barrier
    v_mov_b32 v44, 64
    s_cmp_eq_u32 s13, 3
    s_cbranch_scc0 L_chain_done
    s_mov_b64 exec, 1
    buffer_store_dword v44, off, s[4:7], s15 sc1
    s_waitcnt vmcnt(0)
    s_branch L_chain_done
L_chain_done:
L_chain_fail:
L_fail:
    s_endpgm
L_worker:
    s_sub_u32 s100, s99, 32
    s_mov_b32 s101, 0
    s_and_b32 s12, s100, 7
    s_lshr_b32 s14, s100, 3
    s_mov_b32 s59, 7
    s_mov_b32 s60, 0
    s_cmp_ge_u32 s14, 16
    s_cselect_b32 s61, 1, 2
    s_cmp_lt_u32 s12, 2
    s_cselect_b32 s61, s61, 0
    s_cselect_b32 s62, s12, 0
    s_sub_u32 s61, s61, s62
    s_cmp_ge_u32 s100, 192
    s_cbranch_scc1 L_sib
    s_cmp_eq_u32 s12, 7
    s_cbranch_scc0 L_g1_pass
    s_mov_b32 s59, 1
    s_cmp_lt_u32 s14, 8
    s_cselect_b32 s60, 56, 40
    s_cselect_b32 s12, 0, 1
    s_branch L_g1_pass
L_sib:
    s_sub_u32 s14, s100, 192
    s_mov_b32 s60, 24
    s_mov_b32 s12, 0
    s_mov_b32 s59, 1
    s_mov_b32 s61, 0
    s_mul_i32 s30, s14, 20480
    s_add_u32 s30, s30, 117440512
    v_lshlrev_b32 v1, 4, v0
    v_mov_b32 v4, 0
    v_mov_b32 v5, 0
    v_mov_b32 v6, 0
    v_mov_b32 v7, 0
    buffer_store_dwordx4 v[4:7], v1, s[4:7], s30 offen sc1
    s_add_u32 s30, s30, 4096
    buffer_store_dwordx4 v[4:7], v1, s[4:7], s30 offen sc1
    s_add_u32 s30, s30, 4096
    buffer_store_dwordx4 v[4:7], v1, s[4:7], s30 offen sc1
    s_add_u32 s30, s30, 4096
    buffer_store_dwordx4 v[4:7], v1, s[4:7], s30 offen sc1
    s_add_u32 s30, s30, 4096
    buffer_store_dwordx4 v[4:7], v1, s[4:7], s30 offen sc1
    s_add_u32 s30, s30, 4096
    s_waitcnt vmcnt(0)
    s_barrier
    s_cmp_eq_u32 s13, 0
    s_cbranch_scc0 Lclr_6
    s_mov_b64 exec, 1
    v_mov_b32 v4, 1
    buffer_atomic_add v4, off, s[8:11], 0 offset:8
    s_mov_b64 exec, -1
Lclr_6:
L_g1_pass:
    s_cmp_ge_u32 s12, 4
    s_cselect_b32 s63, 4, 0
    s_cselect_b32 s51, 0, 3
    s_load_dwordx2 s[16:17], s[0:1], 0
    s_load_dwordx2 s[28:29], s[0:1], 16
    s_load_dwordx2 s[30:31], s[0:1], 24
    s_load_dwordx2 s[32:33], s[0:1], 32
    s_load_dwordx2 s[34:35], s[0:1], 64
    s_load_dwordx2 s[36:37], s[0:1], 72
    s_load_dwordx2 s[52:53], s[0:1], 88
    s_waitcnt lgkmcnt(0)
    s_mov_b32 s18, 2359296
    s_mov_b32 s19, 0x00020000
    s_mov_b32 s54, 1152
    s_mov_b32 s55, 0x00020000
    s_mov_b64 s[20:21], s[30:31]
    s_mov_b32 s22, 0
    s_mov_b32 s23, 0x00020000
    v_and_b32 v18, 63, v0
    v_lshrrev_b32 v19, 4, v18
    v_and_b32 v20, 15, v18
    v_lshlrev_b32 v21, 2, v19
    v_xor_b32 v20, v20, v21
    v_lshlrev_b32 v20, 4, v20
    v_lshl_add_u32 v1, v19, 13, v20
    v_lshrrev_b32 v19, 3, v18
    v_and_b32 v20, 7, v18
    v_bfe_u32 v21, v18, 4, 1
    v_lshlrev_b32 v21, 2, v21
    v_xor_b32 v20, v20, v21
    v_lshlrev_b32 v20, 4, v20
    v_mul_u32_u24 v19, 9216, v19
    v_add_u32 v2, v19, v20
    s_lshl_b32 s46, s13, 12
    s_mov_b32 s42, 0
    s_mov_b32 s43, 0
    s_add_u32 s38, s42, s63
    s_cmp_ge_u32 s38, 7
    s_cselect_b32 s41, 7, 0
    s_sub_u32 s38, s38, s41
    s_mul_i32 s38, s38, 24
    s_add_u32 s38, s38, s14
    s_add_u32 s38, s38, s60
    s_cmp_ge_u32 s38, 96
    s_cbranch_scc1 Lg_7
    s_lshr_b32 s39, s38, 5
    s_cmp_eq_u32 s39, 0
    s_cselect_b64 s[20:21], s[30:31], s[32:33]
    s_cmp_eq_u32 s39, 2
    s_cselect_b64 s[20:21], s[28:29], s[20:21]
    s_mov_b32 s22, 4718592
    s_and_b32 s38, s38, 31
    s_lshl_b32 s44, s38, 8
    s_lshl_b32 s39, s13, 17
    s_add_u32 s44, s44, s39
    s_mov_b32 s45, 32768
    s_mov_b32 s57, 425984
    v_mov_b32 v3, v1
    s_branch Le_8
Lg_7:
    s_cmp_lt_u32 s13, 2
    s_cselect_b64 s[20:21], s[34:35], s[36:37]
    s_mov_b32 s22, 5308416
    s_sub_u32 s38, s38, 96
    s_lshl_b32 s44, s38, 7
    s_and_b32 s39, s13, 1
    s_mul_i32 s39, s39, 294912
    s_add_u32 s44, s44, s39
    s_mov_b32 s45, 73728
    s_mov_b32 s57, 368640
    v_mov_b32 v3, v2
Le_8:
    s_add_u32 m0, s46, 0
    s_nop 0
    buffer_load_dwordx4 v3, s[20:23], s44 offen  lds
    s_add_u32 m0, s46, 1024
    s_add_u32 s44, s44, s45
    buffer_load_dwordx4 v3, s[20:23], s44 offen  lds
    s_add_u32 m0, s46, 2048
    s_add_u32 s44, s44, s45
    buffer_load_dwordx4 v3, s[20:23], s44 offen  lds
    s_add_u32 m0, s46, 3072
    s_add_u32 s44, s44, s45
    buffer_load_dwordx4 v3, s[20:23], s44 offen  lds
    s_add_u32 s44, s44, s57
    s_add_u32 s46, s46, 16384
    s_and_b32 s46, s46, 131071
    v_add_u32 v19, 0, v18
    v_mul_u32_u24 v20, 911, v19
    v_lshrrev_b32 v20, 16, v20
    v_bfe_u32 v21, v20, 1, 3
    v_xor_b32 v19, v19, v21
    v_lshlrev_b32 v96, 4, v19
    v_add_u32 v19, 64, v18
    v_mul_u32_u24 v20, 911, v19
    v_lshrrev_b32 v20, 16, v20
    v_bfe_u32 v21, v20, 1, 3
    v_xor_b32 v19, v19, v21
    v_lshlrev_b32 v97, 4, v19
    v_add_u32 v19, 128, v18
    v_mul_u32_u24 v20, 911, v19
    v_lshrrev_b32 v20, 16, v20
    v_bfe_u32 v21, v20, 1, 3
    v_xor_b32 v19, v19, v21
    v_lshlrev_b32 v98, 4, v19
    v_add_u32 v19, 192, v18
    v_mul_u32_u24 v20, 911, v19
    v_lshrrev_b32 v20, 16, v20
    v_bfe_u32 v21, v20, 1, 3
    v_xor_b32 v19, v19, v21
    v_lshlrev_b32 v99, 4, v19
    v_add_u32 v19, 256, v18
    v_mul_u32_u24 v20, 911, v19
    v_lshrrev_b32 v20, 16, v20
    v_bfe_u32 v21, v20, 1, 3
    v_xor_b32 v19, v19, v21
    v_lshlrev_b32 v100, 4, v19
    v_add_u32 v19, 320, v18
    v_mul_u32_u24 v20, 911, v19
    v_lshrrev_b32 v20, 16, v20
    v_bfe_u32 v21, v20, 1, 3
    v_xor_b32 v19, v19, v21
    v_lshlrev_b32 v101, 4, v19
    v_add_u32 v19, 384, v18
    v_mul_u32_u24 v20, 911, v19
    v_lshrrev_b32 v20, 16, v20
    v_bfe_u32 v21, v20, 1, 3
    v_xor_b32 v19, v19, v21
    v_lshlrev_b32 v102, 4, v19
    v_add_u32 v19, 448, v18
    v_mul_u32_u24 v20, 911, v19
    v_lshrrev_b32 v20, 16, v20
    v_bfe_u32 v21, v20, 1, 3
    v_xor_b32 v19, v19, v21
    v_lshlrev_b32 v103, 4, v19
    v_add_u32 v19, 512, v18
    v_mul_u32_u24 v20, 911, v19
    v_lshrrev_b32 v20, 16, v20
    v_bfe_u32 v21, v20, 1, 3
    v_xor_b32 v19, v19, v21
    v_lshlrev_b32 v104, 4, v19
    v_add_u32 v19, 576, v18
    v_mul_u32_u24 v20, 911, v19
    v_lshrrev_b32 v20, 16, v20
    v_bfe_u32 v21, v20, 1, 3
    v_xor_b32 v19, v19, v21
    v_lshlrev_b32 v105, 4, v19
    v_add_u32 v19, 640, v18
    v_mul_u32_u24 v20, 911, v19
    v_lshrrev_b32 v20, 16, v20
    v_bfe_u32 v21, v20, 1, 3
    v_xor_b32 v19, v19, v21
    v_lshlrev_b32 v106, 4, v19
    v_add_u32 v19, 704, v18
    v_mul_u32_u24 v20, 911, v19
    v_lshrrev_b32 v20, 16, v20
    v_bfe_u32 v21, v20, 1, 3
    v_xor_b32 v19, v19, v21
    v_lshlrev_b32 v107, 4, v19
    v_add_u32 v19, 768, v18
    v_mul_u32_u24 v20, 911, v19
    v_lshrrev_b32 v20, 16, v20
    v_bfe_u32 v21, v20, 1, 3
    v_xor_b32 v19, v19, v21
    v_lshlrev_b32 v108, 4, v19
    v_add_u32 v19, 832, v18
    v_mul_u32_u24 v20, 911, v19
    v_lshrrev_b32 v20, 16, v20
    v_bfe_u32 v21, v20, 1, 3
    v_xor_b32 v19, v19, v21
    v_lshlrev_b32 v109, 4, v19
    v_add_u32 v19, 896, v18
    v_mul_u32_u24 v20, 911, v19
    v_lshrrev_b32 v20, 16, v20
    v_bfe_u32 v21, v20, 1, 3
    v_xor_b32 v19, v19, v21
    v_lshlrev_b32 v110, 4, v19
    v_add_u32 v19, 960, v18
    v_mul_u32_u24 v20, 911, v19
    v_lshrrev_b32 v20, 16, v20
    v_bfe_u32 v21, v20, 1, 3
    v_xor_b32 v19, v19, v21
    v_lshlrev_b32 v111, 4, v19
    v_add_u32 v19, 1024, v18
    v_mul_u32_u24 v20, 911, v19
    v_lshrrev_b32 v20, 16, v20
    v_bfe_u32 v21, v20, 1, 3
    v_xor_b32 v19, v19, v21
    v_lshlrev_b32 v112, 4, v19
    v_add_u32 v19, 1088, v18
    v_mul_u32_u24 v20, 911, v19
    v_lshrrev_b32 v20, 16, v20
    v_bfe_u32 v21, v20, 1, 3
    v_xor_b32 v19, v19, v21
    v_lshlrev_b32 v113, 4, v19
    s_lshl_b32 s38, s12, 2
    s_add_u32 s38, s38, s13
    s_mul_i32 s38, s38, 73728
    s_mul_i32 s39, s13, 36864
    s_add_u32 s39, s39, 16384
    s_add_u32 m0, s39, 0
    s_add_u32 s40, s38, 0
    buffer_load_dwordx4 v96, s[16:19], s40 offen lds
    s_add_u32 m0, s39, 1024
    s_nop 0
    buffer_load_dwordx4 v97, s[16:19], s40 offen lds
    s_add_u32 m0, s39, 2048
    s_nop 0
    buffer_load_dwordx4 v98, s[16:19], s40 offen lds
    s_add_u32 m0, s39, 3072
    s_nop 0
    buffer_load_dwordx4 v99, s[16:19], s40 offen lds
    s_add_u32 m0, s39, 4096
    s_nop 0
    buffer_load_dwordx4 v100, s[16:19], s40 offen lds
    s_add_u32 m0, s39, 5120
    s_nop 0
    buffer_load_dwordx4 v101, s[16:19], s40 offen lds
    s_add_u32 m0, s39, 6144
    s_nop 0
    buffer_load_dwordx4 v102, s[16:19], s40 offen lds
    s_add_u32 m0, s39, 7168
    s_nop 0
    buffer_load_dwordx4 v103, s[16:19], s40 offen lds
    s_add_u32 m0, s39, 8192
    s_nop 0
    buffer_load_dwordx4 v104, s[16:19], s40 offen lds
    s_add_u32 m0, s39, 9216
    s_nop 0
    buffer_load_dwordx4 v105, s[16:19], s40 offen lds
    s_add_u32 m0, s39, 10240
    s_nop 0
    buffer_load_dwordx4 v106, s[16:19], s40 offen lds
    s_add_u32 m0, s39, 11264
    s_nop 0
    buffer_load_dwordx4 v107, s[16:19], s40 offen lds
    s_add_u32 m0, s39, 12288
    s_nop 0
    buffer_load_dwordx4 v108, s[16:19], s40 offen lds
    s_add_u32 m0, s39, 13312
    s_nop 0
    buffer_load_dwordx4 v109, s[16:19], s40 offen lds
    s_add_u32 m0, s39, 14336
    s_nop 0
    buffer_load_dwordx4 v110, s[16:19], s40 offen lds
    s_add_u32 m0, s39, 15360
    s_nop 0
    buffer_load_dwordx4 v111, s[16:19], s40 offen lds
    s_add_u32 m0, s39, 16384
    s_nop 0
    buffer_load_dwordx4 v112, s[16:19], s40 offen lds
    s_add_u32 m0, s39, 17408
    s_nop 0
    buffer_load_dwordx4 v113, s[16:19], s40 offen lds
    s_add_u32 m0, s39, 18432
    s_add_u32 s40, s38, 18432
    buffer_load_dwordx4 v96, s[16:19], s40 offen lds
    s_add_u32 m0, s39, 19456
    s_nop 0
    buffer_load_dwordx4 v97, s[16:19], s40 offen lds
    s_add_u32 m0, s39, 20480
    s_nop 0
    buffer_load_dwordx4 v98, s[16:19], s40 offen lds
    s_add_u32 m0, s39, 21504
    s_nop 0
    buffer_load_dwordx4 v99, s[16:19], s40 offen lds
    s_add_u32 m0, s39, 22528
    s_nop 0
    buffer_load_dwordx4 v100, s[16:19], s40 offen lds
    s_add_u32 m0, s39, 23552
    s_nop 0
    buffer_load_dwordx4 v101, s[16:19], s40 offen lds
    s_add_u32 m0, s39, 24576
    s_nop 0
    buffer_load_dwordx4 v102, s[16:19], s40 offen lds
    s_add_u32 m0, s39, 25600
    s_nop 0
    buffer_load_dwordx4 v103, s[16:19], s40 offen lds
    s_add_u32 m0, s39, 26624
    s_nop 0
    buffer_load_dwordx4 v104, s[16:19], s40 offen lds
    s_add_u32 m0, s39, 27648
    s_nop 0
    buffer_load_dwordx4 v105, s[16:19], s40 offen lds
    s_add_u32 m0, s39, 28672
    s_nop 0
    buffer_load_dwordx4 v106, s[16:19], s40 offen lds
    s_add_u32 m0, s39, 29696
    s_nop 0
    buffer_load_dwordx4 v107, s[16:19], s40 offen lds
    s_add_u32 m0, s39, 30720
    s_nop 0
    buffer_load_dwordx4 v108, s[16:19], s40 offen lds
    s_add_u32 m0, s39, 31744
    s_nop 0
    buffer_load_dwordx4 v109, s[16:19], s40 offen lds
    s_add_u32 m0, s39, 32768
    s_nop 0
    buffer_load_dwordx4 v110, s[16:19], s40 offen lds
    s_add_u32 m0, s39, 33792
    s_nop 0
    buffer_load_dwordx4 v111, s[16:19], s40 offen lds
    s_add_u32 m0, s39, 34816
    s_nop 0
    buffer_load_dwordx4 v112, s[16:19], s40 offen lds
    s_add_u32 m0, s39, 35840
    s_nop 0
    buffer_load_dwordx4 v113, s[16:19], s40 offen lds
    v_bfe_u32 v19, v18, 2, 1
    v_bfe_u32 v20, v18, 4, 1
    v_lshlrev_b32 v20, 2, v20
    v_lshl_add_u32 v19, v19, 3, v20
    v_and_b32 v20, 3, v18
    v_add_u32 v19, v19, v20
    v_lshrrev_b32 v21, 1, v19
    v_mul_u32_u24 v19, 1152, v19
    v_add_u32 v19, s39, v19
    v_lshrrev_b32 v20, 5, v18
    v_xor_b32 v21, v21, v20
    v_xor_b32 v22, 0, v21
    v_lshl_add_u32 v116, v22, 4, v19
    v_xor_b32 v22, 2, v21
    v_lshl_add_u32 v117, v22, 4, v19
    v_xor_b32 v22, 4, v21
    v_lshl_add_u32 v118, v22, 4, v19
    v_xor_b32 v22, 6, v21
    v_lshl_add_u32 v119, v22, 4, v19
    v_lshlrev_b32 v21, 4, v20
    s_waitcnt vmcnt(18)
    s_mov_b32 exec_lo, 0x00ff00ff
    s_mov_b32 exec_hi, 0x00ff00ff
    ds_read_b128 a[0:3], v116 offset:0
    ds_read_b128 a[4:7], v117 offset:0
    ds_read_b128 a[8:11], v118 offset:0
    ds_read_b128 a[12:15], v119 offset:0
    ds_read_b128 a[16:19], v116 offset:128
    ds_read_b128 a[20:23], v117 offset:128
    ds_read_b128 a[24:27], v118 offset:128
    ds_read_b128 a[28:31], v119 offset:128
    ds_read_b128 a[32:35], v116 offset:256
    ds_read_b128 a[36:39], v117 offset:256
    ds_read_b128 a[40:43], v118 offset:256
    ds_read_b128 a[44:47], v119 offset:256
    s_waitcnt lgkmcnt(6)
    ds_read_b128 a[48:51], v116 offset:384
    ds_read_b128 a[52:55], v117 offset:384
    ds_read_b128 a[56:59], v118 offset:384
    ds_read_b128 a[60:63], v119 offset:384
    ds_read_b128 a[64:67], v116 offset:512
    ds_read_b128 a[68:71], v117 offset:512
    ds_read_b128 a[72:75], v118 offset:512
    ds_read_b128 a[76:79], v119 offset:512
    ds_read_b128 a[80:83], v116 offset:640
    ds_read_b128 a[84:87], v117 offset:640
    ds_read_b128 a[88:91], v118 offset:640
    ds_read_b128 a[92:95], v119 offset:640
    s_waitcnt lgkmcnt(6)
    ds_read_b128 a[96:99], v116 offset:768
    ds_read_b128 a[100:103], v117 offset:768
    ds_read_b128 a[104:107], v118 offset:768
    ds_read_b128 a[108:111], v119 offset:768
    ds_read_b128 a[112:115], v116 offset:896
    ds_read_b128 a[116:119], v117 offset:896
    ds_read_b128 a[120:123], v118 offset:896
    ds_read_b128 a[124:127], v119 offset:896
    ds_read_b128 a[128:131], v116 offset:1024
    ds_read_b128 a[132:135], v117 offset:1024
    ds_read_b128 a[136:139], v118 offset:1024
    ds_read_b128 a[140:143], v119 offset:1024
    s_waitcnt lgkmcnt(6)
    s_mov_b64 exec, -1
    s_waitcnt lgkmcnt(0)
    s_add_u32 m0, s39, 0
    s_add_u32 s40, s38, 36864
    buffer_load_dwordx4 v96, s[16:19], s40 offen lds
    s_add_u32 m0, s39, 1024
    s_nop 0
    buffer_load_dwordx4 v97, s[16:19], s40 offen lds
    s_add_u32 m0, s39, 2048
    s_nop 0
    buffer_load_dwordx4 v98, s[16:19], s40 offen lds
    s_add_u32 m0, s39, 3072
    s_nop 0
    buffer_load_dwordx4 v99, s[16:19], s40 offen lds
    s_add_u32 m0, s39, 4096
    s_nop 0
    buffer_load_dwordx4 v100, s[16:19], s40 offen lds
    s_add_u32 m0, s39, 5120
    s_nop 0
    buffer_load_dwordx4 v101, s[16:19], s40 offen lds
    s_add_u32 m0, s39, 6144
    s_nop 0
    buffer_load_dwordx4 v102, s[16:19], s40 offen lds
    s_add_u32 m0, s39, 7168
    s_nop 0
    buffer_load_dwordx4 v103, s[16:19], s40 offen lds
    s_add_u32 m0, s39, 8192
    s_nop 0
    buffer_load_dwordx4 v104, s[16:19], s40 offen lds
    s_add_u32 m0, s39, 9216
    s_nop 0
    buffer_load_dwordx4 v105, s[16:19], s40 offen lds
    s_add_u32 m0, s39, 10240
    s_nop 0
    buffer_load_dwordx4 v106, s[16:19], s40 offen lds
    s_add_u32 m0, s39, 11264
    s_nop 0
    buffer_load_dwordx4 v107, s[16:19], s40 offen lds
    s_add_u32 m0, s39, 12288
    s_nop 0
    buffer_load_dwordx4 v108, s[16:19], s40 offen lds
    s_add_u32 m0, s39, 13312
    s_nop 0
    buffer_load_dwordx4 v109, s[16:19], s40 offen lds
    s_add_u32 m0, s39, 14336
    s_nop 0
    buffer_load_dwordx4 v110, s[16:19], s40 offen lds
    s_add_u32 m0, s39, 15360
    s_nop 0
    buffer_load_dwordx4 v111, s[16:19], s40 offen lds
    s_add_u32 m0, s39, 16384
    s_nop 0
    buffer_load_dwordx4 v112, s[16:19], s40 offen lds
    s_add_u32 m0, s39, 17408
    s_nop 0
    buffer_load_dwordx4 v113, s[16:19], s40 offen lds
    s_waitcnt vmcnt(18)
    s_mov_b32 exec_lo, 0xff00ff00
    s_mov_b32 exec_hi, 0xff00ff00
    ds_read_b128 a[0:3], v116 offset:18432
    ds_read_b128 a[4:7], v117 offset:18432
    ds_read_b128 a[8:11], v118 offset:18432
    ds_read_b128 a[12:15], v119 offset:18432
    ds_read_b128 a[16:19], v116 offset:18560
    ds_read_b128 a[20:23], v117 offset:18560
    ds_read_b128 a[24:27], v118 offset:18560
    ds_read_b128 a[28:31], v119 offset:18560
    ds_read_b128 a[32:35], v116 offset:18688
    ds_read_b128 a[36:39], v117 offset:18688
    ds_read_b128 a[40:43], v118 offset:18688
    ds_read_b128 a[44:47], v119 offset:18688
    s_waitcnt lgkmcnt(6)
    ds_read_b128 a[48:51], v116 offset:18816
    ds_read_b128 a[52:55], v117 offset:18816
    ds_read_b128 a[56:59], v118 offset:18816
    ds_read_b128 a[60:63], v119 offset:18816
    ds_read_b128 a[64:67], v116 offset:18944
    ds_read_b128 a[68:71], v117 offset:18944
    ds_read_b128 a[72:75], v118 offset:18944
    ds_read_b128 a[76:79], v119 offset:18944
    ds_read_b128 a[80:83], v116 offset:19072
    ds_read_b128 a[84:87], v117 offset:19072
    ds_read_b128 a[88:91], v118 offset:19072
    ds_read_b128 a[92:95], v119 offset:19072
    s_waitcnt lgkmcnt(6)
    ds_read_b128 a[96:99], v116 offset:19200
    ds_read_b128 a[100:103], v117 offset:19200
    ds_read_b128 a[104:107], v118 offset:19200
    ds_read_b128 a[108:111], v119 offset:19200
    ds_read_b128 a[112:115], v116 offset:19328
    ds_read_b128 a[116:119], v117 offset:19328
    ds_read_b128 a[120:123], v118 offset:19328
    ds_read_b128 a[124:127], v119 offset:19328
    ds_read_b128 a[128:131], v116 offset:19456
    ds_read_b128 a[132:135], v117 offset:19456
    ds_read_b128 a[136:139], v118 offset:19456
    ds_read_b128 a[140:143], v119 offset:19456
    s_waitcnt lgkmcnt(6)
    s_mov_b64 exec, -1
    s_waitcnt lgkmcnt(0)
    s_add_u32 m0, s39, 18432
    s_add_u32 s40, s38, 55296
    buffer_load_dwordx4 v96, s[16:19], s40 offen lds
    s_add_u32 m0, s39, 19456
    s_nop 0
    buffer_load_dwordx4 v97, s[16:19], s40 offen lds
    s_add_u32 m0, s39, 20480
    s_nop 0
    buffer_load_dwordx4 v98, s[16:19], s40 offen lds
    s_add_u32 m0, s39, 21504
    s_nop 0
    buffer_load_dwordx4 v99, s[16:19], s40 offen lds
    s_add_u32 m0, s39, 22528
    s_nop 0
    buffer_load_dwordx4 v100, s[16:19], s40 offen lds
    s_add_u32 m0, s39, 23552
    s_nop 0
    buffer_load_dwordx4 v101, s[16:19], s40 offen lds
    s_add_u32 m0, s39, 24576
    s_nop 0
    buffer_load_dwordx4 v102, s[16:19], s40 offen lds
    s_add_u32 m0, s39, 25600
    s_nop 0
    buffer_load_dwordx4 v103, s[16:19], s40 offen lds
    s_add_u32 m0, s39, 26624
    s_nop 0
    buffer_load_dwordx4 v104, s[16:19], s40 offen lds
    s_add_u32 m0, s39, 27648
    s_nop 0
    buffer_load_dwordx4 v105, s[16:19], s40 offen lds
    s_add_u32 m0, s39, 28672
    s_nop 0
    buffer_load_dwordx4 v106, s[16:19], s40 offen lds
    s_add_u32 m0, s39, 29696
    s_nop 0
    buffer_load_dwordx4 v107, s[16:19], s40 offen lds
    s_add_u32 m0, s39, 30720
    s_nop 0
    buffer_load_dwordx4 v108, s[16:19], s40 offen lds
    s_add_u32 m0, s39, 31744
    s_nop 0
    buffer_load_dwordx4 v109, s[16:19], s40 offen lds
    s_add_u32 m0, s39, 32768
    s_nop 0
    buffer_load_dwordx4 v110, s[16:19], s40 offen lds
    s_add_u32 m0, s39, 33792
    s_nop 0
    buffer_load_dwordx4 v111, s[16:19], s40 offen lds
    s_add_u32 m0, s39, 34816
    s_nop 0
    buffer_load_dwordx4 v112, s[16:19], s40 offen lds
    s_add_u32 m0, s39, 35840
    s_nop 0
    buffer_load_dwordx4 v113, s[16:19], s40 offen lds
    s_waitcnt vmcnt(18)
    s_mov_b32 exec_lo, 0x00ff00ff
    s_mov_b32 exec_hi, 0x00ff00ff
    ds_read_b128 a[144:147], v116 offset:0
    ds_read_b128 a[148:151], v117 offset:0
    ds_read_b128 a[152:155], v118 offset:0
    ds_read_b128 a[156:159], v119 offset:0
    ds_read_b128 a[160:163], v116 offset:128
    ds_read_b128 a[164:167], v117 offset:128
    ds_read_b128 a[168:171], v118 offset:128
    ds_read_b128 a[172:175], v119 offset:128
    ds_read_b128 a[176:179], v116 offset:256
    ds_read_b128 a[180:183], v117 offset:256
    ds_read_b128 a[184:187], v118 offset:256
    ds_read_b128 a[188:191], v119 offset:256
    s_waitcnt lgkmcnt(6)
    ds_read_b128 a[192:195], v116 offset:384
    ds_read_b128 a[196:199], v117 offset:384
    ds_read_b128 a[200:203], v118 offset:384
    ds_read_b128 a[204:207], v119 offset:384
    ds_read_b128 a[208:211], v116 offset:512
    ds_read_b128 a[212:215], v117 offset:512
    ds_read_b128 a[216:219], v118 offset:512
    ds_read_b128 a[220:223], v119 offset:512
    ds_read_b128 a[224:227], v116 offset:640
    ds_read_b128 a[228:231], v117 offset:640
    ds_read_b128 a[232:235], v118 offset:640
    ds_read_b128 a[236:239], v119 offset:640
    s_waitcnt lgkmcnt(6)
    ds_read_b128 a[240:243], v116 offset:768
    ds_read_b128 a[244:247], v117 offset:768
    ds_read_b128 a[248:251], v118 offset:768
    ds_read_b128 a[252:255], v119 offset:768
    ds_read_b128 v[64:67], v116 offset:896
    ds_read_b128 v[68:71], v117 offset:896
    ds_read_b128 v[72:75], v118 offset:896
    ds_read_b128 v[76:79], v119 offset:896
    ds_read_b128 v[80:83], v116 offset:1024
    ds_read_b128 v[84:87], v117 offset:1024
    ds_read_b128 v[88:91], v118 offset:1024
    ds_read_b128 v[92:95], v119 offset:1024
    s_waitcnt lgkmcnt(6)
    s_mov_b64 exec, -1
    s_waitcnt lgkmcnt(0)
    s_waitcnt vmcnt(0)
    s_mov_b32 exec_lo, 0xff00ff00
    s_mov_b32 exec_hi, 0xff00ff00
    ds_read_b128 a[144:147], v116 offset:18432
    ds_read_b128 a[148:151], v117 offset:18432
    ds_read_b128 a[152:155], v118 offset:18432
    ds_read_b128 a[156:159], v119 offset:18432
    ds_read_b128 a[160:163], v116 offset:18560
    ds_read_b128 a[164:167], v117 offset:18560
    ds_read_b128 a[168:171], v118 offset:18560
    ds_read_b128 a[172:175], v119 offset:18560
    ds_read_b128 a[176:179], v116 offset:18688
    ds_read_b128 a[180:183], v117 offset:18688
    ds_read_b128 a[184:187], v118 offset:18688
    ds_read_b128 a[188:191], v119 offset:18688
    s_waitcnt lgkmcnt(6)
    ds_read_b128 a[192:195], v116 offset:18816
    ds_read_b128 a[196:199], v117 offset:18816
    ds_read_b128 a[200:203], v118 offset:18816
    ds_read_b128 a[204:207], v119 offset:18816
    ds_read_b128 a[208:211], v116 offset:18944
    ds_read_b128 a[212:215], v117 offset:18944
    ds_read_b128 a[216:219], v118 offset:18944
    ds_read_b128 a[220:223], v119 offset:18944
    ds_read_b128 a[224:227], v116 offset:19072
    ds_read_b128 a[228:231], v117 offset:19072
    ds_read_b128 a[232:235], v118 offset:19072
    ds_read_b128 a[236:239], v119 offset:19072
    s_waitcnt lgkmcnt(6)
    ds_read_b128 a[240:243], v116 offset:19200
    ds_read_b128 a[244:247], v117 offset:19200
    ds_read_b128 a[248:251], v118 offset:19200
    ds_read_b128 a[252:255], v119 offset:19200
    ds_read_b128 v[64:67], v116 offset:19328
    ds_read_b128 v[68:71], v117 offset:19328
    ds_read_b128 v[72:75], v118 offset:19328
    ds_read_b128 v[76:79], v119 offset:19328
    ds_read_b128 v[80:83], v116 offset:19456
    ds_read_b128 v[84:87], v117 offset:19456
    ds_read_b128 v[88:91], v118 offset:19456
    ds_read_b128 v[92:95], v119 offset:19456
    s_waitcnt lgkmcnt(6)
    s_mov_b64 exec, -1
    s_waitcnt lgkmcnt(0)
    s_barrier
    s_add_u32 m0, s46, 0
    s_nop 0
    buffer_load_dwordx4 v3, s[20:23], s44 offen  lds
    s_add_u32 m0, s46, 1024
    s_add_u32 s44, s44, s45
    buffer_load_dwordx4 v3, s[20:23], s44 offen  lds
    s_add_u32 m0, s46, 2048
    s_add_u32 s44, s44, s45
    buffer_load_dwordx4 v3, s[20:23], s44 offen  lds
    s_add_u32 m0, s46, 3072
    s_add_u32 s44, s44, s45
    buffer_load_dwordx4 v3, s[20:23], s44 offen  lds
    s_add_u32 s44, s44, s57
    s_add_u32 s46, s46, 16384
    s_and_b32 s46, s46, 131071
    s_add_u32 m0, s46, 0
    s_nop 0
    buffer_load_dwordx4 v3, s[20:23], s44 offen  lds
    s_add_u32 m0, s46, 1024
    s_add_u32 s44, s44, s45
    buffer_load_dwordx4 v3, s[20:23], s44 offen  lds
    s_add_u32 m0, s46, 2048
    s_add_u32 s44, s44, s45
    buffer_load_dwordx4 v3, s[20:23], s44 offen  lds
    s_add_u32 m0, s46, 3072
    s_add_u32 s44, s44, s45
    buffer_load_dwordx4 v3, s[20:23], s44 offen  lds
    s_add_u32 s44, s44, s57
    s_add_u32 s46, s46, 16384
    s_and_b32 s46, s46, 131071
    s_add_u32 m0, s46, 0
    s_nop 0
    buffer_load_dwordx4 v3, s[20:23], s44 offen  lds
    s_add_u32 m0, s46, 1024
    s_add_u32 s44, s44, s45
    buffer_load_dwordx4 v3, s[20:23], s44 offen  lds
    s_add_u32 m0, s46, 2048
    s_add_u32 s44, s44, s45
    buffer_load_dwordx4 v3, s[20:23], s44 offen  lds
    s_add_u32 m0, s46, 3072
    s_add_u32 s44, s44, s45
    buffer_load_dwordx4 v3, s[20:23], s44 offen  lds
    s_add_u32 s44, s44, s57
    s_add_u32 s46, s46, 16384
    s_and_b32 s46, s46, 131071
    s_add_u32 m0, s46, 0
    s_nop 0
    buffer_load_dwordx4 v3, s[20:23], s44 offen  lds
    s_add_u32 m0, s46, 1024
    s_add_u32 s44, s44, s45
    buffer_load_dwordx4 v3, s[20:23], s44 offen  lds
    s_add_u32 m0, s46, 2048
    s_add_u32 s44, s44, s45
    buffer_load_dwordx4 v3, s[20:23], s44 offen  lds
    s_add_u32 m0, s46, 3072
    s_add_u32 s44, s44, s45
    buffer_load_dwordx4 v3, s[20:23], s44 offen  lds
    s_add_u32 s44, s44, s57
    s_add_u32 s46, s46, 16384
    s_and_b32 s46, s46, 131071
    s_add_u32 m0, s46, 0
    s_nop 0
    buffer_load_dwordx4 v3, s[20:23], s44 offen  lds
    s_add_u32 m0, s46, 1024
    s_add_u32 s44, s44, s45
    buffer_load_dwordx4 v3, s[20:23], s44 offen  lds
    s_add_u32 m0, s46, 2048
    s_add_u32 s44, s44, s45
    buffer_load_dwordx4 v3, s[20:23], s44 offen  lds
    s_add_u32 m0, s46, 3072
    s_add_u32 s44, s44, s45
    buffer_load_dwordx4 v3, s[20:23], s44 offen  lds
    s_add_u32 s44, s44, s57
    s_add_u32 s46, s46, 16384
    s_and_b32 s46, s46, 131071
    v_bfe_u32 v19, v18, 4, 1
    v_lshrrev_b32 v20, 5, v18
    v_and_b32 v21, 15, v18
    v_lshlrev_b32 v12, 10, v19
    v_lshl_add_u32 v12, v20, 8, v12
    v_lshl_add_u32 v12, v21, 4, v12
    v_bfe_u32 v21, v18, 3, 1
    v_and_b32 v22, 3, v18
    v_lshl_add_u32 v21, v21, 2, v22
    v_lshlrev_b32 v13, 8, v21
    v_bfe_u32 v21, v18, 2, 1
    v_lshl_add_u32 v21, v21, 1, v19
    v_lshl_add_u32 v13, v21, 6, v13
    v_lshl_add_u32 v13, v20, 4, v13
    s_lshl_b32 s38, s13, 13
    s_add_u32 s38, s38, 131072
    v_add_u32 v13, s38, v13
    v_lshlrev_b32 v14, 4, v18
    v_add_u32 v15, s38, v14
    s_mov_b32 s47, 0
    s_mov_b32 s56, 0
    s_waitcnt vmcnt(0)
    s_barrier
    s_mov_b32 s58, 0xf0000000
L_g1_blk:
    s_cmp_eq_u32 s47, s51
    s_cbranch_scc0 L_g1_ng
    s_lshl_b32 s38, s13, 13
    s_add_u32 m0, s38, 131072
    v_lshrrev_b32 v20, 5, v18
    v_lshl_add_u32 v20, v20, 4, s38
    buffer_load_dwordx4 v14, s[52:55], 0 offen lds
    buffer_load_dwordx4 v14, s[52:55], 0 offen offset:1024 lds
    v_add_u32 v20, 131072, v20
    s_waitcnt vmcnt(0)
    ds_read_b128 v[96:99], v20 offset:0
    ds_read_b128 v[100:103], v20 offset:32
    ds_read_b128 v[104:107], v20 offset:64
    ds_read_b128 v[108:111], v20 offset:96
    ds_read_b128 v[112:115], v20 offset:128
    ds_read_b128 v[116:119], v20 offset:160
    ds_read_b128 v[120:123], v20 offset:192
    ds_read_b128 v[124:127], v20 offset:224
    ds_read_b128 v[128:131], v20 offset:256
    ds_read_b128 v[132:135], v20 offset:288
    ds_read_b128 v[136:139], v20 offset:320
    ds_read_b128 v[140:143], v20 offset:352
    s_waitcnt lgkmcnt(0)
    ds_read_b128 v[144:147], v20 offset:384
    ds_read_b128 v[148:151], v20 offset:416
    ds_read_b128 v[152:155], v20 offset:448
    ds_read_b128 v[156:159], v20 offset:480
    ds_read_b128 v[160:163], v20 offset:512
    ds_read_b128 v[164:167], v20 offset:544
    ds_read_b128 v[168:171], v20 offset:576
    ds_read_b128 v[172:175], v20 offset:608
    ds_read_b128 v[176:179], v20 offset:640
    ds_read_b128 v[180:183], v20 offset:672
    ds_read_b128 v[184:187], v20 offset:704
    ds_read_b128 v[188:191], v20 offset:736
    s_waitcnt lgkmcnt(0)
    ds_read_b128 v[192:195], v20 offset:768
    ds_read_b128 v[196:199], v20 offset:800
    ds_read_b128 v[200:203], v20 offset:832
    ds_read_b128 v[204:207], v20 offset:864
    ds_read_b128 v[208:211], v20 offset:896
    ds_read_b128 v[212:215], v20 offset:928
    ds_read_b128 v[216:219], v20 offset:960
    ds_read_b128 v[220:223], v20 offset:992
    ds_read_b128 v[32:35], v20 offset:1024
    ds_read_b128 v[36:39], v20 offset:1056
    ds_read_b128 v[40:43], v20 offset:1088
    ds_read_b128 v[44:47], v20 offset:1120
    s_waitcnt lgkmcnt(0)
    v_mfma_f32_32x32x16_bf16 v[224:239], v[96:99], a[0:3], 0
    v_mfma_f32_32x32x16_bf16 v[224:239], v[100:103], a[4:7], v[224:239]
    v_mfma_f32_32x32x16_bf16 v[224:239], v[104:107], a[8:11], v[224:239]
    v_mfma_f32_32x32x16_bf16 v[224:239], v[108:111], a[12:15], v[224:239]
    v_mfma_f32_32x32x16_bf16 v[224:239], v[112:115], a[16:19], v[224:239]
    v_mfma_f32_32x32x16_bf16 v[224:239], v[116:119], a[20:23], v[224:239]
    v_mfma_f32_32x32x16_bf16 v[224:239], v[120:123], a[24:27], v[224:239]
    v_mfma_f32_32x32x16_bf16 v[224:239], v[124:127], a[28:31], v[224:239]
    v_mfma_f32_32x32x16_bf16 v[224:239], v[128:131], a[32:35], v[224:239]
    v_mfma_f32_32x32x16_bf16 v[224:239], v[132:135], a[36:39], v[224:239]
    v_mfma_f32_32x32x16_bf16 v[224:239], v[136:139], a[40:43], v[224:239]
    v_mfma_f32_32x32x16_bf16 v[224:239], v[140:143], a[44:47], v[224:239]
    v_mfma_f32_32x32x16_bf16 v[224:239], v[144:147], a[48:51], v[224:239]
    v_mfma_f32_32x32x16_bf16 v[224:239], v[148:151], a[52:55], v[224:239]
    v_mfma_f32_32x32x16_bf16 v[224:239], v[152:155], a[56:59], v[224:239]
    v_mfma_f32_32x32x16_bf16 v[224:239], v[156:159], a[60:63], v[224:239]
    v_mfma_f32_32x32x16_bf16 v[224:239], v[160:163], a[64:67], v[224:239]
    v_mfma_f32_32x32x16_bf16 v[224:239], v[164:167], a[68:71], v[224:239]
    v_mfma_f32_32x32x16_bf16 v[224:239], v[168:171], a[72:75], v[224:239]
    v_mfma_f32_32x32x16_bf16 v[224:239], v[172:175], a[76:79], v[224:239]
    v_mfma_f32_32x32x16_bf16 v[224:239], v[176:179], a[80:83], v[224:239]
    v_mfma_f32_32x32x16_bf16 v[224:239], v[180:183], a[84:87], v[224:239]
    v_mfma_f32_32x32x16_bf16 v[224:239], v[184:187], a[88:91], v[224:239]
    v_mfma_f32_32x32x16_bf16 v[224:239], v[188:191], a[92:95], v[224:239]
    v_mfma_f32_32x32x16_bf16 v[224:239], v[192:195], a[96:99], v[224:239]
    v_mfma_f32_32x32x16_bf16 v[224:239], v[196:199], a[100:103], v[224:239]
    v_mfma_f32_32x32x16_bf16 v[224:239], v[200:203], a[104:107], v[224:239]
    v_mfma_f32_32x32x16_bf16 v[224:239], v[204:207], a[108:111], v[224:239]
    v_mfma_f32_32x32x16_bf16 v[224:239], v[208:211], a[112:115], v[224:239]
    v_mfma_f32_32x32x16_bf16 v[224:239], v[212:215], a[116:119], v[224:239]
    v_mfma_f32_32x32x16_bf16 v[224:239], v[216:219], a[120:123], v[224:239]
    v_mfma_f32_32x32x16_bf16 v[224:239], v[220:223], a[124:127], v[224:239]
    v_mfma_f32_32x32x16_bf16 v[224:239], v[32:35], a[128:131], v[224:239]
    v_mfma_f32_32x32x16_bf16 v[224:239], v[36:39], a[132:135], v[224:239]
    v_mfma_f32_32x32x16_bf16 v[224:239], v[40:43], a[136:139], v[224:239]
    v_mfma_f32_32x32x16_bf16 v[224:239], v[44:47], a[140:143], v[224:239]
    v_mfma_f32_32x32x16_bf16 v[240:255], v[96:99], a[144:147], 0
    v_mfma_f32_32x32x16_bf16 v[240:255], v[100:103], a[148:151], v[240:255]
    v_mfma_f32_32x32x16_bf16 v[240:255], v[104:107], a[152:155], v[240:255]
    v_mfma_f32_32x32x16_bf16 v[240:255], v[108:111], a[156:159], v[240:255]
    v_mfma_f32_32x32x16_bf16 v[240:255], v[112:115], a[160:163], v[240:255]
    v_mfma_f32_32x32x16_bf16 v[240:255], v[116:119], a[164:167], v[240:255]
    v_mfma_f32_32x32x16_bf16 v[240:255], v[120:123], a[168:171], v[240:255]
    v_mfma_f32_32x32x16_bf16 v[240:255], v[124:127], a[172:175], v[240:255]
    v_mfma_f32_32x32x16_bf16 v[240:255], v[128:131], a[176:179], v[240:255]
    v_mfma_f32_32x32x16_bf16 v[240:255], v[132:135], a[180:183], v[240:255]
    v_mfma_f32_32x32x16_bf16 v[240:255], v[136:139], a[184:187], v[240:255]
    v_mfma_f32_32x32x16_bf16 v[240:255], v[140:143], a[188:191], v[240:255]
    v_mfma_f32_32x32x16_bf16 v[240:255], v[144:147], a[192:195], v[240:255]
    v_mfma_f32_32x32x16_bf16 v[240:255], v[148:151], a[196:199], v[240:255]
    v_mfma_f32_32x32x16_bf16 v[240:255], v[152:155], a[200:203], v[240:255]
    v_mfma_f32_32x32x16_bf16 v[240:255], v[156:159], a[204:207], v[240:255]
    v_mfma_f32_32x32x16_bf16 v[240:255], v[160:163], a[208:211], v[240:255]
    v_mfma_f32_32x32x16_bf16 v[240:255], v[164:167], a[212:215], v[240:255]
    v_mfma_f32_32x32x16_bf16 v[240:255], v[168:171], a[216:219], v[240:255]
    v_mfma_f32_32x32x16_bf16 v[240:255], v[172:175], a[220:223], v[240:255]
    v_mfma_f32_32x32x16_bf16 v[240:255], v[176:179], a[224:227], v[240:255]
    v_mfma_f32_32x32x16_bf16 v[240:255], v[180:183], a[228:231], v[240:255]
    v_mfma_f32_32x32x16_bf16 v[240:255], v[184:187], a[232:235], v[240:255]
    v_mfma_f32_32x32x16_bf16 v[240:255], v[188:191], a[236:239], v[240:255]
    v_mfma_f32_32x32x16_bf16 v[240:255], v[192:195], a[240:243], v[240:255]
    v_mfma_f32_32x32x16_bf16 v[240:255], v[196:199], a[244:247], v[240:255]
    v_mfma_f32_32x32x16_bf16 v[240:255], v[200:203], a[248:251], v[240:255]
    v_mfma_f32_32x32x16_bf16 v[240:255], v[204:207], a[252:255], v[240:255]
    v_mfma_f32_32x32x16_bf16 v[240:255], v[208:211], v[64:67], v[240:255]
    v_mfma_f32_32x32x16_bf16 v[240:255], v[212:215], v[68:71], v[240:255]
    v_mfma_f32_32x32x16_bf16 v[240:255], v[216:219], v[72:75], v[240:255]
    v_mfma_f32_32x32x16_bf16 v[240:255], v[220:223], v[76:79], v[240:255]
    v_mfma_f32_32x32x16_bf16 v[240:255], v[32:35], v[80:83], v[240:255]
    v_mfma_f32_32x32x16_bf16 v[240:255], v[36:39], v[84:87], v[240:255]
    v_mfma_f32_32x32x16_bf16 v[240:255], v[40:43], v[88:91], v[240:255]
    v_mfma_f32_32x32x16_bf16 v[240:255], v[44:47], v[92:95], v[240:255]
    v_mul_f32 v21, 0x3fb8aa3b, v224
    v_exp_f32 v22, v21
    v_exp_f32_e64 v21, -v21
    v_add_f32 v22, 1.0, v22
    v_add_f32 v21, 1.0, v21
    v_rcp_f32 v16, v22
    v_rcp_f32 v23, v21
    s_nop 4
    v_mul_f32 v21, 0x3fb8aa3b, v240
    v_exp_f32 v22, v21
    v_exp_f32_e64 v21, -v21
    v_add_f32 v22, 1.0, v22
    v_add_f32 v21, 1.0, v21
    v_rcp_f32 v17, v22
    v_rcp_f32 v24, v21
    s_cmp_eq_u32 s14, 0
    s_cbranch_scc0 Lng_9
    s_lshl_b32 s38, s12, 2
    s_add_u32 s38, s38, s13
    s_lshl_b32 s38, s38, 8
    s_add_u32 s38, s38, 121634816
    v_and_b32 v19, 31, v18
    v_lshlrev_b32 v19, 2, v19
    buffer_store_dword v23, v19, s[4:7], s38 offen sc1
    buffer_store_dword v24, v19, s[4:7], s38 offen offset:128 sc1
    s_waitcnt vmcnt(0)
Lng_9:
L_g1_ng:
    s_add_u32 s49, s47, s63
    s_cmp_ge_u32 s49, 7
    s_cselect_b32 s41, 7, 0
    s_sub_u32 s49, s49, s41
    s_mul_i32 s49, s49, 24
    s_add_u32 s49, s49, s14
    s_add_u32 s49, s49, s60
    s_cmp_ge_u32 s49, 96
    s_cbranch_scc1 L_g1_glu
    v_bfe_u32 v19, v18, 2, 2
    v_lshrrev_b32 v20, 5, v18
    v_lshl_add_u32 v20, v20, 3, v19
    v_lshlrev_b32 v20, 8, v20
    v_bfe_u32 v21, v18, 4, 1
    v_lshl_add_u32 v20, v21, 5, v20
    v_and_b32 v21, 3, v18
    v_lshl_add_u32 v20, v21, 3, v20
    v_xor_b32 v21, 0, v19
    v_lshl_add_u32 v4, v21, 6, v20
    v_xor_b32 v21, 1, v19
    v_lshl_add_u32 v5, v21, 6, v20
    v_xor_b32 v21, 2, v19
    v_lshl_add_u32 v6, v21, 6, v20
    v_xor_b32 v21, 3, v19
    v_lshl_add_u32 v7, v21, 6, v20
    v_add_u32 v8, s56, v4
    v_add_u32 v9, s56, v5
    v_add_u32 v10, s56, v6
    v_add_u32 v11, s56, v7
    ds_read_b64_tr_b16 v[32:33], v8 offset:0
    ds_read_b64_tr_b16 v[34:35], v8 offset:1024
    ds_read_b64_tr_b16 v[36:37], v9 offset:0
    ds_read_b64_tr_b16 v[38:39], v9 offset:1024
    ds_read_b64_tr_b16 v[40:41], v10 offset:0
    ds_read_b64_tr_b16 v[42:43], v10 offset:1024
    ds_read_b64_tr_b16 v[44:45], v11 offset:0
    ds_read_b64_tr_b16 v[46:47], v11 offset:1024
    s_waitcnt lgkmcnt(6)
    v_mfma_f32_32x32x16_bf16 v[96:111], v[32:35], a[0:3], 0
    ds_read_b64_tr_b16 v[48:49], v8 offset:4096
    s_waitcnt vmcnt(24)
    s_barrier
    v_mfma_f32_32x32x16_bf16 v[160:175], v[32:35], a[144:147], 0
    ds_read_b64_tr_b16 v[50:51], v8 offset:5120
    s_add_u32 m0, s46, 0
    s_nop 0
    buffer_load_dwordx4 v3, s[20:23], s44 offen  lds
    s_waitcnt lgkmcnt(6)
    v_mfma_f32_32x32x16_bf16 v[112:127], v[36:39], a[0:3], 0
    ds_read_b64_tr_b16 v[52:53], v9 offset:4096
    s_add_u32 m0, s46, 1024
    s_add_u32 s44, s44, s45
    buffer_load_dwordx4 v3, s[20:23], s44 offen  lds
    v_mfma_f32_32x32x16_bf16 v[176:191], v[36:39], a[144:147], 0
    ds_read_b64_tr_b16 v[54:55], v9 offset:5120
    s_add_u32 m0, s46, 2048
    s_add_u32 s44, s44, s45
    buffer_load_dwordx4 v3, s[20:23], s44 offen  lds
    s_waitcnt lgkmcnt(6)
    v_mfma_f32_32x32x16_bf16 v[128:143], v[40:43], a[0:3], 0
    ds_read_b64_tr_b16 v[56:57], v10 offset:4096
    s_add_u32 m0, s46, 3072
    s_add_u32 s44, s44, s45
    buffer_load_dwordx4 v3, s[20:23], s44 offen  lds
    v_mfma_f32_32x32x16_bf16 v[192:207], v[40:43], a[144:147], 0
    ds_read_b64_tr_b16 v[58:59], v10 offset:5120
    s_add_u32 s44, s44, s57
    s_add_u32 s46, s46, 16384
    s_and_b32 s46, s46, 131071
    s_waitcnt lgkmcnt(6)
    v_mfma_f32_32x32x16_bf16 v[144:159], v[44:47], a[0:3], 0
    ds_read_b64_tr_b16 v[60:61], v11 offset:4096
    s_add_u32 s56, s56, 16384
    s_and_b32 s56, s56, 131071
    v_mfma_f32_32x32x16_bf16 v[208:223], v[44:47], a[144:147], 0
    ds_read_b64_tr_b16 v[62:63], v11 offset:5120
    s_waitcnt lgkmcnt(6)
    v_mfma_f32_32x32x16_bf16 v[96:111], v[48:51], a[4:7], v[96:111]
    ds_read_b64_tr_b16 v[32:33], v8 offset:8192
    v_mfma_f32_32x32x16_bf16 v[160:175], v[48:51], a[148:151], v[160:175]
    ds_read_b64_tr_b16 v[34:35], v8 offset:9216
    s_waitcnt lgkmcnt(6)
    v_mfma_f32_32x32x16_bf16 v[112:127], v[52:55], a[4:7], v[112:127]
    ds_read_b64_tr_b16 v[36:37], v9 offset:8192
    v_mfma_f32_32x32x16_bf16 v[176:191], v[52:55], a[148:151], v[176:191]
    ds_read_b64_tr_b16 v[38:39], v9 offset:9216
    s_waitcnt lgkmcnt(6)
    v_mfma_f32_32x32x16_bf16 v[128:143], v[56:59], a[4:7], v[128:143]
    ds_read_b64_tr_b16 v[40:41], v10 offset:8192
    v_mfma_f32_32x32x16_bf16 v[192:207], v[56:59], a[148:151], v[192:207]
    ds_read_b64_tr_b16 v[42:43], v10 offset:9216
    s_waitcnt lgkmcnt(6)
    v_mfma_f32_32x32x16_bf16 v[144:159], v[60:63], a[4:7], v[144:159]
    ds_read_b64_tr_b16 v[44:45], v11 offset:8192
    v_mfma_f32_32x32x16_bf16 v[208:223], v[60:63], a[148:151], v[208:223]
    ds_read_b64_tr_b16 v[46:47], v11 offset:9216
    s_waitcnt lgkmcnt(6)
    v_mfma_f32_32x32x16_bf16 v[96:111], v[32:35], a[8:11], v[96:111]
    ds_read_b64_tr_b16 v[48:49], v8 offset:12288
    v_mfma_f32_32x32x16_bf16 v[160:175], v[32:35], a[152:155], v[160:175]
    ds_read_b64_tr_b16 v[50:51], v8 offset:13312
    s_waitcnt lgkmcnt(6)
    v_add_u32 v8, s56, v4
    v_mfma_f32_32x32x16_bf16 v[112:127], v[36:39], a[8:11], v[112:127]
    ds_read_b64_tr_b16 v[52:53], v9 offset:12288
    v_mfma_f32_32x32x16_bf16 v[176:191], v[36:39], a[152:155], v[176:191]
    ds_read_b64_tr_b16 v[54:55], v9 offset:13312
    s_waitcnt lgkmcnt(6)
    v_add_u32 v9, s56, v5
    v_mfma_f32_32x32x16_bf16 v[128:143], v[40:43], a[8:11], v[128:143]
    ds_read_b64_tr_b16 v[56:57], v10 offset:12288
    v_mfma_f32_32x32x16_bf16 v[192:207], v[40:43], a[152:155], v[192:207]
    ds_read_b64_tr_b16 v[58:59], v10 offset:13312
    s_waitcnt lgkmcnt(6)
    v_add_u32 v10, s56, v6
    v_mfma_f32_32x32x16_bf16 v[144:159], v[44:47], a[8:11], v[144:159]
    ds_read_b64_tr_b16 v[60:61], v11 offset:12288
    v_mfma_f32_32x32x16_bf16 v[208:223], v[44:47], a[152:155], v[208:223]
    ds_read_b64_tr_b16 v[62:63], v11 offset:13312
    s_waitcnt lgkmcnt(6)
    v_add_u32 v11, s56, v7
    v_mfma_f32_32x32x16_bf16 v[96:111], v[48:51], a[12:15], v[96:111]
    ds_read_b64_tr_b16 v[32:33], v8 offset:0
    v_mfma_f32_32x32x16_bf16 v[160:175], v[48:51], a[156:159], v[160:175]
    ds_read_b64_tr_b16 v[34:35], v8 offset:1024
    s_waitcnt lgkmcnt(6)
    v_mfma_f32_32x32x16_bf16 v[112:127], v[52:55], a[12:15], v[112:127]
    ds_read_b64_tr_b16 v[36:37], v9 offset:0
    v_mfma_f32_32x32x16_bf16 v[176:191], v[52:55], a[156:159], v[176:191]
    ds_read_b64_tr_b16 v[38:39], v9 offset:1024
    s_waitcnt lgkmcnt(6)
    v_mfma_f32_32x32x16_bf16 v[128:143], v[56:59], a[12:15], v[128:143]
    ds_read_b64_tr_b16 v[40:41], v10 offset:0
    v_mfma_f32_32x32x16_bf16 v[192:207], v[56:59], a[156:159], v[192:207]
    ds_read_b64_tr_b16 v[42:43], v10 offset:1024
    s_waitcnt lgkmcnt(6)
    v_mfma_f32_32x32x16_bf16 v[144:159], v[60:63], a[12:15], v[144:159]
    ds_read_b64_tr_b16 v[44:45], v11 offset:0
    v_mfma_f32_32x32x16_bf16 v[208:223], v[60:63], a[156:159], v[208:223]
    ds_read_b64_tr_b16 v[46:47], v11 offset:1024
    s_waitcnt lgkmcnt(6)
    v_mfma_f32_32x32x16_bf16 v[96:111], v[32:35], a[16:19], v[96:111]
    ds_read_b64_tr_b16 v[48:49], v8 offset:4096
    s_waitcnt vmcnt(24)
    s_barrier
    v_mfma_f32_32x32x16_bf16 v[160:175], v[32:35], a[160:163], v[160:175]
    ds_read_b64_tr_b16 v[50:51], v8 offset:5120
    s_add_u32 m0, s46, 0
    s_nop 0
    buffer_load_dwordx4 v3, s[20:23], s44 offen  lds
    s_waitcnt lgkmcnt(6)
    v_mfma_f32_32x32x16_bf16 v[112:127], v[36:39], a[16:19], v[112:127]
    ds_read_b64_tr_b16 v[52:53], v9 offset:4096
    s_add_u32 m0, s46, 1024
    s_add_u32 s44, s44, s45
    buffer_load_dwordx4 v3, s[20:23], s44 offen  lds
    v_mfma_f32_32x32x16_bf16 v[176:191], v[36:39], a[160:163], v[176:191]
    ds_read_b64_tr_b16 v[54:55], v9 offset:5120
    s_add_u32 m0, s46, 2048
    s_add_u32 s44, s44, s45
    buffer_load_dwordx4 v3, s[20:23], s44 offen  lds
    s_waitcnt lgkmcnt(6)
    v_mfma_f32_32x32x16_bf16 v[128:143], v[40:43], a[16:19], v[128:143]
    ds_read_b64_tr_b16 v[56:57], v10 offset:4096
    s_add_u32 m0, s46, 3072
    s_add_u32 s44, s44, s45
    buffer_load_dwordx4 v3, s[20:23], s44 offen  lds
    v_mfma_f32_32x32x16_bf16 v[192:207], v[40:43], a[160:163], v[192:207]
    ds_read_b64_tr_b16 v[58:59], v10 offset:5120
    s_add_u32 s44, s44, s57
    s_add_u32 s46, s46, 16384
    s_and_b32 s46, s46, 131071
    s_waitcnt lgkmcnt(6)
    v_mfma_f32_32x32x16_bf16 v[144:159], v[44:47], a[16:19], v[144:159]
    ds_read_b64_tr_b16 v[60:61], v11 offset:4096
    s_add_u32 s56, s56, 16384
    s_and_b32 s56, s56, 131071
    v_mfma_f32_32x32x16_bf16 v[208:223], v[44:47], a[160:163], v[208:223]
    ds_read_b64_tr_b16 v[62:63], v11 offset:5120
    s_waitcnt lgkmcnt(6)
    v_mfma_f32_32x32x16_bf16 v[96:111], v[48:51], a[20:23], v[96:111]
    ds_read_b64_tr_b16 v[32:33], v8 offset:8192
    v_mfma_f32_32x32x16_bf16 v[160:175], v[48:51], a[164:167], v[160:175]
    ds_read_b64_tr_b16 v[34:35], v8 offset:9216
    s_waitcnt lgkmcnt(6)
    v_mfma_f32_32x32x16_bf16 v[112:127], v[52:55], a[20:23], v[112:127]
    ds_read_b64_tr_b16 v[36:37], v9 offset:8192
    v_mfma_f32_32x32x16_bf16 v[176:191], v[52:55], a[164:167], v[176:191]
    ds_read_b64_tr_b16 v[38:39], v9 offset:9216
    s_waitcnt lgkmcnt(6)
    v_mfma_f32_32x32x16_bf16 v[128:143], v[56:59], a[20:23], v[128:143]
    ds_read_b64_tr_b16 v[40:41], v10 offset:8192
    v_mfma_f32_32x32x16_bf16 v[192:207], v[56:59], a[164:167], v[192:207]
    ds_read_b64_tr_b16 v[42:43], v10 offset:9216
    s_waitcnt lgkmcnt(6)
    v_mfma_f32_32x32x16_bf16 v[144:159], v[60:63], a[20:23], v[144:159]
    ds_read_b64_tr_b16 v[44:45], v11 offset:8192
    v_mfma_f32_32x32x16_bf16 v[208:223], v[60:63], a[164:167], v[208:223]
    ds_read_b64_tr_b16 v[46:47], v11 offset:9216
    s_waitcnt lgkmcnt(6)
    v_mfma_f32_32x32x16_bf16 v[96:111], v[32:35], a[24:27], v[96:111]
    ds_read_b64_tr_b16 v[48:49], v8 offset:12288
    v_mfma_f32_32x32x16_bf16 v[160:175], v[32:35], a[168:171], v[160:175]
    ds_read_b64_tr_b16 v[50:51], v8 offset:13312
    s_waitcnt lgkmcnt(6)
    v_add_u32 v8, s56, v4
    v_mfma_f32_32x32x16_bf16 v[112:127], v[36:39], a[24:27], v[112:127]
    ds_read_b64_tr_b16 v[52:53], v9 offset:12288
    v_mfma_f32_32x32x16_bf16 v[176:191], v[36:39], a[168:171], v[176:191]
    ds_read_b64_tr_b16 v[54:55], v9 offset:13312
    s_waitcnt lgkmcnt(6)
    v_add_u32 v9, s56, v5
    v_mfma_f32_32x32x16_bf16 v[128:143], v[40:43], a[24:27], v[128:143]
    ds_read_b64_tr_b16 v[56:57], v10 offset:12288
    v_mfma_f32_32x32x16_bf16 v[192:207], v[40:43], a[168:171], v[192:207]
    ds_read_b64_tr_b16 v[58:59], v10 offset:13312
    s_waitcnt lgkmcnt(6)
    v_add_u32 v10, s56, v6
    v_mfma_f32_32x32x16_bf16 v[144:159], v[44:47], a[24:27], v[144:159]
    ds_read_b64_tr_b16 v[60:61], v11 offset:12288
    v_mfma_f32_32x32x16_bf16 v[208:223], v[44:47], a[168:171], v[208:223]
    ds_read_b64_tr_b16 v[62:63], v11 offset:13312
    s_waitcnt lgkmcnt(6)
    v_add_u32 v11, s56, v7
    v_mfma_f32_32x32x16_bf16 v[96:111], v[48:51], a[28:31], v[96:111]
    ds_read_b64_tr_b16 v[32:33], v8 offset:0
    v_mfma_f32_32x32x16_bf16 v[160:175], v[48:51], a[172:175], v[160:175]
    ds_read_b64_tr_b16 v[34:35], v8 offset:1024
    s_waitcnt lgkmcnt(6)
    v_mfma_f32_32x32x16_bf16 v[112:127], v[52:55], a[28:31], v[112:127]
    ds_read_b64_tr_b16 v[36:37], v9 offset:0
    v_mfma_f32_32x32x16_bf16 v[176:191], v[52:55], a[172:175], v[176:191]
    ds_read_b64_tr_b16 v[38:39], v9 offset:1024
    s_waitcnt lgkmcnt(6)
    v_mfma_f32_32x32x16_bf16 v[128:143], v[56:59], a[28:31], v[128:143]
    ds_read_b64_tr_b16 v[40:41], v10 offset:0
    v_mfma_f32_32x32x16_bf16 v[192:207], v[56:59], a[172:175], v[192:207]
    ds_read_b64_tr_b16 v[42:43], v10 offset:1024
    s_waitcnt lgkmcnt(6)
    v_mfma_f32_32x32x16_bf16 v[144:159], v[60:63], a[28:31], v[144:159]
    ds_read_b64_tr_b16 v[44:45], v11 offset:0
    v_mfma_f32_32x32x16_bf16 v[208:223], v[60:63], a[172:175], v[208:223]
    ds_read_b64_tr_b16 v[46:47], v11 offset:1024
    s_waitcnt lgkmcnt(6)
    v_mfma_f32_32x32x16_bf16 v[96:111], v[32:35], a[32:35], v[96:111]
    ds_read_b64_tr_b16 v[48:49], v8 offset:4096
    s_waitcnt vmcnt(24)
    s_barrier
    v_mfma_f32_32x32x16_bf16 v[160:175], v[32:35], a[176:179], v[160:175]
    ds_read_b64_tr_b16 v[50:51], v8 offset:5120
    s_add_u32 m0, s46, 0
    s_nop 0
    buffer_load_dwordx4 v3, s[20:23], s44 offen  lds
    s_waitcnt lgkmcnt(6)
    v_mfma_f32_32x32x16_bf16 v[112:127], v[36:39], a[32:35], v[112:127]
    ds_read_b64_tr_b16 v[52:53], v9 offset:4096
    s_add_u32 m0, s46, 1024
    s_add_u32 s44, s44, s45
    buffer_load_dwordx4 v3, s[20:23], s44 offen  lds
    v_mfma_f32_32x32x16_bf16 v[176:191], v[36:39], a[176:179], v[176:191]
    ds_read_b64_tr_b16 v[54:55], v9 offset:5120
    s_add_u32 m0, s46, 2048
    s_add_u32 s44, s44, s45
    buffer_load_dwordx4 v3, s[20:23], s44 offen  lds
    s_waitcnt lgkmcnt(6)
    v_mfma_f32_32x32x16_bf16 v[128:143], v[40:43], a[32:35], v[128:143]
    ds_read_b64_tr_b16 v[56:57], v10 offset:4096
    s_add_u32 m0, s46, 3072
    s_add_u32 s44, s44, s45
    buffer_load_dwordx4 v3, s[20:23], s44 offen  lds
    v_mfma_f32_32x32x16_bf16 v[192:207], v[40:43], a[176:179], v[192:207]
    ds_read_b64_tr_b16 v[58:59], v10 offset:5120
    s_add_u32 s44, s44, s57
    s_add_u32 s46, s46, 16384
    s_and_b32 s46, s46, 131071
    s_waitcnt lgkmcnt(6)
    v_mfma_f32_32x32x16_bf16 v[144:159], v[44:47], a[32:35], v[144:159]
    ds_read_b64_tr_b16 v[60:61], v11 offset:4096
    s_add_u32 s56, s56, 16384
    s_and_b32 s56, s56, 131071
    v_mfma_f32_32x32x16_bf16 v[208:223], v[44:47], a[176:179], v[208:223]
    ds_read_b64_tr_b16 v[62:63], v11 offset:5120
    s_waitcnt lgkmcnt(6)
    v_mfma_f32_32x32x16_bf16 v[96:111], v[48:51], a[36:39], v[96:111]
    ds_read_b64_tr_b16 v[32:33], v8 offset:8192
    s_cmp_eq_u32 s42, s62
    s_cselect_b32 s38, s61, 0
    s_add_u32 s42, s42, s38
    s_add_u32 s42, s42, 1
    s_add_u32 s38, s42, s63
    s_cmp_ge_u32 s38, 7
    s_cselect_b32 s41, 7, 0
    s_sub_u32 s38, s38, s41
    s_mul_i32 s38, s38, 24
    s_add_u32 s38, s38, s14
    s_add_u32 s38, s38, s60
    s_cmp_ge_u32 s38, 96
    s_cbranch_scc1 Lg_10
    s_lshr_b32 s39, s38, 5
    s_cmp_eq_u32 s39, 0
    s_cselect_b64 s[20:21], s[30:31], s[32:33]
    s_cmp_eq_u32 s39, 2
    s_cselect_b64 s[20:21], s[28:29], s[20:21]
    s_mov_b32 s22, 4718592
    s_and_b32 s38, s38, 31
    s_lshl_b32 s44, s38, 8
    s_lshl_b32 s39, s13, 17
    s_add_u32 s44, s44, s39
    s_mov_b32 s45, 32768
    s_mov_b32 s57, 425984
    v_mov_b32 v3, v1
    s_branch Le_11
Lg_10:
    s_cmp_lt_u32 s13, 2
    s_cselect_b64 s[20:21], s[34:35], s[36:37]
    s_mov_b32 s22, 5308416
    s_sub_u32 s38, s38, 96
    s_lshl_b32 s44, s38, 7
    s_and_b32 s39, s13, 1
    s_mul_i32 s39, s39, 294912
    s_add_u32 s44, s44, s39
    s_mov_b32 s45, 73728
    s_mov_b32 s57, 368640
    v_mov_b32 v3, v2
Le_11:
    s_cmp_lt_u32 s42, s59
    s_cselect_b32 s22, s22, 0
    v_mfma_f32_32x32x16_bf16 v[160:175], v[48:51], a[180:183], v[160:175]
    ds_read_b64_tr_b16 v[34:35], v8 offset:9216
    s_waitcnt lgkmcnt(6)
    v_mfma_f32_32x32x16_bf16 v[112:127], v[52:55], a[36:39], v[112:127]
    ds_read_b64_tr_b16 v[36:37], v9 offset:8192
    v_mfma_f32_32x32x16_bf16 v[176:191], v[52:55], a[180:183], v[176:191]
    ds_read_b64_tr_b16 v[38:39], v9 offset:9216
    s_waitcnt lgkmcnt(6)
    v_mfma_f32_32x32x16_bf16 v[128:143], v[56:59], a[36:39], v[128:143]
    ds_read_b64_tr_b16 v[40:41], v10 offset:8192
    v_mfma_f32_32x32x16_bf16 v[192:207], v[56:59], a[180:183], v[192:207]
    ds_read_b64_tr_b16 v[42:43], v10 offset:9216
    s_waitcnt lgkmcnt(6)
    v_mfma_f32_32x32x16_bf16 v[144:159], v[60:63], a[36:39], v[144:159]
    ds_read_b64_tr_b16 v[44:45], v11 offset:8192
    v_mfma_f32_32x32x16_bf16 v[208:223], v[60:63], a[180:183], v[208:223]
    ds_read_b64_tr_b16 v[46:47], v11 offset:9216
    s_waitcnt lgkmcnt(6)
    v_mfma_f32_32x32x16_bf16 v[96:111], v[32:35], a[40:43], v[96:111]
    ds_read_b64_tr_b16 v[48:49], v8 offset:12288
    v_mfma_f32_32x32x16_bf16 v[160:175], v[32:35], a[184:187], v[160:175]
    ds_read_b64_tr_b16 v[50:51], v8 offset:13312
    s_waitcnt lgkmcnt(6)
    v_add_u32 v8, s56, v4
    v_mfma_f32_32x32x16_bf16 v[112:127], v[36:39], a[40:43], v[112:127]
    ds_read_b64_tr_b16 v[52:53], v9 offset:12288
    v_mfma_f32_32x32x16_bf16 v[176:191], v[36:39], a[184:187], v[176:191]
    ds_read_b64_tr_b16 v[54:55], v9 offset:13312
    s_waitcnt lgkmcnt(6)
    v_add_u32 v9, s56, v5
    v_mfma_f32_32x32x16_bf16 v[128:143], v[40:43], a[40:43], v[128:143]
    ds_read_b64_tr_b16 v[56:57], v10 offset:12288
    v_mfma_f32_32x32x16_bf16 v[192:207], v[40:43], a[184:187], v[192:207]
    ds_read_b64_tr_b16 v[58:59], v10 offset:13312
    s_waitcnt lgkmcnt(6)
    v_add_u32 v10, s56, v6
    v_mfma_f32_32x32x16_bf16 v[144:159], v[44:47], a[40:43], v[144:159]
    ds_read_b64_tr_b16 v[60:61], v11 offset:12288
    v_mfma_f32_32x32x16_bf16 v[208:223], v[44:47], a[184:187], v[208:223]
    ds_read_b64_tr_b16 v[62:63], v11 offset:13312
    s_waitcnt lgkmcnt(6)
    v_add_u32 v11, s56, v7
    v_mfma_f32_32x32x16_bf16 v[96:111], v[48:51], a[44:47], v[96:111]
    ds_read_b64_tr_b16 v[32:33], v8 offset:0
    v_mfma_f32_32x32x16_bf16 v[160:175], v[48:51], a[188:191], v[160:175]
    ds_read_b64_tr_b16 v[34:35], v8 offset:1024
    s_waitcnt lgkmcnt(6)
    v_mfma_f32_32x32x16_bf16 v[112:127], v[52:55], a[44:47], v[112:127]
    ds_read_b64_tr_b16 v[36:37], v9 offset:0
    v_mfma_f32_32x32x16_bf16 v[176:191], v[52:55], a[188:191], v[176:191]
    ds_read_b64_tr_b16 v[38:39], v9 offset:1024
    s_waitcnt lgkmcnt(6)
    v_mfma_f32_32x32x16_bf16 v[128:143], v[56:59], a[44:47], v[128:143]
    ds_read_b64_tr_b16 v[40:41], v10 offset:0
    v_mfma_f32_32x32x16_bf16 v[192:207], v[56:59], a[188:191], v[192:207]
    ds_read_b64_tr_b16 v[42:43], v10 offset:1024
    s_waitcnt lgkmcnt(6)
    v_mfma_f32_32x32x16_bf16 v[144:159], v[60:63], a[44:47], v[144:159]
    ds_read_b64_tr_b16 v[44:45], v11 offset:0
    v_mfma_f32_32x32x16_bf16 v[208:223], v[60:63], a[188:191], v[208:223]
    ds_read_b64_tr_b16 v[46:47], v11 offset:1024
    s_waitcnt lgkmcnt(6)
    v_mfma_f32_32x32x16_bf16 v[96:111], v[32:35], a[48:51], v[96:111]
    ds_read_b64_tr_b16 v[48:49], v8 offset:4096
    s_waitcnt vmcnt(24)
    s_barrier
    v_mfma_f32_32x32x16_bf16 v[160:175], v[32:35], a[192:195], v[160:175]
    ds_read_b64_tr_b16 v[50:51], v8 offset:5120
    s_add_u32 m0, s46, 0
    s_nop 0
    buffer_load_dwordx4 v3, s[20:23], s44 offen  lds
    s_waitcnt lgkmcnt(6)
    v_mfma_f32_32x32x16_bf16 v[112:127], v[36:39], a[48:51], v[112:127]
    ds_read_b64_tr_b16 v[52:53], v9 offset:4096
    s_add_u32 m0, s46, 1024
    s_add_u32 s44, s44, s45
    buffer_load_dwordx4 v3, s[20:23], s44 offen  lds
    v_mfma_f32_32x32x16_bf16 v[176:191], v[36:39], a[192:195], v[176:191]
    ds_read_b64_tr_b16 v[54:55], v9 offset:5120
    s_add_u32 m0, s46, 2048
    s_add_u32 s44, s44, s45
    buffer_load_dwordx4 v3, s[20:23], s44 offen  lds
    s_waitcnt lgkmcnt(6)
    v_mfma_f32_32x32x16_bf16 v[128:143], v[40:43], a[48:51], v[128:143]
    ds_read_b64_tr_b16 v[56:57], v10 offset:4096
    s_add_u32 m0, s46, 3072
    s_add_u32 s44, s44, s45
    buffer_load_dwordx4 v3, s[20:23], s44 offen  lds
    v_mfma_f32_32x32x16_bf16 v[192:207], v[40:43], a[192:195], v[192:207]
    ds_read_b64_tr_b16 v[58:59], v10 offset:5120
    s_add_u32 s44, s44, s57
    s_add_u32 s46, s46, 16384
    s_and_b32 s46, s46, 131071
    s_waitcnt lgkmcnt(6)
    v_mfma_f32_32x32x16_bf16 v[144:159], v[44:47], a[48:51], v[144:159]
    ds_read_b64_tr_b16 v[60:61], v11 offset:4096
    s_add_u32 s56, s56, 16384
    s_and_b32 s56, s56, 131071
    v_mfma_f32_32x32x16_bf16 v[208:223], v[44:47], a[192:195], v[208:223]
    ds_read_b64_tr_b16 v[62:63], v11 offset:5120
    s_waitcnt lgkmcnt(6)
    v_mfma_f32_32x32x16_bf16 v[96:111], v[48:51], a[52:55], v[96:111]
    ds_read_b64_tr_b16 v[32:33], v8 offset:8192
    v_mfma_f32_32x32x16_bf16 v[160:175], v[48:51], a[196:199], v[160:175]
    ds_read_b64_tr_b16 v[34:35], v8 offset:9216
    s_waitcnt lgkmcnt(6)
    v_mfma_f32_32x32x16_bf16 v[112:127], v[52:55], a[52:55], v[112:127]
    ds_read_b64_tr_b16 v[36:37], v9 offset:8192
    v_mfma_f32_32x32x16_bf16 v[176:191], v[52:55], a[196:199], v[176:191]
    ds_read_b64_tr_b16 v[38:39], v9 offset:9216
    s_waitcnt lgkmcnt(6)
    v_mfma_f32_32x32x16_bf16 v[128:143], v[56:59], a[52:55], v[128:143]
    ds_read_b64_tr_b16 v[40:41], v10 offset:8192
    v_mfma_f32_32x32x16_bf16 v[192:207], v[56:59], a[196:199], v[192:207]
    ds_read_b64_tr_b16 v[42:43], v10 offset:9216
    s_waitcnt lgkmcnt(6)
    v_mfma_f32_32x32x16_bf16 v[144:159], v[60:63], a[52:55], v[144:159]
    ds_read_b64_tr_b16 v[44:45], v11 offset:8192
    v_mfma_f32_32x32x16_bf16 v[208:223], v[60:63], a[196:199], v[208:223]
    ds_read_b64_tr_b16 v[46:47], v11 offset:9216
    s_waitcnt lgkmcnt(6)
    v_mfma_f32_32x32x16_bf16 v[96:111], v[32:35], a[56:59], v[96:111]
    ds_read_b64_tr_b16 v[48:49], v8 offset:12288
    v_mfma_f32_32x32x16_bf16 v[160:175], v[32:35], a[200:203], v[160:175]
    ds_read_b64_tr_b16 v[50:51], v8 offset:13312
    s_waitcnt lgkmcnt(6)
    v_add_u32 v8, s56, v4
    v_mfma_f32_32x32x16_bf16 v[112:127], v[36:39], a[56:59], v[112:127]
    ds_read_b64_tr_b16 v[52:53], v9 offset:12288
    v_mfma_f32_32x32x16_bf16 v[176:191], v[36:39], a[200:203], v[176:191]
    ds_read_b64_tr_b16 v[54:55], v9 offset:13312
    s_waitcnt lgkmcnt(6)
    v_add_u32 v9, s56, v5
    v_mfma_f32_32x32x16_bf16 v[128:143], v[40:43], a[56:59], v[128:143]
    ds_read_b64_tr_b16 v[56:57], v10 offset:12288
    v_mfma_f32_32x32x16_bf16 v[192:207], v[40:43], a[200:203], v[192:207]
    ds_read_b64_tr_b16 v[58:59], v10 offset:13312
    s_waitcnt lgkmcnt(6)
    v_add_u32 v10, s56, v6
    v_mfma_f32_32x32x16_bf16 v[144:159], v[44:47], a[56:59], v[144:159]
    ds_read_b64_tr_b16 v[60:61], v11 offset:12288
    v_mfma_f32_32x32x16_bf16 v[208:223], v[44:47], a[200:203], v[208:223]
    ds_read_b64_tr_b16 v[62:63], v11 offset:13312
    s_waitcnt lgkmcnt(6)
    v_add_u32 v11, s56, v7
    v_mfma_f32_32x32x16_bf16 v[96:111], v[48:51], a[60:63], v[96:111]
    ds_read_b64_tr_b16 v[32:33], v8 offset:0
    v_mfma_f32_32x32x16_bf16 v[160:175], v[48:51], a[204:207], v[160:175]
    ds_read_b64_tr_b16 v[34:35], v8 offset:1024
    s_waitcnt lgkmcnt(6)
    v_mfma_f32_32x32x16_bf16 v[112:127], v[52:55], a[60:63], v[112:127]
    ds_read_b64_tr_b16 v[36:37], v9 offset:0
    v_mfma_f32_32x32x16_bf16 v[176:191], v[52:55], a[204:207], v[176:191]
    ds_read_b64_tr_b16 v[38:39], v9 offset:1024
    s_waitcnt lgkmcnt(6)
    v_mfma_f32_32x32x16_bf16 v[128:143], v[56:59], a[60:63], v[128:143]
    ds_read_b64_tr_b16 v[40:41], v10 offset:0
    v_mfma_f32_32x32x16_bf16 v[192:207], v[56:59], a[204:207], v[192:207]
    ds_read_b64_tr_b16 v[42:43], v10 offset:1024
    s_waitcnt lgkmcnt(6)
    v_mfma_f32_32x32x16_bf16 v[144:159], v[60:63], a[60:63], v[144:159]
    ds_read_b64_tr_b16 v[44:45], v11 offset:0
    v_mfma_f32_32x32x16_bf16 v[208:223], v[60:63], a[204:207], v[208:223]
    ds_read_b64_tr_b16 v[46:47], v11 offset:1024
    s_waitcnt lgkmcnt(6)
    v_mfma_f32_32x32x16_bf16 v[96:111], v[32:35], a[64:67], v[96:111]
    ds_read_b64_tr_b16 v[48:49], v8 offset:4096
    s_waitcnt vmcnt(24)
    s_barrier
    v_mfma_f32_32x32x16_bf16 v[160:175], v[32:35], a[208:211], v[160:175]
    ds_read_b64_tr_b16 v[50:51], v8 offset:5120
    s_add_u32 m0, s46, 0
    s_nop 0
    buffer_load_dwordx4 v3, s[20:23], s44 offen  lds
    s_waitcnt lgkmcnt(6)
    v_mfma_f32_32x32x16_bf16 v[112:127], v[36:39], a[64:67], v[112:127]
    ds_read_b64_tr_b16 v[52:53], v9 offset:4096
    s_add_u32 m0, s46, 1024
    s_add_u32 s44, s44, s45
    buffer_load_dwordx4 v3, s[20:23], s44 offen  lds
    v_mfma_f32_32x32x16_bf16 v[176:191], v[36:39], a[208:211], v[176:191]
    ds_read_b64_tr_b16 v[54:55], v9 offset:5120
    s_add_u32 m0, s46, 2048
    s_add_u32 s44, s44, s45
    buffer_load_dwordx4 v3, s[20:23], s44 offen  lds
    s_waitcnt lgkmcnt(6)
    v_mfma_f32_32x32x16_bf16 v[128:143], v[40:43], a[64:67], v[128:143]
    ds_read_b64_tr_b16 v[56:57], v10 offset:4096
    s_add_u32 m0, s46, 3072
    s_add_u32 s44, s44, s45
    buffer_load_dwordx4 v3, s[20:23], s44 offen  lds
    v_mfma_f32_32x32x16_bf16 v[192:207], v[40:43], a[208:211], v[192:207]
    ds_read_b64_tr_b16 v[58:59], v10 offset:5120
    s_add_u32 s44, s44, s57
    s_add_u32 s46, s46, 16384
    s_and_b32 s46, s46, 131071
    s_waitcnt lgkmcnt(6)
    v_mfma_f32_32x32x16_bf16 v[144:159], v[44:47], a[64:67], v[144:159]
    ds_read_b64_tr_b16 v[60:61], v11 offset:4096
    s_add_u32 s56, s56, 16384
    s_and_b32 s56, s56, 131071
    v_mfma_f32_32x32x16_bf16 v[208:223], v[44:47], a[208:211], v[208:223]
    ds_read_b64_tr_b16 v[62:63], v11 offset:5120
    s_waitcnt lgkmcnt(6)
    v_mfma_f32_32x32x16_bf16 v[96:111], v[48:51], a[68:71], v[96:111]
    ds_read_b64_tr_b16 v[32:33], v8 offset:8192
    v_mfma_f32_32x32x16_bf16 v[160:175], v[48:51], a[212:215], v[160:175]
    ds_read_b64_tr_b16 v[34:35], v8 offset:9216
    s_waitcnt lgkmcnt(6)
    v_mfma_f32_32x32x16_bf16 v[112:127], v[52:55], a[68:71], v[112:127]
    ds_read_b64_tr_b16 v[36:37], v9 offset:8192
    v_mfma_f32_32x32x16_bf16 v[176:191], v[52:55], a[212:215], v[176:191]
    ds_read_b64_tr_b16 v[38:39], v9 offset:9216
    s_waitcnt lgkmcnt(6)
    v_mfma_f32_32x32x16_bf16 v[128:143], v[56:59], a[68:71], v[128:143]
    ds_read_b64_tr_b16 v[40:41], v10 offset:8192
    v_mfma_f32_32x32x16_bf16 v[192:207], v[56:59], a[212:215], v[192:207]
    ds_read_b64_tr_b16 v[42:43], v10 offset:9216
    s_waitcnt lgkmcnt(6)
    v_mfma_f32_32x32x16_bf16 v[144:159], v[60:63], a[68:71], v[144:159]
    ds_read_b64_tr_b16 v[44:45], v11 offset:8192
    v_mfma_f32_32x32x16_bf16 v[208:223], v[60:63], a[212:215], v[208:223]
    ds_read_b64_tr_b16 v[46:47], v11 offset:9216
    s_waitcnt lgkmcnt(6)
    v_mfma_f32_32x32x16_bf16 v[96:111], v[32:35], a[72:75], v[96:111]
    ds_read_b64_tr_b16 v[48:49], v8 offset:12288
    v_mfma_f32_32x32x16_bf16 v[160:175], v[32:35], a[216:219], v[160:175]
    ds_read_b64_tr_b16 v[50:51], v8 offset:13312
    s_waitcnt lgkmcnt(6)
    v_add_u32 v8, s56, v4
    v_mfma_f32_32x32x16_bf16 v[112:127], v[36:39], a[72:75], v[112:127]
    ds_read_b64_tr_b16 v[52:53], v9 offset:12288
    v_mfma_f32_32x32x16_bf16 v[176:191], v[36:39], a[216:219], v[176:191]
    ds_read_b64_tr_b16 v[54:55], v9 offset:13312
    s_waitcnt lgkmcnt(6)
    v_add_u32 v9, s56, v5
    v_mfma_f32_32x32x16_bf16 v[128:143], v[40:43], a[72:75], v[128:143]
    ds_read_b64_tr_b16 v[56:57], v10 offset:12288
    v_mfma_f32_32x32x16_bf16 v[192:207], v[40:43], a[216:219], v[192:207]
    ds_read_b64_tr_b16 v[58:59], v10 offset:13312
    s_waitcnt lgkmcnt(6)
    v_add_u32 v10, s56, v6
    v_mfma_f32_32x32x16_bf16 v[144:159], v[44:47], a[72:75], v[144:159]
    ds_read_b64_tr_b16 v[60:61], v11 offset:12288
    v_mfma_f32_32x32x16_bf16 v[208:223], v[44:47], a[216:219], v[208:223]
    ds_read_b64_tr_b16 v[62:63], v11 offset:13312
    s_waitcnt lgkmcnt(6)
    v_add_u32 v11, s56, v7
    v_mfma_f32_32x32x16_bf16 v[96:111], v[48:51], a[76:79], v[96:111]
    ds_read_b64_tr_b16 v[32:33], v8 offset:0
    v_mfma_f32_32x32x16_bf16 v[160:175], v[48:51], a[220:223], v[160:175]
    ds_read_b64_tr_b16 v[34:35], v8 offset:1024
    s_waitcnt lgkmcnt(6)
    v_mfma_f32_32x32x16_bf16 v[112:127], v[52:55], a[76:79], v[112:127]
    ds_read_b64_tr_b16 v[36:37], v9 offset:0
    v_mfma_f32_32x32x16_bf16 v[176:191], v[52:55], a[220:223], v[176:191]
    ds_read_b64_tr_b16 v[38:39], v9 offset:1024
    s_waitcnt lgkmcnt(6)
    v_mfma_f32_32x32x16_bf16 v[128:143], v[56:59], a[76:79], v[128:143]
    ds_read_b64_tr_b16 v[40:41], v10 offset:0
    v_mfma_f32_32x32x16_bf16 v[192:207], v[56:59], a[220:223], v[192:207]
    ds_read_b64_tr_b16 v[42:43], v10 offset:1024
    s_waitcnt lgkmcnt(6)
    v_mfma_f32_32x32x16_bf16 v[144:159], v[60:63], a[76:79], v[144:159]
    ds_read_b64_tr_b16 v[44:45], v11 offset:0
    v_mfma_f32_32x32x16_bf16 v[208:223], v[60:63], a[220:223], v[208:223]
    ds_read_b64_tr_b16 v[46:47], v11 offset:1024
    s_waitcnt lgkmcnt(6)
    v_mfma_f32_32x32x16_bf16 v[96:111], v[32:35], a[80:83], v[96:111]
    ds_read_b64_tr_b16 v[48:49], v8 offset:4096
    s_waitcnt vmcnt(16)
    s_barrier
    v_mfma_f32_32x32x16_bf16 v[160:175], v[32:35], a[224:227], v[160:175]
    ds_read_b64_tr_b16 v[50:51], v8 offset:5120
    s_add_u32 m0, s46, 0
    s_nop 0
    buffer_load_dwordx4 v3, s[20:23], s44 offen  lds
    s_waitcnt lgkmcnt(6)
    v_mfma_f32_32x32x16_bf16 v[112:127], v[36:39], a[80:83], v[112:127]
    ds_read_b64_tr_b16 v[52:53], v9 offset:4096
    s_add_u32 m0, s46, 1024
    s_add_u32 s44, s44, s45
    buffer_load_dwordx4 v3, s[20:23], s44 offen  lds
    v_mfma_f32_32x32x16_bf16 v[176:191], v[36:39], a[224:227], v[176:191]
    ds_read_b64_tr_b16 v[54:55], v9 offset:5120
    s_add_u32 m0, s46, 2048
    s_add_u32 s44, s44, s45
    buffer_load_dwordx4 v3, s[20:23], s44 offen  lds
    s_waitcnt lgkmcnt(6)
    v_mfma_f32_32x32x16_bf16 v[128:143], v[40:43], a[80:83], v[128:143]
    ds_read_b64_tr_b16 v[56:57], v10 offset:4096
    s_add_u32 m0, s46, 3072
    s_add_u32 s44, s44, s45
    buffer_load_dwordx4 v3, s[20:23], s44 offen  lds
    v_mfma_f32_32x32x16_bf16 v[192:207], v[40:43], a[224:227], v[192:207]
    ds_read_b64_tr_b16 v[58:59], v10 offset:5120
    s_add_u32 s44, s44, s57
    s_add_u32 s46, s46, 16384
    s_and_b32 s46, s46, 131071
    s_waitcnt lgkmcnt(6)
    v_mfma_f32_32x32x16_bf16 v[144:159], v[44:47], a[80:83], v[144:159]
    ds_read_b64_tr_b16 v[60:61], v11 offset:4096
    s_add_u32 s56, s56, 16384
    s_and_b32 s56, s56, 131071
    v_mfma_f32_32x32x16_bf16 v[208:223], v[44:47], a[224:227], v[208:223]
    ds_read_b64_tr_b16 v[62:63], v11 offset:5120
    s_waitcnt lgkmcnt(6)
    v_mfma_f32_32x32x16_bf16 v[96:111], v[48:51], a[84:87], v[96:111]
    ds_read_b64_tr_b16 v[32:33], v8 offset:8192
    s_cmp_eq_u32 s13, 0
    s_cbranch_scc0 Lsig_12
    s_mov_b64 exec, 1
    v_mov_b32 v25, 1
    buffer_store_dword v25, off, s[4:7], s58 sc1
    s_mov_b64 exec, -1
Lsig_12:
    s_mov_b32 s58, 0xf0000000
    v_mfma_f32_32x32x16_bf16 v[160:175], v[48:51], a[228:231], v[160:175]
    ds_read_b64_tr_b16 v[34:35], v8 offset:9216
    s_waitcnt lgkmcnt(6)
    v_mfma_f32_32x32x16_bf16 v[112:127], v[52:55], a[84:87], v[112:127]
    ds_read_b64_tr_b16 v[36:37], v9 offset:8192
    v_mfma_f32_32x32x16_bf16 v[176:191], v[52:55], a[228:231], v[176:191]
    ds_read_b64_tr_b16 v[38:39], v9 offset:9216
    s_waitcnt lgkmcnt(6)
    v_mfma_f32_32x32x16_bf16 v[128:143], v[56:59], a[84:87], v[128:143]
    ds_read_b64_tr_b16 v[40:41], v10 offset:8192
    v_mfma_f32_32x32x16_bf16 v[192:207], v[56:59], a[228:231], v[192:207]
    ds_read_b64_tr_b16 v[42:43], v10 offset:9216
    s_waitcnt lgkmcnt(6)
    v_mfma_f32_32x32x16_bf16 v[144:159], v[60:63], a[84:87], v[144:159]
    ds_read_b64_tr_b16 v[44:45], v11 offset:8192
    v_mfma_f32_32x32x16_bf16 v[208:223], v[60:63], a[228:231], v[208:223]
    ds_read_b64_tr_b16 v[46:47], v11 offset:9216
    s_waitcnt lgkmcnt(6)
    v_mfma_f32_32x32x16_bf16 v[96:111], v[32:35], a[88:91], v[96:111]
    ds_read_b64_tr_b16 v[48:49], v8 offset:12288
    v_mfma_f32_32x32x16_bf16 v[160:175], v[32:35], a[232:235], v[160:175]
    ds_read_b64_tr_b16 v[50:51], v8 offset:13312
    s_waitcnt lgkmcnt(6)
    v_add_u32 v8, s56, v4
    v_mfma_f32_32x32x16_bf16 v[112:127], v[36:39], a[88:91], v[112:127]
    ds_read_b64_tr_b16 v[52:53], v9 offset:12288
    v_mfma_f32_32x32x16_bf16 v[176:191], v[36:39], a[232:235], v[176:191]
    ds_read_b64_tr_b16 v[54:55], v9 offset:13312
    s_waitcnt lgkmcnt(6)
    v_add_u32 v9, s56, v5
    v_mfma_f32_32x32x16_bf16 v[128:143], v[40:43], a[88:91], v[128:143]
    ds_read_b64_tr_b16 v[56:57], v10 offset:12288
    v_mfma_f32_32x32x16_bf16 v[192:207], v[40:43], a[232:235], v[192:207]
    ds_read_b64_tr_b16 v[58:59], v10 offset:13312
    s_waitcnt lgkmcnt(6)
    v_add_u32 v10, s56, v6
    v_mfma_f32_32x32x16_bf16 v[144:159], v[44:47], a[88:91], v[144:159]
    ds_read_b64_tr_b16 v[60:61], v11 offset:12288
    v_mfma_f32_32x32x16_bf16 v[208:223], v[44:47], a[232:235], v[208:223]
    ds_read_b64_tr_b16 v[62:63], v11 offset:13312
    s_waitcnt lgkmcnt(6)
    v_add_u32 v11, s56, v7
    v_mfma_f32_32x32x16_bf16 v[96:111], v[48:51], a[92:95], v[96:111]
    ds_read_b64_tr_b16 v[32:33], v8 offset:0
    v_mfma_f32_32x32x16_bf16 v[160:175], v[48:51], a[236:239], v[160:175]
    ds_read_b64_tr_b16 v[34:35], v8 offset:1024
    s_waitcnt lgkmcnt(6)
    v_mfma_f32_32x32x16_bf16 v[112:127], v[52:55], a[92:95], v[112:127]
    ds_read_b64_tr_b16 v[36:37], v9 offset:0
    v_mfma_f32_32x32x16_bf16 v[176:191], v[52:55], a[236:239], v[176:191]
    ds_read_b64_tr_b16 v[38:39], v9 offset:1024
    s_waitcnt lgkmcnt(6)
    v_mfma_f32_32x32x16_bf16 v[128:143], v[56:59], a[92:95], v[128:143]
    ds_read_b64_tr_b16 v[40:41], v10 offset:0
    v_mfma_f32_32x32x16_bf16 v[192:207], v[56:59], a[236:239], v[192:207]
    ds_read_b64_tr_b16 v[42:43], v10 offset:1024
    s_waitcnt lgkmcnt(6)
    v_mfma_f32_32x32x16_bf16 v[144:159], v[60:63], a[92:95], v[144:159]
    ds_read_b64_tr_b16 v[44:45], v11 offset:0
    v_mfma_f32_32x32x16_bf16 v[208:223], v[60:63], a[236:239], v[208:223]
    ds_read_b64_tr_b16 v[46:47], v11 offset:1024
    s_waitcnt lgkmcnt(6)
    v_mfma_f32_32x32x16_bf16 v[96:111], v[32:35], a[96:99], v[96:111]
    ds_read_b64_tr_b16 v[48:49], v8 offset:4096
    s_waitcnt vmcnt(16)
    s_barrier
    v_mfma_f32_32x32x16_bf16 v[160:175], v[32:35], a[240:243], v[160:175]
    ds_read_b64_tr_b16 v[50:51], v8 offset:5120
    s_add_u32 m0, s46, 0
    s_nop 0
    buffer_load_dwordx4 v3, s[20:23], s44 offen  lds
    s_waitcnt lgkmcnt(6)
    v_mfma_f32_32x32x16_bf16 v[112:127], v[36:39], a[96:99], v[112:127]
    ds_read_b64_tr_b16 v[52:53], v9 offset:4096
    s_add_u32 m0, s46, 1024
    s_add_u32 s44, s44, s45
    buffer_load_dwordx4 v3, s[20:23], s44 offen  lds
    v_mfma_f32_32x32x16_bf16 v[176:191], v[36:39], a[240:243], v[176:191]
    ds_read_b64_tr_b16 v[54:55], v9 offset:5120
    s_add_u32 m0, s46, 2048
    s_add_u32 s44, s44, s45
    buffer_load_dwordx4 v3, s[20:23], s44 offen  lds
    s_waitcnt lgkmcnt(6)
    v_mfma_f32_32x32x16_bf16 v[128:143], v[40:43], a[96:99], v[128:143]
    ds_read_b64_tr_b16 v[56:57], v10 offset:4096
    s_add_u32 m0, s46, 3072
    s_add_u32 s44, s44, s45
    buffer_load_dwordx4 v3, s[20:23], s44 offen  lds
    v_mfma_f32_32x32x16_bf16 v[192:207], v[40:43], a[240:243], v[192:207]
    ds_read_b64_tr_b16 v[58:59], v10 offset:5120
    s_add_u32 s44, s44, s57
    s_add_u32 s46, s46, 16384
    s_and_b32 s46, s46, 131071
    s_waitcnt lgkmcnt(6)
    v_mfma_f32_32x32x16_bf16 v[144:159], v[44:47], a[96:99], v[144:159]
    ds_read_b64_tr_b16 v[60:61], v11 offset:4096
    s_add_u32 s56, s56, 16384
    s_and_b32 s56, s56, 131071
    v_mfma_f32_32x32x16_bf16 v[208:223], v[44:47], a[240:243], v[208:223]
    ds_read_b64_tr_b16 v[62:63], v11 offset:5120
    s_waitcnt lgkmcnt(6)
    v_mfma_f32_32x32x16_bf16 v[96:111], v[48:51], a[100:103], v[96:111]
    ds_read_b64_tr_b16 v[32:33], v8 offset:8192
    v_mfma_f32_32x32x16_bf16 v[160:175], v[48:51], a[244:247], v[160:175]
    ds_read_b64_tr_b16 v[34:35], v8 offset:9216
    s_waitcnt lgkmcnt(6)
    v_mfma_f32_32x32x16_bf16 v[112:127], v[52:55], a[100:103], v[112:127]
    ds_read_b64_tr_b16 v[36:37], v9 offset:8192
    v_mfma_f32_32x32x16_bf16 v[176:191], v[52:55], a[244:247], v[176:191]
    ds_read_b64_tr_b16 v[38:39], v9 offset:9216
    s_waitcnt lgkmcnt(6)
    v_mfma_f32_32x32x16_bf16 v[128:143], v[56:59], a[100:103], v[128:143]
    ds_read_b64_tr_b16 v[40:41], v10 offset:8192
    v_mfma_f32_32x32x16_bf16 v[192:207], v[56:59], a[244:247], v[192:207]
    ds_read_b64_tr_b16 v[42:43], v10 offset:9216
    s_waitcnt lgkmcnt(6)
    v_mfma_f32_32x32x16_bf16 v[144:159], v[60:63], a[100:103], v[144:159]
    ds_read_b64_tr_b16 v[44:45], v11 offset:8192
    v_mfma_f32_32x32x16_bf16 v[208:223], v[60:63], a[244:247], v[208:223]
    ds_read_b64_tr_b16 v[46:47], v11 offset:9216
    s_waitcnt lgkmcnt(6)
    v_mfma_f32_32x32x16_bf16 v[96:111], v[32:35], a[104:107], v[96:111]
    ds_read_b64_tr_b16 v[48:49], v8 offset:12288
    v_mfma_f32_32x32x16_bf16 v[160:175], v[32:35], a[248:251], v[160:175]
    ds_read_b64_tr_b16 v[50:51], v8 offset:13312
    s_waitcnt lgkmcnt(6)
    v_add_u32 v8, s56, v4
    v_mfma_f32_32x32x16_bf16 v[112:127], v[36:39], a[104:107], v[112:127]
    ds_read_b64_tr_b16 v[52:53], v9 offset:12288
    v_mfma_f32_32x32x16_bf16 v[176:191], v[36:39], a[248:251], v[176:191]
    ds_read_b64_tr_b16 v[54:55], v9 offset:13312
    s_waitcnt lgkmcnt(6)
    v_add_u32 v9, s56, v5
    v_mfma_f32_32x32x16_bf16 v[128:143], v[40:43], a[104:107], v[128:143]
    ds_read_b64_tr_b16 v[56:57], v10 offset:12288
    v_mfma_f32_32x32x16_bf16 v[192:207], v[40:43], a[248:251], v[192:207]
    ds_read_b64_tr_b16 v[58:59], v10 offset:13312
    s_waitcnt lgkmcnt(6)
    v_add_u32 v10, s56, v6
    v_mfma_f32_32x32x16_bf16 v[144:159], v[44:47], a[104:107], v[144:159]
    ds_read_b64_tr_b16 v[60:61], v11 offset:12288
    v_mfma_f32_32x32x16_bf16 v[208:223], v[44:47], a[248:251], v[208:223]
    ds_read_b64_tr_b16 v[62:63], v11 offset:13312
    s_waitcnt lgkmcnt(6)
    v_add_u32 v11, s56, v7
    v_mfma_f32_32x32x16_bf16 v[96:111], v[48:51], a[108:111], v[96:111]
    ds_read_b64_tr_b16 v[32:33], v8 offset:0
    v_mfma_f32_32x32x16_bf16 v[160:175], v[48:51], a[252:255], v[160:175]
    ds_read_b64_tr_b16 v[34:35], v8 offset:1024
    s_waitcnt lgkmcnt(6)
    v_mfma_f32_32x32x16_bf16 v[112:127], v[52:55], a[108:111], v[112:127]
    ds_read_b64_tr_b16 v[36:37], v9 offset:0
    v_mfma_f32_32x32x16_bf16 v[176:191], v[52:55], a[252:255], v[176:191]
    ds_read_b64_tr_b16 v[38:39], v9 offset:1024
    s_waitcnt lgkmcnt(6)
    v_mfma_f32_32x32x16_bf16 v[128:143], v[56:59], a[108:111], v[128:143]
    ds_read_b64_tr_b16 v[40:41], v10 offset:0
    v_mfma_f32_32x32x16_bf16 v[192:207], v[56:59], a[252:255], v[192:207]
    ds_read_b64_tr_b16 v[42:43], v10 offset:1024
    s_waitcnt lgkmcnt(6)
    v_mfma_f32_32x32x16_bf16 v[144:159], v[60:63], a[108:111], v[144:159]
    ds_read_b64_tr_b16 v[44:45], v11 offset:0
    v_mfma_f32_32x32x16_bf16 v[208:223], v[60:63], a[252:255], v[208:223]
    ds_read_b64_tr_b16 v[46:47], v11 offset:1024
    s_waitcnt lgkmcnt(6)
    v_mfma_f32_32x32x16_bf16 v[96:111], v[32:35], a[112:115], v[96:111]
    ds_read_b64_tr_b16 v[48:49], v8 offset:4096
    s_waitcnt vmcnt(16)
    s_barrier
    v_mfma_f32_32x32x16_bf16 v[160:175], v[32:35], v[64:67], v[160:175]
    ds_read_b64_tr_b16 v[50:51], v8 offset:5120
    s_add_u32 m0, s46, 0
    s_nop 0
    buffer_load_dwordx4 v3, s[20:23], s44 offen  lds
    s_waitcnt lgkmcnt(6)
    v_mfma_f32_32x32x16_bf16 v[112:127], v[36:39], a[112:115], v[112:127]
    ds_read_b64_tr_b16 v[52:53], v9 offset:4096
    s_add_u32 m0, s46, 1024
    s_add_u32 s44, s44, s45
    buffer_load_dwordx4 v3, s[20:23], s44 offen  lds
    v_mfma_f32_32x32x16_bf16 v[176:191], v[36:39], v[64:67], v[176:191]
    ds_read_b64_tr_b16 v[54:55], v9 offset:5120
    s_add_u32 m0, s46, 2048
    s_add_u32 s44, s44, s45
    buffer_load_dwordx4 v3, s[20:23], s44 offen  lds
    s_waitcnt lgkmcnt(6)
    v_mfma_f32_32x32x16_bf16 v[128:143], v[40:43], a[112:115], v[128:143]
    ds_read_b64_tr_b16 v[56:57], v10 offset:4096
    s_add_u32 m0, s46, 3072
    s_add_u32 s44, s44, s45
    buffer_load_dwordx4 v3, s[20:23], s44 offen  lds
    v_mfma_f32_32x32x16_bf16 v[192:207], v[40:43], v[64:67], v[192:207]
    ds_read_b64_tr_b16 v[58:59], v10 offset:5120
    s_add_u32 s44, s44, s57
    s_add_u32 s46, s46, 16384
    s_and_b32 s46, s46, 131071
    s_waitcnt lgkmcnt(6)
    v_mfma_f32_32x32x16_bf16 v[144:159], v[44:47], a[112:115], v[144:159]
    ds_read_b64_tr_b16 v[60:61], v11 offset:4096
    s_add_u32 s56, s56, 16384
    s_and_b32 s56, s56, 131071
    v_mfma_f32_32x32x16_bf16 v[208:223], v[44:47], v[64:67], v[208:223]
    ds_read_b64_tr_b16 v[62:63], v11 offset:5120
    s_waitcnt lgkmcnt(6)
    v_mfma_f32_32x32x16_bf16 v[96:111], v[48:51], a[116:119], v[96:111]
    ds_read_b64_tr_b16 v[32:33], v8 offset:8192
    v_mfma_f32_32x32x16_bf16 v[160:175], v[48:51], v[68:71], v[160:175]
    ds_read_b64_tr_b16 v[34:35], v8 offset:9216
    s_waitcnt lgkmcnt(6)
    v_mfma_f32_32x32x16_bf16 v[112:127], v[52:55], a[116:119], v[112:127]
    ds_read_b64_tr_b16 v[36:37], v9 offset:8192
    v_mfma_f32_32x32x16_bf16 v[176:191], v[52:55], v[68:71], v[176:191]
    ds_read_b64_tr_b16 v[38:39], v9 offset:9216
    s_waitcnt lgkmcnt(6)
    v_mfma_f32_32x32x16_bf16 v[128:143], v[56:59], a[116:119], v[128:143]
    ds_read_b64_tr_b16 v[40:41], v10 offset:8192
    v_mfma_f32_32x32x16_bf16 v[192:207], v[56:59], v[68:71], v[192:207]
    ds_read_b64_tr_b16 v[42:43], v10 offset:9216
    s_waitcnt lgkmcnt(6)
    v_mfma_f32_32x32x16_bf16 v[144:159], v[60:63], a[116:119], v[144:159]
    ds_read_b64_tr_b16 v[44:45], v11 offset:8192
    v_mfma_f32_32x32x16_bf16 v[208:223], v[60:63], v[68:71], v[208:223]
    ds_read_b64_tr_b16 v[46:47], v11 offset:9216
    s_waitcnt lgkmcnt(6)
    v_mfma_f32_32x32x16_bf16 v[96:111], v[32:35], a[120:123], v[96:111]
    ds_read_b64_tr_b16 v[48:49], v8 offset:12288
    v_mfma_f32_32x32x16_bf16 v[160:175], v[32:35], v[72:75], v[160:175]
    ds_read_b64_tr_b16 v[50:51], v8 offset:13312
    s_waitcnt lgkmcnt(6)
    v_add_u32 v8, s56, v4
    v_mfma_f32_32x32x16_bf16 v[112:127], v[36:39], a[120:123], v[112:127]
    ds_read_b64_tr_b16 v[52:53], v9 offset:12288
    v_mfma_f32_32x32x16_bf16 v[176:191], v[36:39], v[72:75], v[176:191]
    ds_read_b64_tr_b16 v[54:55], v9 offset:13312
    s_waitcnt lgkmcnt(6)
    v_add_u32 v9, s56, v5
    v_mfma_f32_32x32x16_bf16 v[128:143], v[40:43], a[120:123], v[128:143]
    ds_read_b64_tr_b16 v[56:57], v10 offset:12288
    v_mfma_f32_32x32x16_bf16 v[192:207], v[40:43], v[72:75], v[192:207]
    ds_read_b64_tr_b16 v[58:59], v10 offset:13312
    s_waitcnt lgkmcnt(6)
    v_add_u32 v10, s56, v6
    v_mfma_f32_32x32x16_bf16 v[144:159], v[44:47], a[120:123], v[144:159]
    ds_read_b64_tr_b16 v[60:61], v11 offset:12288
    v_mfma_f32_32x32x16_bf16 v[208:223], v[44:47], v[72:75], v[208:223]
    ds_read_b64_tr_b16 v[62:63], v11 offset:13312
    s_waitcnt lgkmcnt(6)
    v_add_u32 v11, s56, v7
    v_mfma_f32_32x32x16_bf16 v[96:111], v[48:51], a[124:127], v[96:111]
    ds_read_b64_tr_b16 v[32:33], v8 offset:0
    v_mfma_f32_32x32x16_bf16 v[160:175], v[48:51], v[76:79], v[160:175]
    ds_read_b64_tr_b16 v[34:35], v8 offset:1024
    s_waitcnt lgkmcnt(6)
    v_mfma_f32_32x32x16_bf16 v[112:127], v[52:55], a[124:127], v[112:127]
    ds_read_b64_tr_b16 v[36:37], v9 offset:0
    v_mfma_f32_32x32x16_bf16 v[176:191], v[52:55], v[76:79], v[176:191]
    ds_read_b64_tr_b16 v[38:39], v9 offset:1024
    s_waitcnt lgkmcnt(6)
    v_mfma_f32_32x32x16_bf16 v[128:143], v[56:59], a[124:127], v[128:143]
    ds_read_b64_tr_b16 v[40:41], v10 offset:0
    v_mfma_f32_32x32x16_bf16 v[192:207], v[56:59], v[76:79], v[192:207]
    ds_read_b64_tr_b16 v[42:43], v10 offset:1024
    s_waitcnt lgkmcnt(6)
    v_mfma_f32_32x32x16_bf16 v[144:159], v[60:63], a[124:127], v[144:159]
    ds_read_b64_tr_b16 v[44:45], v11 offset:0
    v_mfma_f32_32x32x16_bf16 v[208:223], v[60:63], v[76:79], v[208:223]
    ds_read_b64_tr_b16 v[46:47], v11 offset:1024
    s_waitcnt lgkmcnt(6)
    v_mfma_f32_32x32x16_bf16 v[96:111], v[32:35], a[128:131], v[96:111]
    ds_read_b64_tr_b16 v[48:49], v8 offset:4096
    s_waitcnt vmcnt(16)
    s_barrier
    v_mfma_f32_32x32x16_bf16 v[160:175], v[32:35], v[80:83], v[160:175]
    ds_read_b64_tr_b16 v[50:51], v8 offset:5120
    s_add_u32 m0, s46, 0
    s_nop 0
    buffer_load_dwordx4 v3, s[20:23], s44 offen  lds
    s_waitcnt lgkmcnt(6)
    v_mfma_f32_32x32x16_bf16 v[112:127], v[36:39], a[128:131], v[112:127]
    ds_read_b64_tr_b16 v[52:53], v9 offset:4096
    s_add_u32 m0, s46, 1024
    s_add_u32 s44, s44, s45
    buffer_load_dwordx4 v3, s[20:23], s44 offen  lds
    v_mfma_f32_32x32x16_bf16 v[176:191], v[36:39], v[80:83], v[176:191]
    ds_read_b64_tr_b16 v[54:55], v9 offset:5120
    s_add_u32 m0, s46, 2048
    s_add_u32 s44, s44, s45
    buffer_load_dwordx4 v3, s[20:23], s44 offen  lds
    s_waitcnt lgkmcnt(6)
    v_mfma_f32_32x32x16_bf16 v[128:143], v[40:43], a[128:131], v[128:143]
    ds_read_b64_tr_b16 v[56:57], v10 offset:4096
    s_add_u32 m0, s46, 3072
    s_add_u32 s44, s44, s45
    buffer_load_dwordx4 v3, s[20:23], s44 offen  lds
    v_mfma_f32_32x32x16_bf16 v[192:207], v[40:43], v[80:83], v[192:207]
    ds_read_b64_tr_b16 v[58:59], v10 offset:5120
    s_add_u32 s44, s44, s57
    s_add_u32 s46, s46, 16384
    s_and_b32 s46, s46, 131071
    s_waitcnt lgkmcnt(6)
    v_mfma_f32_32x32x16_bf16 v[144:159], v[44:47], a[128:131], v[144:159]
    ds_read_b64_tr_b16 v[60:61], v11 offset:4096
    s_add_u32 s56, s56, 16384
    s_and_b32 s56, s56, 131071
    v_mfma_f32_32x32x16_bf16 v[208:223], v[44:47], v[80:83], v[208:223]
    ds_read_b64_tr_b16 v[62:63], v11 offset:5120
    s_waitcnt lgkmcnt(6)
    v_mfma_f32_32x32x16_bf16 v[96:111], v[48:51], a[132:135], v[96:111]
    ds_read_b64_tr_b16 v[32:33], v8 offset:8192
    v_mfma_f32_32x32x16_bf16 v[160:175], v[48:51], v[84:87], v[160:175]
    ds_read_b64_tr_b16 v[34:35], v8 offset:9216
    s_waitcnt lgkmcnt(6)
    v_mfma_f32_32x32x16_bf16 v[112:127], v[52:55], a[132:135], v[112:127]
    ds_read_b64_tr_b16 v[36:37], v9 offset:8192
    v_mfma_f32_32x32x16_bf16 v[176:191], v[52:55], v[84:87], v[176:191]
    ds_read_b64_tr_b16 v[38:39], v9 offset:9216
    s_waitcnt lgkmcnt(6)
    v_mfma_f32_32x32x16_bf16 v[128:143], v[56:59], a[132:135], v[128:143]
    ds_read_b64_tr_b16 v[40:41], v10 offset:8192
    v_mfma_f32_32x32x16_bf16 v[192:207], v[56:59], v[84:87], v[192:207]
    ds_read_b64_tr_b16 v[42:43], v10 offset:9216
    s_waitcnt lgkmcnt(6)
    v_mfma_f32_32x32x16_bf16 v[144:159], v[60:63], a[132:135], v[144:159]
    ds_read_b64_tr_b16 v[44:45], v11 offset:8192
    v_mfma_f32_32x32x16_bf16 v[208:223], v[60:63], v[84:87], v[208:223]
    ds_read_b64_tr_b16 v[46:47], v11 offset:9216
    s_waitcnt lgkmcnt(6)
    v_mfma_f32_32x32x16_bf16 v[96:111], v[32:35], a[136:139], v[96:111]
    ds_read_b64_tr_b16 v[48:49], v8 offset:12288
    v_mfma_f32_32x32x16_bf16 v[160:175], v[32:35], v[88:91], v[160:175]
    ds_read_b64_tr_b16 v[50:51], v8 offset:13312
    s_waitcnt lgkmcnt(6)
    v_mfma_f32_32x32x16_bf16 v[112:127], v[36:39], a[136:139], v[112:127]
    ds_read_b64_tr_b16 v[52:53], v9 offset:12288
    v_mfma_f32_32x32x16_bf16 v[176:191], v[36:39], v[88:91], v[176:191]
    ds_read_b64_tr_b16 v[54:55], v9 offset:13312
    s_waitcnt lgkmcnt(6)
    v_mfma_f32_32x32x16_bf16 v[128:143], v[40:43], a[136:139], v[128:143]
    ds_read_b64_tr_b16 v[56:57], v10 offset:12288
    v_mfma_f32_32x32x16_bf16 v[192:207], v[40:43], v[88:91], v[192:207]
    ds_read_b64_tr_b16 v[58:59], v10 offset:13312
    s_waitcnt lgkmcnt(6)
    v_mfma_f32_32x32x16_bf16 v[144:159], v[44:47], a[136:139], v[144:159]
    ds_read_b64_tr_b16 v[60:61], v11 offset:12288
    v_mfma_f32_32x32x16_bf16 v[208:223], v[44:47], v[88:91], v[208:223]
    ds_read_b64_tr_b16 v[62:63], v11 offset:13312
    s_waitcnt lgkmcnt(6)
    v_mfma_f32_32x32x16_bf16 v[96:111], v[48:51], a[140:143], v[96:111]
    v_mfma_f32_32x32x16_bf16 v[160:175], v[48:51], v[92:95], v[160:175]
    s_waitcnt lgkmcnt(4)
    v_mfma_f32_32x32x16_bf16 v[112:127], v[52:55], a[140:143], v[112:127]
    v_mfma_f32_32x32x16_bf16 v[176:191], v[52:55], v[92:95], v[176:191]
    s_waitcnt lgkmcnt(2)
    v_mfma_f32_32x32x16_bf16 v[128:143], v[56:59], a[140:143], v[128:143]
    v_mfma_f32_32x32x16_bf16 v[192:207], v[56:59], v[92:95], v[192:207]
    s_waitcnt lgkmcnt(0)
    v_mfma_f32_32x32x16_bf16 v[144:159], v[60:63], a[140:143], v[144:159]
    v_mfma_f32_32x32x16_bf16 v[208:223], v[60:63], v[92:95], v[208:223]
    s_lshl_b32 s38, s12, 2
    s_add_u32 s38, s38, s13
    s_lshl_b32 s38, s38, 19
    s_and_b32 s39, s49, 31
    s_lshl_b32 s39, s39, 13
    s_add_u32 s38, s38, s39
    s_lshr_b32 s39, s49, 5
    s_cmp_eq_u32 s39, 2
    s_cselect_b32 s40, 0, 16777216
    s_cmp_eq_u32 s39, 1
    s_cselect_b32 s40, 33554432, s40
    s_add_u32 s64, s38, s40
    s_add_u32 s65, s64, 4096
    s_cmp_eq_u32 s39, 1
    s_cbranch_scc1 L_g1_v
    v_cvt_pk_bf16_f32 v224, v96, v104
    v_cvt_pk_bf16_f32 v225, v97, v105
    v_cvt_pk_bf16_f32 v226, v98, v106
    v_cvt_pk_bf16_f32 v227, v99, v107
    buffer_store_dwordx4 v[224:227], v12, s[4:7], s64 offen offset:0 sc1
    v_cvt_pk_bf16_f32 v228, v100, v108
    v_cvt_pk_bf16_f32 v229, v101, v109
    v_cvt_pk_bf16_f32 v230, v102, v110
    v_cvt_pk_bf16_f32 v231, v103, v111
    buffer_store_dwordx4 v[228:231], v12, s[4:7], s64 offen offset:512 sc1
    v_cvt_pk_bf16_f32 v232, v112, v120
    v_cvt_pk_bf16_f32 v233, v113, v121
    v_cvt_pk_bf16_f32 v234, v114, v122
    v_cvt_pk_bf16_f32 v235, v115, v123
    buffer_store_dwordx4 v[232:235], v12, s[4:7], s64 offen offset:2048 sc1
    v_cvt_pk_bf16_f32 v236, v116, v124
    v_cvt_pk_bf16_f32 v237, v117, v125
    v_cvt_pk_bf16_f32 v238, v118, v126
    v_cvt_pk_bf16_f32 v239, v119, v127
    buffer_store_dwordx4 v[236:239], v12, s[4:7], s64 offen offset:2560 sc1
    v_cvt_pk_bf16_f32 v240, v128, v136
    v_cvt_pk_bf16_f32 v241, v129, v137
    v_cvt_pk_bf16_f32 v242, v130, v138
    v_cvt_pk_bf16_f32 v243, v131, v139
    buffer_store_dwordx4 v[240:243], v12, s[4:7], s65 offen offset:0 sc1
    v_cvt_pk_bf16_f32 v244, v132, v140
    v_cvt_pk_bf16_f32 v245, v133, v141
    v_cvt_pk_bf16_f32 v246, v134, v142
    v_cvt_pk_bf16_f32 v247, v135, v143
    buffer_store_dwordx4 v[244:247], v12, s[4:7], s65 offen offset:512 sc1
    v_cvt_pk_bf16_f32 v248, v144, v152
    v_cvt_pk_bf16_f32 v249, v145, v153
    v_cvt_pk_bf16_f32 v250, v146, v154
    v_cvt_pk_bf16_f32 v251, v147, v155
    buffer_store_dwordx4 v[248:251], v12, s[4:7], s65 offen offset:2048 sc1
    v_cvt_pk_bf16_f32 v252, v148, v156
    v_cvt_pk_bf16_f32 v253, v149, v157
    v_cvt_pk_bf16_f32 v254, v150, v158
    v_cvt_pk_bf16_f32 v255, v151, v159
    buffer_store_dwordx4 v[252:255], v12, s[4:7], s65 offen offset:2560 sc1
    s_add_u32 s64, s64, 262144
    s_add_u32 s65, s65, 262144
    v_cvt_pk_bf16_f32 v224, v160, v168
    v_cvt_pk_bf16_f32 v225, v161, v169
    v_cvt_pk_bf16_f32 v226, v162, v170
    v_cvt_pk_bf16_f32 v227, v163, v171
    buffer_store_dwordx4 v[224:227], v12, s[4:7], s64 offen offset:0 sc1
    v_cvt_pk_bf16_f32 v228, v164, v172
    v_cvt_pk_bf16_f32 v229, v165, v173
    v_cvt_pk_bf16_f32 v230, v166, v174
    v_cvt_pk_bf16_f32 v231, v167, v175
    buffer_store_dwordx4 v[228:231], v12, s[4:7], s64 offen offset:512 sc1
    v_cvt_pk_bf16_f32 v232, v176, v184
    v_cvt_pk_bf16_f32 v233, v177, v185
    v_cvt_pk_bf16_f32 v234, v178, v186
    v_cvt_pk_bf16_f32 v235, v179, v187
    buffer_store_dwordx4 v[232:235], v12, s[4:7], s64 offen offset:2048 sc1
    v_cvt_pk_bf16_f32 v236, v180, v188
    v_cvt_pk_bf16_f32 v237, v181, v189
    v_cvt_pk_bf16_f32 v238, v182, v190
    v_cvt_pk_bf16_f32 v239, v183, v191
    buffer_store_dwordx4 v[236:239], v12, s[4:7], s64 offen offset:2560 sc1
    v_cvt_pk_bf16_f32 v240, v192, v200
    v_cvt_pk_bf16_f32 v241, v193, v201
    v_cvt_pk_bf16_f32 v242, v194, v202
    v_cvt_pk_bf16_f32 v243, v195, v203
    buffer_store_dwordx4 v[240:243], v12, s[4:7], s65 offen offset:0 sc1
    v_cvt_pk_bf16_f32 v244, v196, v204
    v_cvt_pk_bf16_f32 v245, v197, v205
    v_cvt_pk_bf16_f32 v246, v198, v206
    v_cvt_pk_bf16_f32 v247, v199, v207
    buffer_store_dwordx4 v[244:247], v12, s[4:7], s65 offen offset:512 sc1
    v_cvt_pk_bf16_f32 v248, v208, v216
    v_cvt_pk_bf16_f32 v249, v209, v217
    v_cvt_pk_bf16_f32 v250, v210, v218
    v_cvt_pk_bf16_f32 v251, v211, v219
    buffer_store_dwordx4 v[248:251], v12, s[4:7], s65 offen offset:2048 sc1
    v_cvt_pk_bf16_f32 v252, v212, v220
    v_cvt_pk_bf16_f32 v253, v213, v221
    v_cvt_pk_bf16_f32 v254, v214, v222
    v_cvt_pk_bf16_f32 v255, v215, v223
    buffer_store_dwordx4 v[252:255], v12, s[4:7], s65 offen offset:2560 sc1
    s_branch L_g1_next
L_g1_v:
    v_cvt_pk_bf16_f32 v224, v96, v104
    v_cvt_pk_bf16_f32 v225, v97, v105
    v_cvt_pk_bf16_f32 v226, v98, v106
    v_cvt_pk_bf16_f32 v227, v99, v107
    ds_write_b128 v13, v[224:227] offset:0
    v_cvt_pk_bf16_f32 v228, v100, v108
    v_cvt_pk_bf16_f32 v229, v101, v109
    v_cvt_pk_bf16_f32 v230, v102, v110
    v_cvt_pk_bf16_f32 v231, v103, v111
    ds_write_b128 v13, v[228:231] offset:32
    v_cvt_pk_bf16_f32 v232, v112, v120
    v_cvt_pk_bf16_f32 v233, v113, v121
    v_cvt_pk_bf16_f32 v234, v114, v122
    v_cvt_pk_bf16_f32 v235, v115, v123
    ds_write_b128 v13, v[232:235] offset:2048
    v_cvt_pk_bf16_f32 v236, v116, v124
    v_cvt_pk_bf16_f32 v237, v117, v125
    v_cvt_pk_bf16_f32 v238, v118, v126
    v_cvt_pk_bf16_f32 v239, v119, v127
    ds_write_b128 v13, v[236:239] offset:2080
    v_cvt_pk_bf16_f32 v240, v128, v136
    v_cvt_pk_bf16_f32 v241, v129, v137
    v_cvt_pk_bf16_f32 v242, v130, v138
    v_cvt_pk_bf16_f32 v243, v131, v139
    ds_write_b128 v13, v[240:243] offset:4096
    v_cvt_pk_bf16_f32 v244, v132, v140
    v_cvt_pk_bf16_f32 v245, v133, v141
    v_cvt_pk_bf16_f32 v246, v134, v142
    v_cvt_pk_bf16_f32 v247, v135, v143
    ds_write_b128 v13, v[244:247] offset:4128
    v_cvt_pk_bf16_f32 v248, v144, v152
    v_cvt_pk_bf16_f32 v249, v145, v153
    v_cvt_pk_bf16_f32 v250, v146, v154
    v_cvt_pk_bf16_f32 v251, v147, v155
    ds_write_b128 v13, v[248:251] offset:6144
    v_cvt_pk_bf16_f32 v252, v148, v156
    v_cvt_pk_bf16_f32 v253, v149, v157
    v_cvt_pk_bf16_f32 v254, v150, v158
    v_cvt_pk_bf16_f32 v255, v151, v159
    ds_write_b128 v13, v[252:255] offset:6176
    s_waitcnt lgkmcnt(0)
    ds_read_b128 v[96:99], v15 offset:0
    ds_read_b128 v[100:103], v15 offset:1024
    ds_read_b128 v[104:107], v15 offset:2048
    ds_read_b128 v[108:111], v15 offset:3072
    ds_read_b128 v[112:115], v15 offset:4096
    ds_read_b128 v[116:119], v15 offset:5120
    ds_read_b128 v[120:123], v15 offset:6144
    ds_read_b128 v[124:127], v15 offset:7168
    s_waitcnt lgkmcnt(7)
    buffer_store_dwordx4 v[96:99], v14, s[4:7], s64 offen offset:0 sc1
    s_waitcnt lgkmcnt(6)
    buffer_store_dwordx4 v[100:103], v14, s[4:7], s64 offen offset:1024 sc1
    s_waitcnt lgkmcnt(5)
    buffer_store_dwordx4 v[104:107], v14, s[4:7], s64 offen offset:2048 sc1
    s_waitcnt lgkmcnt(4)
    buffer_store_dwordx4 v[108:111], v14, s[4:7], s64 offen offset:3072 sc1
    s_waitcnt lgkmcnt(3)
    buffer_store_dwordx4 v[112:115], v14, s[4:7], s65 offen offset:0 sc1
    s_waitcnt lgkmcnt(2)
    buffer_store_dwordx4 v[116:119], v14, s[4:7], s65 offen offset:1024 sc1
    s_waitcnt lgkmcnt(1)
    buffer_store_dwordx4 v[120:123], v14, s[4:7], s65 offen offset:2048 sc1
    s_waitcnt lgkmcnt(0)
    buffer_store_dwordx4 v[124:127], v14, s[4:7], s65 offen offset:3072 sc1
    s_add_u32 s64, s64, 262144
    s_add_u32 s65, s65, 262144
    v_cvt_pk_bf16_f32 v224, v160, v168
    v_cvt_pk_bf16_f32 v225, v161, v169
    v_cvt_pk_bf16_f32 v226, v162, v170
    v_cvt_pk_bf16_f32 v227, v163, v171
    ds_write_b128 v13, v[224:227] offset:0
    v_cvt_pk_bf16_f32 v228, v164, v172
    v_cvt_pk_bf16_f32 v229, v165, v173
    v_cvt_pk_bf16_f32 v230, v166, v174
    v_cvt_pk_bf16_f32 v231, v167, v175
    ds_write_b128 v13, v[228:231] offset:32
    v_cvt_pk_bf16_f32 v232, v176, v184
    v_cvt_pk_bf16_f32 v233, v177, v185
    v_cvt_pk_bf16_f32 v234, v178, v186
    v_cvt_pk_bf16_f32 v235, v179, v187
    ds_write_b128 v13, v[232:235] offset:2048
    v_cvt_pk_bf16_f32 v236, v180, v188
    v_cvt_pk_bf16_f32 v237, v181, v189
    v_cvt_pk_bf16_f32 v238, v182, v190
    v_cvt_pk_bf16_f32 v239, v183, v191
    ds_write_b128 v13, v[236:239] offset:2080
    v_cvt_pk_bf16_f32 v240, v192, v200
    v_cvt_pk_bf16_f32 v241, v193, v201
    v_cvt_pk_bf16_f32 v242, v194, v202
    v_cvt_pk_bf16_f32 v243, v195, v203
    ds_write_b128 v13, v[240:243] offset:4096
    v_cvt_pk_bf16_f32 v244, v196, v204
    v_cvt_pk_bf16_f32 v245, v197, v205
    v_cvt_pk_bf16_f32 v246, v198, v206
    v_cvt_pk_bf16_f32 v247, v199, v207
    ds_write_b128 v13, v[244:247] offset:4128
    v_cvt_pk_bf16_f32 v248, v208, v216
    v_cvt_pk_bf16_f32 v249, v209, v217
    v_cvt_pk_bf16_f32 v250, v210, v218
    v_cvt_pk_bf16_f32 v251, v211, v219
    ds_write_b128 v13, v[248:251] offset:6144
    v_cvt_pk_bf16_f32 v252, v212, v220
    v_cvt_pk_bf16_f32 v253, v213, v221
    v_cvt_pk_bf16_f32 v254, v214, v222
    v_cvt_pk_bf16_f32 v255, v215, v223
    ds_write_b128 v13, v[252:255] offset:6176
    s_waitcnt lgkmcnt(0)
    ds_read_b128 v[160:163], v15 offset:0
    ds_read_b128 v[164:167], v15 offset:1024
    ds_read_b128 v[168:171], v15 offset:2048
    ds_read_b128 v[172:175], v15 offset:3072
    ds_read_b128 v[176:179], v15 offset:4096
    ds_read_b128 v[180:183], v15 offset:5120
    ds_read_b128 v[184:187], v15 offset:6144
    ds_read_b128 v[188:191], v15 offset:7168
    s_waitcnt lgkmcnt(7)
    buffer_store_dwordx4 v[160:163], v14, s[4:7], s64 offen offset:0 sc1
    s_waitcnt lgkmcnt(6)
    buffer_store_dwordx4 v[164:167], v14, s[4:7], s64 offen offset:1024 sc1
    s_waitcnt lgkmcnt(5)
    buffer_store_dwordx4 v[168:171], v14, s[4:7], s64 offen offset:2048 sc1
    s_waitcnt lgkmcnt(4)
    buffer_store_dwordx4 v[172:175], v14, s[4:7], s64 offen offset:3072 sc1
    s_waitcnt lgkmcnt(3)
    buffer_store_dwordx4 v[176:179], v14, s[4:7], s65 offen offset:0 sc1
    s_waitcnt lgkmcnt(2)
    buffer_store_dwordx4 v[180:183], v14, s[4:7], s65 offen offset:1024 sc1
    s_waitcnt lgkmcnt(1)
    buffer_store_dwordx4 v[184:187], v14, s[4:7], s65 offen offset:2048 sc1
    s_waitcnt lgkmcnt(0)
    buffer_store_dwordx4 v[188:191], v14, s[4:7], s65 offen offset:3072 sc1
    s_branch L_g1_next
L_g1_glu:
    v_bfe_u32 v19, v18, 2, 2
    v_lshrrev_b32 v20, 5, v18
    v_lshl_add_u32 v20, v20, 3, v19
    v_lshlrev_b32 v20, 7, v20
    v_bfe_u32 v21, v18, 4, 1
    v_lshl_add_u32 v20, v21, 5, v20
    v_and_b32 v21, 3, v18
    v_lshl_add_u32 v20, v21, 3, v20
    v_lshrrev_b32 v19, 1, v19
    v_xor_b32 v21, 0, v19
    v_lshl_add_u32 v4, v21, 6, v20
    v_xor_b32 v21, 1, v19
    v_lshl_add_u32 v5, v21, 6, v20
    v_xor_b32 v21, 0, v19
    v_lshl_add_u32 v6, v21, 6, v20
    v_add_u32 v6, 8192, v6
    v_xor_b32 v21, 1, v19
    v_lshl_add_u32 v7, v21, 6, v20
    v_add_u32 v7, 8192, v7
    v_add_u32 v8, s56, v4
    v_add_u32 v9, s56, v5
    v_add_u32 v10, s56, v6
    v_add_u32 v11, s56, v7
    ds_read_b64_tr_b16 v[32:33], v8 offset:0
    ds_read_b64_tr_b16 v[34:35], v8 offset:512
    ds_read_b64_tr_b16 v[36:37], v9 offset:0
    ds_read_b64_tr_b16 v[38:39], v9 offset:512
    ds_read_b64_tr_b16 v[40:41], v10 offset:0
    ds_read_b64_tr_b16 v[42:43], v10 offset:512
    ds_read_b64_tr_b16 v[44:45], v11 offset:0
    ds_read_b64_tr_b16 v[46:47], v11 offset:512
    s_waitcnt lgkmcnt(6)
    v_mfma_f32_32x32x16_bf16 v[96:111], v[32:35], a[0:3], 0
    ds_read_b64_tr_b16 v[48:49], v8 offset:2048
    s_waitcnt vmcnt(24)
    s_barrier
    v_mfma_f32_32x32x16_bf16 v[160:175], v[32:35], a[144:147], 0
    ds_read_b64_tr_b16 v[50:51], v8 offset:2560
    s_add_u32 m0, s46, 0
    s_nop 0
    buffer_load_dwordx4 v3, s[20:23], s44 offen  lds
    s_waitcnt lgkmcnt(6)
    v_mfma_f32_32x32x16_bf16 v[112:127], v[36:39], a[0:3], 0
    ds_read_b64_tr_b16 v[52:53], v9 offset:2048
    s_add_u32 m0, s46, 1024
    s_add_u32 s44, s44, s45
    buffer_load_dwordx4 v3, s[20:23], s44 offen  lds
    v_mfma_f32_32x32x16_bf16 v[176:191], v[36:39], a[144:147], 0
    ds_read_b64_tr_b16 v[54:55], v9 offset:2560
    s_add_u32 m0, s46, 2048
    s_add_u32 s44, s44, s45
    buffer_load_dwordx4 v3, s[20:23], s44 offen  lds
    s_waitcnt lgkmcnt(6)
    v_mfma_f32_32x32x16_bf16 v[128:143], v[40:43], a[0:3], 0
    ds_read_b64_tr_b16 v[56:57], v10 offset:2048
    s_add_u32 m0, s46, 3072
    s_add_u32 s44, s44, s45
    buffer_load_dwordx4 v3, s[20:23], s44 offen  lds
    v_mfma_f32_32x32x16_bf16 v[192:207], v[40:43], a[144:147], 0
    ds_read_b64_tr_b16 v[58:59], v10 offset:2560
    s_add_u32 s44, s44, s57
    s_add_u32 s46, s46, 16384
    s_and_b32 s46, s46, 131071
    s_waitcnt lgkmcnt(6)
    v_mfma_f32_32x32x16_bf16 v[144:159], v[44:47], a[0:3], 0
    ds_read_b64_tr_b16 v[60:61], v11 offset:2048
    s_add_u32 s56, s56, 16384
    s_and_b32 s56, s56, 131071
    v_mfma_f32_32x32x16_bf16 v[208:223], v[44:47], a[144:147], 0
    ds_read_b64_tr_b16 v[62:63], v11 offset:2560
    s_waitcnt lgkmcnt(6)
    v_mfma_f32_32x32x16_bf16 v[96:111], v[48:51], a[4:7], v[96:111]
    ds_read_b64_tr_b16 v[32:33], v8 offset:4096
    v_mfma_f32_32x32x16_bf16 v[160:175], v[48:51], a[148:151], v[160:175]
    ds_read_b64_tr_b16 v[34:35], v8 offset:4608
    s_waitcnt lgkmcnt(6)
    v_mfma_f32_32x32x16_bf16 v[112:127], v[52:55], a[4:7], v[112:127]
    ds_read_b64_tr_b16 v[36:37], v9 offset:4096
    v_mfma_f32_32x32x16_bf16 v[176:191], v[52:55], a[148:151], v[176:191]
    ds_read_b64_tr_b16 v[38:39], v9 offset:4608
    s_waitcnt lgkmcnt(6)
    v_mfma_f32_32x32x16_bf16 v[128:143], v[56:59], a[4:7], v[128:143]
    ds_read_b64_tr_b16 v[40:41], v10 offset:4096
    v_mfma_f32_32x32x16_bf16 v[192:207], v[56:59], a[148:151], v[192:207]
    ds_read_b64_tr_b16 v[42:43], v10 offset:4608
    s_waitcnt lgkmcnt(6)
    v_mfma_f32_32x32x16_bf16 v[144:159], v[60:63], a[4:7], v[144:159]
    ds_read_b64_tr_b16 v[44:45], v11 offset:4096
    v_mfma_f32_32x32x16_bf16 v[208:223], v[60:63], a[148:151], v[208:223]
    ds_read_b64_tr_b16 v[46:47], v11 offset:4608
    s_waitcnt lgkmcnt(6)
    v_mfma_f32_32x32x16_bf16 v[96:111], v[32:35], a[8:11], v[96:111]
    ds_read_b64_tr_b16 v[48:49], v8 offset:6144
    v_mfma_f32_32x32x16_bf16 v[160:175], v[32:35], a[152:155], v[160:175]
    ds_read_b64_tr_b16 v[50:51], v8 offset:6656
    s_waitcnt lgkmcnt(6)
    v_add_u32 v8, s56, v4
    v_mfma_f32_32x32x16_bf16 v[112:127], v[36:39], a[8:11], v[112:127]
    ds_read_b64_tr_b16 v[52:53], v9 offset:6144
    v_mfma_f32_32x32x16_bf16 v[176:191], v[36:39], a[152:155], v[176:191]
    ds_read_b64_tr_b16 v[54:55], v9 offset:6656
    s_waitcnt lgkmcnt(6)
    v_add_u32 v9, s56, v5
    v_mfma_f32_32x32x16_bf16 v[128:143], v[40:43], a[8:11], v[128:143]
    ds_read_b64_tr_b16 v[56:57], v10 offset:6144
    v_mfma_f32_32x32x16_bf16 v[192:207], v[40:43], a[152:155], v[192:207]
    ds_read_b64_tr_b16 v[58:59], v10 offset:6656
    s_waitcnt lgkmcnt(6)
    v_add_u32 v10, s56, v6
    v_mfma_f32_32x32x16_bf16 v[144:159], v[44:47], a[8:11], v[144:159]
    ds_read_b64_tr_b16 v[60:61], v11 offset:6144
    v_mfma_f32_32x32x16_bf16 v[208:223], v[44:47], a[152:155], v[208:223]
    ds_read_b64_tr_b16 v[62:63], v11 offset:6656
    s_waitcnt lgkmcnt(6)
    v_add_u32 v11, s56, v7
    v_mfma_f32_32x32x16_bf16 v[96:111], v[48:51], a[12:15], v[96:111]
    ds_read_b64_tr_b16 v[32:33], v8 offset:0
    v_mfma_f32_32x32x16_bf16 v[160:175], v[48:51], a[156:159], v[160:175]
    ds_read_b64_tr_b16 v[34:35], v8 offset:512
    s_waitcnt lgkmcnt(6)
    v_mfma_f32_32x32x16_bf16 v[112:127], v[52:55], a[12:15], v[112:127]
    ds_read_b64_tr_b16 v[36:37], v9 offset:0
    v_mfma_f32_32x32x16_bf16 v[176:191], v[52:55], a[156:159], v[176:191]
    ds_read_b64_tr_b16 v[38:39], v9 offset:512
    s_waitcnt lgkmcnt(6)
    v_mfma_f32_32x32x16_bf16 v[128:143], v[56:59], a[12:15], v[128:143]
    ds_read_b64_tr_b16 v[40:41], v10 offset:0
    v_mfma_f32_32x32x16_bf16 v[192:207], v[56:59], a[156:159], v[192:207]
    ds_read_b64_tr_b16 v[42:43], v10 offset:512
    s_waitcnt lgkmcnt(6)
    v_mfma_f32_32x32x16_bf16 v[144:159], v[60:63], a[12:15], v[144:159]
    ds_read_b64_tr_b16 v[44:45], v11 offset:0
    v_mfma_f32_32x32x16_bf16 v[208:223], v[60:63], a[156:159], v[208:223]
    ds_read_b64_tr_b16 v[46:47], v11 offset:512
    s_waitcnt lgkmcnt(6)
    v_mfma_f32_32x32x16_bf16 v[96:111], v[32:35], a[16:19], v[96:111]
    ds_read_b64_tr_b16 v[48:49], v8 offset:2048
    s_waitcnt vmcnt(24)
    s_barrier
    v_mfma_f32_32x32x16_bf16 v[160:175], v[32:35], a[160:163], v[160:175]
    ds_read_b64_tr_b16 v[50:51], v8 offset:2560
    s_add_u32 m0, s46, 0
    s_nop 0
    buffer_load_dwordx4 v3, s[20:23], s44 offen  lds
    s_waitcnt lgkmcnt(6)
    v_mfma_f32_32x32x16_bf16 v[112:127], v[36:39], a[16:19], v[112:127]
    ds_read_b64_tr_b16 v[52:53], v9 offset:2048
    s_add_u32 m0, s46, 1024
    s_add_u32 s44, s44, s45
    buffer_load_dwordx4 v3, s[20:23], s44 offen  lds
    v_mfma_f32_32x32x16_bf16 v[176:191], v[36:39], a[160:163], v[176:191]
    ds_read_b64_tr_b16 v[54:55], v9 offset:2560
    s_add_u32 m0, s46, 2048
    s_add_u32 s44, s44, s45
    buffer_load_dwordx4 v3, s[20:23], s44 offen  lds
    s_waitcnt lgkmcnt(6)
    v_mfma_f32_32x32x16_bf16 v[128:143], v[40:43], a[16:19], v[128:143]
    ds_read_b64_tr_b16 v[56:57], v10 offset:2048
    s_add_u32 m0, s46, 3072
    s_add_u32 s44, s44, s45
    buffer_load_dwordx4 v3, s[20:23], s44 offen  lds
    v_mfma_f32_32x32x16_bf16 v[192:207], v[40:43], a[160:163], v[192:207]
    ds_read_b64_tr_b16 v[58:59], v10 offset:2560
    s_add_u32 s44, s44, s57
    s_add_u32 s46, s46, 16384
    s_and_b32 s46, s46, 131071
    s_waitcnt lgkmcnt(6)
    v_mfma_f32_32x32x16_bf16 v[144:159], v[44:47], a[16:19], v[144:159]
    ds_read_b64_tr_b16 v[60:61], v11 offset:2048
    s_add_u32 s56, s56, 16384
    s_and_b32 s56, s56, 131071
    v_mfma_f32_32x32x16_bf16 v[208:223], v[44:47], a[160:163], v[208:223]
    ds_read_b64_tr_b16 v[62:63], v11 offset:2560
    s_waitcnt lgkmcnt(6)
    v_mfma_f32_32x32x16_bf16 v[96:111], v[48:51], a[20:23], v[96:111]
    ds_read_b64_tr_b16 v[32:33], v8 offset:4096
    v_mfma_f32_32x32x16_bf16 v[160:175], v[48:51], a[164:167], v[160:175]
    ds_read_b64_tr_b16 v[34:35], v8 offset:4608
    s_waitcnt lgkmcnt(6)
    v_mfma_f32_32x32x16_bf16 v[112:127], v[52:55], a[20:23], v[112:127]
    ds_read_b64_tr_b16 v[36:37], v9 offset:4096
    v_mfma_f32_32x32x16_bf16 v[176:191], v[52:55], a[164:167], v[176:191]
    ds_read_b64_tr_b16 v[38:39], v9 offset:4608
    s_waitcnt lgkmcnt(6)
    v_mfma_f32_32x32x16_bf16 v[128:143], v[56:59], a[20:23], v[128:143]
    ds_read_b64_tr_b16 v[40:41], v10 offset:4096
    v_mfma_f32_32x32x16_bf16 v[192:207], v[56:59], a[164:167], v[192:207]
    ds_read_b64_tr_b16 v[42:43], v10 offset:4608
    s_waitcnt lgkmcnt(6)
    v_mfma_f32_32x32x16_bf16 v[144:159], v[60:63], a[20:23], v[144:159]
    ds_read_b64_tr_b16 v[44:45], v11 offset:4096
    v_mfma_f32_32x32x16_bf16 v[208:223], v[60:63], a[164:167], v[208:223]
    ds_read_b64_tr_b16 v[46:47], v11 offset:4608
    s_waitcnt lgkmcnt(6)
    v_mfma_f32_32x32x16_bf16 v[96:111], v[32:35], a[24:27], v[96:111]
    ds_read_b64_tr_b16 v[48:49], v8 offset:6144
    v_mfma_f32_32x32x16_bf16 v[160:175], v[32:35], a[168:171], v[160:175]
    ds_read_b64_tr_b16 v[50:51], v8 offset:6656
    s_waitcnt lgkmcnt(6)
    v_add_u32 v8, s56, v4
    v_mfma_f32_32x32x16_bf16 v[112:127], v[36:39], a[24:27], v[112:127]
    ds_read_b64_tr_b16 v[52:53], v9 offset:6144
    v_mfma_f32_32x32x16_bf16 v[176:191], v[36:39], a[168:171], v[176:191]
    ds_read_b64_tr_b16 v[54:55], v9 offset:6656
    s_waitcnt lgkmcnt(6)
    v_add_u32 v9, s56, v5
    v_mfma_f32_32x32x16_bf16 v[128:143], v[40:43], a[24:27], v[128:143]
    ds_read_b64_tr_b16 v[56:57], v10 offset:6144
    v_mfma_f32_32x32x16_bf16 v[192:207], v[40:43], a[168:171], v[192:207]
    ds_read_b64_tr_b16 v[58:59], v10 offset:6656
    s_waitcnt lgkmcnt(6)
    v_add_u32 v10, s56, v6
    v_mfma_f32_32x32x16_bf16 v[144:159], v[44:47], a[24:27], v[144:159]
    ds_read_b64_tr_b16 v[60:61], v11 offset:6144
    v_mfma_f32_32x32x16_bf16 v[208:223], v[44:47], a[168:171], v[208:223]
    ds_read_b64_tr_b16 v[62:63], v11 offset:6656
    s_waitcnt lgkmcnt(6)
    v_add_u32 v11, s56, v7
    v_mfma_f32_32x32x16_bf16 v[96:111], v[48:51], a[28:31], v[96:111]
    ds_read_b64_tr_b16 v[32:33], v8 offset:0
    v_mfma_f32_32x32x16_bf16 v[160:175], v[48:51], a[172:175], v[160:175]
    ds_read_b64_tr_b16 v[34:35], v8 offset:512
    s_waitcnt lgkmcnt(6)
    v_mfma_f32_32x32x16_bf16 v[112:127], v[52:55], a[28:31], v[112:127]
    ds_read_b64_tr_b16 v[36:37], v9 offset:0
    v_mfma_f32_32x32x16_bf16 v[176:191], v[52:55], a[172:175], v[176:191]
    ds_read_b64_tr_b16 v[38:39], v9 offset:512
    s_waitcnt lgkmcnt(6)
    v_mfma_f32_32x32x16_bf16 v[128:143], v[56:59], a[28:31], v[128:143]
    ds_read_b64_tr_b16 v[40:41], v10 offset:0
    v_mfma_f32_32x32x16_bf16 v[192:207], v[56:59], a[172:175], v[192:207]
    ds_read_b64_tr_b16 v[42:43], v10 offset:512
    s_waitcnt lgkmcnt(6)
    v_mfma_f32_32x32x16_bf16 v[144:159], v[60:63], a[28:31], v[144:159]
    ds_read_b64_tr_b16 v[44:45], v11 offset:0
    v_mfma_f32_32x32x16_bf16 v[208:223], v[60:63], a[172:175], v[208:223]
    ds_read_b64_tr_b16 v[46:47], v11 offset:512
    s_waitcnt lgkmcnt(6)
    v_mfma_f32_32x32x16_bf16 v[96:111], v[32:35], a[32:35], v[96:111]
    ds_read_b64_tr_b16 v[48:49], v8 offset:2048
    s_waitcnt vmcnt(24)
    s_barrier
    v_mfma_f32_32x32x16_bf16 v[160:175], v[32:35], a[176:179], v[160:175]
    ds_read_b64_tr_b16 v[50:51], v8 offset:2560
    s_add_u32 m0, s46, 0
    s_nop 0
    buffer_load_dwordx4 v3, s[20:23], s44 offen  lds
    s_waitcnt lgkmcnt(6)
    v_mfma_f32_32x32x16_bf16 v[112:127], v[36:39], a[32:35], v[112:127]
    ds_read_b64_tr_b16 v[52:53], v9 offset:2048
    s_add_u32 m0, s46, 1024
    s_add_u32 s44, s44, s45
    buffer_load_dwordx4 v3, s[20:23], s44 offen  lds
    v_mfma_f32_32x32x16_bf16 v[176:191], v[36:39], a[176:179], v[176:191]
    ds_read_b64_tr_b16 v[54:55], v9 offset:2560
    s_add_u32 m0, s46, 2048
    s_add_u32 s44, s44, s45
    buffer_load_dwordx4 v3, s[20:23], s44 offen  lds
    s_waitcnt lgkmcnt(6)
    v_mfma_f32_32x32x16_bf16 v[128:143], v[40:43], a[32:35], v[128:143]
    ds_read_b64_tr_b16 v[56:57], v10 offset:2048
    s_add_u32 m0, s46, 3072
    s_add_u32 s44, s44, s45
    buffer_load_dwordx4 v3, s[20:23], s44 offen  lds
    v_mfma_f32_32x32x16_bf16 v[192:207], v[40:43], a[176:179], v[192:207]
    ds_read_b64_tr_b16 v[58:59], v10 offset:2560
    s_add_u32 s44, s44, s57
    s_add_u32 s46, s46, 16384
    s_and_b32 s46, s46, 131071
    s_waitcnt lgkmcnt(6)
    v_mfma_f32_32x32x16_bf16 v[144:159], v[44:47], a[32:35], v[144:159]
    ds_read_b64_tr_b16 v[60:61], v11 offset:2048
    s_add_u32 s56, s56, 16384
    s_and_b32 s56, s56, 131071
    v_mfma_f32_32x32x16_bf16 v[208:223], v[44:47], a[176:179], v[208:223]
    ds_read_b64_tr_b16 v[62:63], v11 offset:2560
    s_waitcnt lgkmcnt(6)
    v_mfma_f32_32x32x16_bf16 v[96:111], v[48:51], a[36:39], v[96:111]
    ds_read_b64_tr_b16 v[32:33], v8 offset:4096
    s_cmp_eq_u32 s42, s62
    s_cselect_b32 s38, s61, 0
    s_add_u32 s42, s42, s38
    s_add_u32 s42, s42, 1
    s_add_u32 s38, s42, s63
    s_cmp_ge_u32 s38, 7
    s_cselect_b32 s41, 7, 0
    s_sub_u32 s38, s38, s41
    s_mul_i32 s38, s38, 24
    s_add_u32 s38, s38, s14
    s_add_u32 s38, s38, s60
    s_cmp_ge_u32 s38, 96
    s_cbranch_scc1 Lg_13
    s_lshr_b32 s39, s38, 5
    s_cmp_eq_u32 s39, 0
    s_cselect_b64 s[20:21], s[30:31], s[32:33]
    s_cmp_eq_u32 s39, 2
    s_cselect_b64 s[20:21], s[28:29], s[20:21]
    s_mov_b32 s22, 4718592
    s_and_b32 s38, s38, 31
    s_lshl_b32 s44, s38, 8
    s_lshl_b32 s39, s13, 17
    s_add_u32 s44, s44, s39
    s_mov_b32 s45, 32768
    s_mov_b32 s57, 425984
    v_mov_b32 v3, v1
    s_branch Le_14
Lg_13:
    s_cmp_lt_u32 s13, 2
    s_cselect_b64 s[20:21], s[34:35], s[36:37]
    s_mov_b32 s22, 5308416
    s_sub_u32 s38, s38, 96
    s_lshl_b32 s44, s38, 7
    s_and_b32 s39, s13, 1
    s_mul_i32 s39, s39, 294912
    s_add_u32 s44, s44, s39
    s_mov_b32 s45, 73728
    s_mov_b32 s57, 368640
    v_mov_b32 v3, v2
Le_14:
    s_cmp_lt_u32 s42, s59
    s_cselect_b32 s22, s22, 0
    v_mfma_f32_32x32x16_bf16 v[160:175], v[48:51], a[180:183], v[160:175]
    ds_read_b64_tr_b16 v[34:35], v8 offset:4608
    s_waitcnt lgkmcnt(6)
    v_mfma_f32_32x32x16_bf16 v[112:127], v[52:55], a[36:39], v[112:127]
    ds_read_b64_tr_b16 v[36:37], v9 offset:4096
    v_mfma_f32_32x32x16_bf16 v[176:191], v[52:55], a[180:183], v[176:191]
    ds_read_b64_tr_b16 v[38:39], v9 offset:4608
    s_waitcnt lgkmcnt(6)
    v_mfma_f32_32x32x16_bf16 v[128:143], v[56:59], a[36:39], v[128:143]
    ds_read_b64_tr_b16 v[40:41], v10 offset:4096
    v_mfma_f32_32x32x16_bf16 v[192:207], v[56:59], a[180:183], v[192:207]
    ds_read_b64_tr_b16 v[42:43], v10 offset:4608
    s_waitcnt lgkmcnt(6)
    v_mfma_f32_32x32x16_bf16 v[144:159], v[60:63], a[36:39], v[144:159]
    ds_read_b64_tr_b16 v[44:45], v11 offset:4096
    v_mfma_f32_32x32x16_bf16 v[208:223], v[60:63], a[180:183], v[208:223]
    ds_read_b64_tr_b16 v[46:47], v11 offset:4608
    s_waitcnt lgkmcnt(6)
    v_mfma_f32_32x32x16_bf16 v[96:111], v[32:35], a[40:43], v[96:111]
    ds_read_b64_tr_b16 v[48:49], v8 offset:6144
    v_mfma_f32_32x32x16_bf16 v[160:175], v[32:35], a[184:187], v[160:175]
    ds_read_b64_tr_b16 v[50:51], v8 offset:6656
    s_waitcnt lgkmcnt(6)
    v_add_u32 v8, s56, v4
    v_mfma_f32_32x32x16_bf16 v[112:127], v[36:39], a[40:43], v[112:127]
    ds_read_b64_tr_b16 v[52:53], v9 offset:6144
    v_mfma_f32_32x32x16_bf16 v[176:191], v[36:39], a[184:187], v[176:191]
    ds_read_b64_tr_b16 v[54:55], v9 offset:6656
    s_waitcnt lgkmcnt(6)
    v_add_u32 v9, s56, v5
    v_mfma_f32_32x32x16_bf16 v[128:143], v[40:43], a[40:43], v[128:143]
    ds_read_b64_tr_b16 v[56:57], v10 offset:6144
    v_mfma_f32_32x32x16_bf16 v[192:207], v[40:43], a[184:187], v[192:207]
    ds_read_b64_tr_b16 v[58:59], v10 offset:6656
    s_waitcnt lgkmcnt(6)
    v_add_u32 v10, s56, v6
    v_mfma_f32_32x32x16_bf16 v[144:159], v[44:47], a[40:43], v[144:159]
    ds_read_b64_tr_b16 v[60:61], v11 offset:6144
    v_mfma_f32_32x32x16_bf16 v[208:223], v[44:47], a[184:187], v[208:223]
    ds_read_b64_tr_b16 v[62:63], v11 offset:6656
    s_waitcnt lgkmcnt(6)
    v_add_u32 v11, s56, v7
    v_mfma_f32_32x32x16_bf16 v[96:111], v[48:51], a[44:47], v[96:111]
    ds_read_b64_tr_b16 v[32:33], v8 offset:0
    v_mfma_f32_32x32x16_bf16 v[160:175], v[48:51], a[188:191], v[160:175]
    ds_read_b64_tr_b16 v[34:35], v8 offset:512
    s_waitcnt lgkmcnt(6)
    v_mfma_f32_32x32x16_bf16 v[112:127], v[52:55], a[44:47], v[112:127]
    ds_read_b64_tr_b16 v[36:37], v9 offset:0
    v_mfma_f32_32x32x16_bf16 v[176:191], v[52:55], a[188:191], v[176:191]
    ds_read_b64_tr_b16 v[38:39], v9 offset:512
    s_waitcnt lgkmcnt(6)
    v_mfma_f32_32x32x16_bf16 v[128:143], v[56:59], a[44:47], v[128:143]
    ds_read_b64_tr_b16 v[40:41], v10 offset:0
    v_mfma_f32_32x32x16_bf16 v[192:207], v[56:59], a[188:191], v[192:207]
    ds_read_b64_tr_b16 v[42:43], v10 offset:512
    s_waitcnt lgkmcnt(6)
    v_mfma_f32_32x32x16_bf16 v[144:159], v[60:63], a[44:47], v[144:159]
    ds_read_b64_tr_b16 v[44:45], v11 offset:0
    v_mfma_f32_32x32x16_bf16 v[208:223], v[60:63], a[188:191], v[208:223]
    ds_read_b64_tr_b16 v[46:47], v11 offset:512
    s_waitcnt lgkmcnt(6)
    v_mfma_f32_32x32x16_bf16 v[96:111], v[32:35], a[48:51], v[96:111]
    ds_read_b64_tr_b16 v[48:49], v8 offset:2048
    s_waitcnt vmcnt(24)
    s_barrier
    v_mfma_f32_32x32x16_bf16 v[160:175], v[32:35], a[192:195], v[160:175]
    ds_read_b64_tr_b16 v[50:51], v8 offset:2560
    s_add_u32 m0, s46, 0
    s_nop 0
    buffer_load_dwordx4 v3, s[20:23], s44 offen  lds
    s_waitcnt lgkmcnt(6)
    v_mfma_f32_32x32x16_bf16 v[112:127], v[36:39], a[48:51], v[112:127]
    ds_read_b64_tr_b16 v[52:53], v9 offset:2048
    s_add_u32 m0, s46, 1024
    s_add_u32 s44, s44, s45
    buffer_load_dwordx4 v3, s[20:23], s44 offen  lds
    v_mfma_f32_32x32x16_bf16 v[176:191], v[36:39], a[192:195], v[176:191]
    ds_read_b64_tr_b16 v[54:55], v9 offset:2560
    s_add_u32 m0, s46, 2048
    s_add_u32 s44, s44, s45
    buffer_load_dwordx4 v3, s[20:23], s44 offen  lds
    s_waitcnt lgkmcnt(6)
    v_mfma_f32_32x32x16_bf16 v[128:143], v[40:43], a[48:51], v[128:143]
    ds_read_b64_tr_b16 v[56:57], v10 offset:2048
    s_add_u32 m0, s46, 3072
    s_add_u32 s44, s44, s45
    buffer_load_dwordx4 v3, s[20:23], s44 offen  lds
    v_mfma_f32_32x32x16_bf16 v[192:207], v[40:43], a[192:195], v[192:207]
    ds_read_b64_tr_b16 v[58:59], v10 offset:2560
    s_add_u32 s44, s44, s57
    s_add_u32 s46, s46, 16384
    s_and_b32 s46, s46, 131071
    s_waitcnt lgkmcnt(6)
    v_mfma_f32_32x32x16_bf16 v[144:159], v[44:47], a[48:51], v[144:159]
    ds_read_b64_tr_b16 v[60:61], v11 offset:2048
    s_add_u32 s56, s56, 16384
    s_and_b32 s56, s56, 131071
    v_mfma_f32_32x32x16_bf16 v[208:223], v[44:47], a[192:195], v[208:223]
    ds_read_b64_tr_b16 v[62:63], v11 offset:2560
    s_waitcnt lgkmcnt(6)
    v_mfma_f32_32x32x16_bf16 v[96:111], v[48:51], a[52:55], v[96:111]
    ds_read_b64_tr_b16 v[32:33], v8 offset:4096
    v_mfma_f32_32x32x16_bf16 v[160:175], v[48:51], a[196:199], v[160:175]
    ds_read_b64_tr_b16 v[34:35], v8 offset:4608
    s_waitcnt lgkmcnt(6)
    v_mfma_f32_32x32x16_bf16 v[112:127], v[52:55], a[52:55], v[112:127]
    ds_read_b64_tr_b16 v[36:37], v9 offset:4096
    v_mfma_f32_32x32x16_bf16 v[176:191], v[52:55], a[196:199], v[176:191]
    ds_read_b64_tr_b16 v[38:39], v9 offset:4608
    s_waitcnt lgkmcnt(6)
    v_mfma_f32_32x32x16_bf16 v[128:143], v[56:59], a[52:55], v[128:143]
    ds_read_b64_tr_b16 v[40:41], v10 offset:4096
    v_mfma_f32_32x32x16_bf16 v[192:207], v[56:59], a[196:199], v[192:207]
    ds_read_b64_tr_b16 v[42:43], v10 offset:4608
    s_waitcnt lgkmcnt(6)
    v_mfma_f32_32x32x16_bf16 v[144:159], v[60:63], a[52:55], v[144:159]
    ds_read_b64_tr_b16 v[44:45], v11 offset:4096
    v_mfma_f32_32x32x16_bf16 v[208:223], v[60:63], a[196:199], v[208:223]
    ds_read_b64_tr_b16 v[46:47], v11 offset:4608
    s_waitcnt lgkmcnt(6)
    v_mfma_f32_32x32x16_bf16 v[96:111], v[32:35], a[56:59], v[96:111]
    ds_read_b64_tr_b16 v[48:49], v8 offset:6144
    v_mfma_f32_32x32x16_bf16 v[160:175], v[32:35], a[200:203], v[160:175]
    ds_read_b64_tr_b16 v[50:51], v8 offset:6656
    s_waitcnt lgkmcnt(6)
    v_add_u32 v8, s56, v4
    v_mfma_f32_32x32x16_bf16 v[112:127], v[36:39], a[56:59], v[112:127]
    ds_read_b64_tr_b16 v[52:53], v9 offset:6144
    v_mfma_f32_32x32x16_bf16 v[176:191], v[36:39], a[200:203], v[176:191]
    ds_read_b64_tr_b16 v[54:55], v9 offset:6656
    s_waitcnt lgkmcnt(6)
    v_add_u32 v9, s56, v5
    v_mfma_f32_32x32x16_bf16 v[128:143], v[40:43], a[56:59], v[128:143]
    ds_read_b64_tr_b16 v[56:57], v10 offset:6144
    v_mfma_f32_32x32x16_bf16 v[192:207], v[40:43], a[200:203], v[192:207]
    ds_read_b64_tr_b16 v[58:59], v10 offset:6656
    s_waitcnt lgkmcnt(6)
    v_add_u32 v10, s56, v6
    v_mfma_f32_32x32x16_bf16 v[144:159], v[44:47], a[56:59], v[144:159]
    ds_read_b64_tr_b16 v[60:61], v11 offset:6144
    v_mfma_f32_32x32x16_bf16 v[208:223], v[44:47], a[200:203], v[208:223]
    ds_read_b64_tr_b16 v[62:63], v11 offset:6656
    s_waitcnt lgkmcnt(6)
    v_add_u32 v11, s56, v7
    v_mfma_f32_32x32x16_bf16 v[96:111], v[48:51], a[60:63], v[96:111]
    ds_read_b64_tr_b16 v[32:33], v8 offset:0
    v_mfma_f32_32x32x16_bf16 v[160:175], v[48:51], a[204:207], v[160:175]
    ds_read_b64_tr_b16 v[34:35], v8 offset:512
    s_waitcnt lgkmcnt(6)
    v_mfma_f32_32x32x16_bf16 v[112:127], v[52:55], a[60:63], v[112:127]
    ds_read_b64_tr_b16 v[36:37], v9 offset:0
    v_mfma_f32_32x32x16_bf16 v[176:191], v[52:55], a[204:207], v[176:191]
    ds_read_b64_tr_b16 v[38:39], v9 offset:512
    s_waitcnt lgkmcnt(6)
    v_mfma_f32_32x32x16_bf16 v[128:143], v[56:59], a[60:63], v[128:143]
    ds_read_b64_tr_b16 v[40:41], v10 offset:0
    v_mfma_f32_32x32x16_bf16 v[192:207], v[56:59], a[204:207], v[192:207]
    ds_read_b64_tr_b16 v[42:43], v10 offset:512
    s_waitcnt lgkmcnt(6)
    v_mfma_f32_32x32x16_bf16 v[144:159], v[60:63], a[60:63], v[144:159]
    ds_read_b64_tr_b16 v[44:45], v11 offset:0
    v_mfma_f32_32x32x16_bf16 v[208:223], v[60:63], a[204:207], v[208:223]
    ds_read_b64_tr_b16 v[46:47], v11 offset:512
    s_waitcnt lgkmcnt(6)
    v_mfma_f32_32x32x16_bf16 v[96:111], v[32:35], a[64:67], v[96:111]
    ds_read_b64_tr_b16 v[48:49], v8 offset:2048
    s_waitcnt vmcnt(24)
    s_barrier
    v_mfma_f32_32x32x16_bf16 v[160:175], v[32:35], a[208:211], v[160:175]
    ds_read_b64_tr_b16 v[50:51], v8 offset:2560
    s_add_u32 m0, s46, 0
    s_nop 0
    buffer_load_dwordx4 v3, s[20:23], s44 offen  lds
    s_waitcnt lgkmcnt(6)
    v_mfma_f32_32x32x16_bf16 v[112:127], v[36:39], a[64:67], v[112:127]
    ds_read_b64_tr_b16 v[52:53], v9 offset:2048
    s_add_u32 m0, s46, 1024
    s_add_u32 s44, s44, s45
    buffer_load_dwordx4 v3, s[20:23], s44 offen  lds
    v_mfma_f32_32x32x16_bf16 v[176:191], v[36:39], a[208:211], v[176:191]
    ds_read_b64_tr_b16 v[54:55], v9 offset:2560
    s_add_u32 m0, s46, 2048
    s_add_u32 s44, s44, s45
    buffer_load_dwordx4 v3, s[20:23], s44 offen  lds
    s_waitcnt lgkmcnt(6)
    v_mfma_f32_32x32x16_bf16 v[128:143], v[40:43], a[64:67], v[128:143]
    ds_read_b64_tr_b16 v[56:57], v10 offset:2048
    s_add_u32 m0, s46, 3072
    s_add_u32 s44, s44, s45
    buffer_load_dwordx4 v3, s[20:23], s44 offen  lds
    v_mfma_f32_32x32x16_bf16 v[192:207], v[40:43], a[208:211], v[192:207]
    ds_read_b64_tr_b16 v[58:59], v10 offset:2560
    s_add_u32 s44, s44, s57
    s_add_u32 s46, s46, 16384
    s_and_b32 s46, s46, 131071
    s_waitcnt lgkmcnt(6)
    v_mfma_f32_32x32x16_bf16 v[144:159], v[44:47], a[64:67], v[144:159]
    ds_read_b64_tr_b16 v[60:61], v11 offset:2048
    s_add_u32 s56, s56, 16384
    s_and_b32 s56, s56, 131071
    v_mfma_f32_32x32x16_bf16 v[208:223], v[44:47], a[208:211], v[208:223]
    ds_read_b64_tr_b16 v[62:63], v11 offset:2560
    s_waitcnt lgkmcnt(6)
    v_mfma_f32_32x32x16_bf16 v[96:111], v[48:51], a[68:71], v[96:111]
    ds_read_b64_tr_b16 v[32:33], v8 offset:4096
    v_mfma_f32_32x32x16_bf16 v[160:175], v[48:51], a[212:215], v[160:175]
    ds_read_b64_tr_b16 v[34:35], v8 offset:4608
    s_waitcnt lgkmcnt(6)
    v_mfma_f32_32x32x16_bf16 v[112:127], v[52:55], a[68:71], v[112:127]
    ds_read_b64_tr_b16 v[36:37], v9 offset:4096
    v_mfma_f32_32x32x16_bf16 v[176:191], v[52:55], a[212:215], v[176:191]
    ds_read_b64_tr_b16 v[38:39], v9 offset:4608
    s_waitcnt lgkmcnt(6)
    v_mfma_f32_32x32x16_bf16 v[128:143], v[56:59], a[68:71], v[128:143]
    ds_read_b64_tr_b16 v[40:41], v10 offset:4096
    v_mfma_f32_32x32x16_bf16 v[192:207], v[56:59], a[212:215], v[192:207]
    ds_read_b64_tr_b16 v[42:43], v10 offset:4608
    s_waitcnt lgkmcnt(6)
    v_mfma_f32_32x32x16_bf16 v[144:159], v[60:63], a[68:71], v[144:159]
    ds_read_b64_tr_b16 v[44:45], v11 offset:4096
    v_mfma_f32_32x32x16_bf16 v[208:223], v[60:63], a[212:215], v[208:223]
    ds_read_b64_tr_b16 v[46:47], v11 offset:4608
    s_waitcnt lgkmcnt(6)
    v_mfma_f32_32x32x16_bf16 v[96:111], v[32:35], a[72:75], v[96:111]
    ds_read_b64_tr_b16 v[48:49], v8 offset:6144
    v_mfma_f32_32x32x16_bf16 v[160:175], v[32:35], a[216:219], v[160:175]
    ds_read_b64_tr_b16 v[50:51], v8 offset:6656
    s_waitcnt lgkmcnt(6)
    v_add_u32 v8, s56, v4
    v_mfma_f32_32x32x16_bf16 v[112:127], v[36:39], a[72:75], v[112:127]
    ds_read_b64_tr_b16 v[52:53], v9 offset:6144
    v_mfma_f32_32x32x16_bf16 v[176:191], v[36:39], a[216:219], v[176:191]
    ds_read_b64_tr_b16 v[54:55], v9 offset:6656
    s_waitcnt lgkmcnt(6)
    v_add_u32 v9, s56, v5
    v_mfma_f32_32x32x16_bf16 v[128:143], v[40:43], a[72:75], v[128:143]
    ds_read_b64_tr_b16 v[56:57], v10 offset:6144
    v_mfma_f32_32x32x16_bf16 v[192:207], v[40:43], a[216:219], v[192:207]
    ds_read_b64_tr_b16 v[58:59], v10 offset:6656
    s_waitcnt lgkmcnt(6)
    v_add_u32 v10, s56, v6
    v_mfma_f32_32x32x16_bf16 v[144:159], v[44:47], a[72:75], v[144:159]
    ds_read_b64_tr_b16 v[60:61], v11 offset:6144
    v_mfma_f32_32x32x16_bf16 v[208:223], v[44:47], a[216:219], v[208:223]
    ds_read_b64_tr_b16 v[62:63], v11 offset:6656
    s_waitcnt lgkmcnt(6)
    v_add_u32 v11, s56, v7
    v_mfma_f32_32x32x16_bf16 v[96:111], v[48:51], a[76:79], v[96:111]
    ds_read_b64_tr_b16 v[32:33], v8 offset:0
    v_mfma_f32_32x32x16_bf16 v[160:175], v[48:51], a[220:223], v[160:175]
    ds_read_b64_tr_b16 v[34:35], v8 offset:512
    s_waitcnt lgkmcnt(6)
    v_mfma_f32_32x32x16_bf16 v[112:127], v[52:55], a[76:79], v[112:127]
    ds_read_b64_tr_b16 v[36:37], v9 offset:0
    v_mfma_f32_32x32x16_bf16 v[176:191], v[52:55], a[220:223], v[176:191]
    ds_read_b64_tr_b16 v[38:39], v9 offset:512
    s_waitcnt lgkmcnt(6)
    v_mfma_f32_32x32x16_bf16 v[128:143], v[56:59], a[76:79], v[128:143]
    ds_read_b64_tr_b16 v[40:41], v10 offset:0
    v_mfma_f32_32x32x16_bf16 v[192:207], v[56:59], a[220:223], v[192:207]
    ds_read_b64_tr_b16 v[42:43], v10 offset:512
    s_waitcnt lgkmcnt(6)
    v_mfma_f32_32x32x16_bf16 v[144:159], v[60:63], a[76:79], v[144:159]
    ds_read_b64_tr_b16 v[44:45], v11 offset:0
    v_mfma_f32_32x32x16_bf16 v[208:223], v[60:63], a[220:223], v[208:223]
    ds_read_b64_tr_b16 v[46:47], v11 offset:512
    s_waitcnt lgkmcnt(6)
    v_mfma_f32_32x32x16_bf16 v[96:111], v[32:35], a[80:83], v[96:111]
    ds_read_b64_tr_b16 v[48:49], v8 offset:2048
    s_waitcnt vmcnt(16)
    s_barrier
    v_mfma_f32_32x32x16_bf16 v[160:175], v[32:35], a[224:227], v[160:175]
    ds_read_b64_tr_b16 v[50:51], v8 offset:2560
    s_add_u32 m0, s46, 0
    s_nop 0
    buffer_load_dwordx4 v3, s[20:23], s44 offen  lds
    s_waitcnt lgkmcnt(6)
    v_mfma_f32_32x32x16_bf16 v[112:127], v[36:39], a[80:83], v[112:127]
    ds_read_b64_tr_b16 v[52:53], v9 offset:2048
    s_add_u32 m0, s46, 1024
    s_add_u32 s44, s44, s45
    buffer_load_dwordx4 v3, s[20:23], s44 offen  lds
    v_mfma_f32_32x32x16_bf16 v[176:191], v[36:39], a[224:227], v[176:191]
    ds_read_b64_tr_b16 v[54:55], v9 offset:2560
    s_add_u32 m0, s46, 2048
    s_add_u32 s44, s44, s45
    buffer_load_dwordx4 v3, s[20:23], s44 offen  lds
    s_waitcnt lgkmcnt(6)
    v_mfma_f32_32x32x16_bf16 v[128:143], v[40:43], a[80:83], v[128:143]
    ds_read_b64_tr_b16 v[56:57], v10 offset:2048
    s_add_u32 m0, s46, 3072
    s_add_u32 s44, s44, s45
    buffer_load_dwordx4 v3, s[20:23], s44 offen  lds
    v_mfma_f32_32x32x16_bf16 v[192:207], v[40:43], a[224:227], v[192:207]
    ds_read_b64_tr_b16 v[58:59], v10 offset:2560
    s_add_u32 s44, s44, s57
    s_add_u32 s46, s46, 16384
    s_and_b32 s46, s46, 131071
    s_waitcnt lgkmcnt(6)
    v_mfma_f32_32x32x16_bf16 v[144:159], v[44:47], a[80:83], v[144:159]
    ds_read_b64_tr_b16 v[60:61], v11 offset:2048
    s_add_u32 s56, s56, 16384
    s_and_b32 s56, s56, 131071
    v_mfma_f32_32x32x16_bf16 v[208:223], v[44:47], a[224:227], v[208:223]
    ds_read_b64_tr_b16 v[62:63], v11 offset:2560
    s_waitcnt lgkmcnt(6)
    v_mfma_f32_32x32x16_bf16 v[96:111], v[48:51], a[84:87], v[96:111]
    ds_read_b64_tr_b16 v[32:33], v8 offset:4096
    s_cmp_eq_u32 s13, 0
    s_cbranch_scc0 Lsig_15
    s_mov_b64 exec, 1
    v_mov_b32 v25, 1
    buffer_store_dword v25, off, s[4:7], s58 sc1
    s_mov_b64 exec, -1
Lsig_15:
    s_mov_b32 s58, 0xf0000000
    v_mfma_f32_32x32x16_bf16 v[160:175], v[48:51], a[228:231], v[160:175]
    ds_read_b64_tr_b16 v[34:35], v8 offset:4608
    s_waitcnt lgkmcnt(6)
    v_mfma_f32_32x32x16_bf16 v[112:127], v[52:55], a[84:87], v[112:127]
    ds_read_b64_tr_b16 v[36:37], v9 offset:4096
    v_mfma_f32_32x32x16_bf16 v[176:191], v[52:55], a[228:231], v[176:191]
    ds_read_b64_tr_b16 v[38:39], v9 offset:4608
    s_waitcnt lgkmcnt(6)
    v_mfma_f32_32x32x16_bf16 v[128:143], v[56:59], a[84:87], v[128:143]
    ds_read_b64_tr_b16 v[40:41], v10 offset:4096
    v_mfma_f32_32x32x16_bf16 v[192:207], v[56:59], a[228:231], v[192:207]
    ds_read_b64_tr_b16 v[42:43], v10 offset:4608
    s_waitcnt lgkmcnt(6)
    v_mfma_f32_32x32x16_bf16 v[144:159], v[60:63], a[84:87], v[144:159]
    ds_read_b64_tr_b16 v[44:45], v11 offset:4096
    v_mfma_f32_32x32x16_bf16 v[208:223], v[60:63], a[228:231], v[208:223]
    ds_read_b64_tr_b16 v[46:47], v11 offset:4608
    s_waitcnt lgkmcnt(6)
    v_mfma_f32_32x32x16_bf16 v[96:111], v[32:35], a[88:91], v[96:111]
    ds_read_b64_tr_b16 v[48:49], v8 offset:6144
    v_mfma_f32_32x32x16_bf16 v[160:175], v[32:35], a[232:235], v[160:175]
    ds_read_b64_tr_b16 v[50:51], v8 offset:6656
    s_waitcnt lgkmcnt(6)
    v_add_u32 v8, s56, v4
    v_mfma_f32_32x32x16_bf16 v[112:127], v[36:39], a[88:91], v[112:127]
    ds_read_b64_tr_b16 v[52:53], v9 offset:6144
    v_mfma_f32_32x32x16_bf16 v[176:191], v[36:39], a[232:235], v[176:191]
    ds_read_b64_tr_b16 v[54:55], v9 offset:6656
    s_waitcnt lgkmcnt(6)
    v_add_u32 v9, s56, v5
    v_mfma_f32_32x32x16_bf16 v[128:143], v[40:43], a[88:91], v[128:143]
    ds_read_b64_tr_b16 v[56:57], v10 offset:6144
    v_mfma_f32_32x32x16_bf16 v[192:207], v[40:43], a[232:235], v[192:207]
    ds_read_b64_tr_b16 v[58:59], v10 offset:6656
    s_waitcnt lgkmcnt(6)
    v_add_u32 v10, s56, v6
    v_mfma_f32_32x32x16_bf16 v[144:159], v[44:47], a[88:91], v[144:159]
    ds_read_b64_tr_b16 v[60:61], v11 offset:6144
    v_mfma_f32_32x32x16_bf16 v[208:223], v[44:47], a[232:235], v[208:223]
    ds_read_b64_tr_b16 v[62:63], v11 offset:6656
    s_waitcnt lgkmcnt(6)
    v_add_u32 v11, s56, v7
    v_mfma_f32_32x32x16_bf16 v[96:111], v[48:51], a[92:95], v[96:111]
    ds_read_b64_tr_b16 v[32:33], v8 offset:0
    v_mfma_f32_32x32x16_bf16 v[160:175], v[48:51], a[236:239], v[160:175]
    ds_read_b64_tr_b16 v[34:35], v8 offset:512
    s_waitcnt lgkmcnt(6)
    v_mfma_f32_32x32x16_bf16 v[112:127], v[52:55], a[92:95], v[112:127]
    ds_read_b64_tr_b16 v[36:37], v9 offset:0
    v_mfma_f32_32x32x16_bf16 v[176:191], v[52:55], a[236:239], v[176:191]
    ds_read_b64_tr_b16 v[38:39], v9 offset:512
    s_waitcnt lgkmcnt(6)
    v_mfma_f32_32x32x16_bf16 v[128:143], v[56:59], a[92:95], v[128:143]
    ds_read_b64_tr_b16 v[40:41], v10 offset:0
    v_mfma_f32_32x32x16_bf16 v[192:207], v[56:59], a[236:239], v[192:207]
    ds_read_b64_tr_b16 v[42:43], v10 offset:512
    s_waitcnt lgkmcnt(6)
    v_mfma_f32_32x32x16_bf16 v[144:159], v[60:63], a[92:95], v[144:159]
    ds_read_b64_tr_b16 v[44:45], v11 offset:0
    v_mfma_f32_32x32x16_bf16 v[208:223], v[60:63], a[236:239], v[208:223]
    ds_read_b64_tr_b16 v[46:47], v11 offset:512
    s_waitcnt lgkmcnt(6)
    v_mfma_f32_32x32x16_bf16 v[96:111], v[32:35], a[96:99], v[96:111]
    ds_read_b64_tr_b16 v[48:49], v8 offset:2048
    s_waitcnt vmcnt(16)
    s_barrier
    v_mfma_f32_32x32x16_bf16 v[160:175], v[32:35], a[240:243], v[160:175]
    ds_read_b64_tr_b16 v[50:51], v8 offset:2560
    s_add_u32 m0, s46, 0
    s_nop 0
    buffer_load_dwordx4 v3, s[20:23], s44 offen  lds
    s_waitcnt lgkmcnt(6)
    v_mfma_f32_32x32x16_bf16 v[112:127], v[36:39], a[96:99], v[112:127]
    ds_read_b64_tr_b16 v[52:53], v9 offset:2048
    s_add_u32 m0, s46, 1024
    s_add_u32 s44, s44, s45
    buffer_load_dwordx4 v3, s[20:23], s44 offen  lds
    v_mfma_f32_32x32x16_bf16 v[176:191], v[36:39], a[240:243], v[176:191]
    ds_read_b64_tr_b16 v[54:55], v9 offset:2560
    s_add_u32 m0, s46, 2048
    s_add_u32 s44, s44, s45
    buffer_load_dwordx4 v3, s[20:23], s44 offen  lds
    s_waitcnt lgkmcnt(6)
    v_mfma_f32_32x32x16_bf16 v[128:143], v[40:43], a[96:99], v[128:143]
    ds_read_b64_tr_b16 v[56:57], v10 offset:2048
    s_add_u32 m0, s46, 3072
    s_add_u32 s44, s44, s45
    buffer_load_dwordx4 v3, s[20:23], s44 offen  lds
    v_mfma_f32_32x32x16_bf16 v[192:207], v[40:43], a[240:243], v[192:207]
    ds_read_b64_tr_b16 v[58:59], v10 offset:2560
    s_add_u32 s44, s44, s57
    s_add_u32 s46, s46, 16384
    s_and_b32 s46, s46, 131071
    s_waitcnt lgkmcnt(6)
    v_mfma_f32_32x32x16_bf16 v[144:159], v[44:47], a[96:99], v[144:159]
    ds_read_b64_tr_b16 v[60:61], v11 offset:2048
    s_add_u32 s56, s56, 16384
    s_and_b32 s56, s56, 131071
    v_mfma_f32_32x32x16_bf16 v[208:223], v[44:47], a[240:243], v[208:223]
    ds_read_b64_tr_b16 v[62:63], v11 offset:2560
    s_waitcnt lgkmcnt(6)
    v_mfma_f32_32x32x16_bf16 v[96:111], v[48:51], a[100:103], v[96:111]
    ds_read_b64_tr_b16 v[32:33], v8 offset:4096
    v_mfma_f32_32x32x16_bf16 v[160:175], v[48:51], a[244:247], v[160:175]
    ds_read_b64_tr_b16 v[34:35], v8 offset:4608
    s_waitcnt lgkmcnt(6)
    v_mfma_f32_32x32x16_bf16 v[112:127], v[52:55], a[100:103], v[112:127]
    ds_read_b64_tr_b16 v[36:37], v9 offset:4096
    v_mfma_f32_32x32x16_bf16 v[176:191], v[52:55], a[244:247], v[176:191]
    ds_read_b64_tr_b16 v[38:39], v9 offset:4608
    s_waitcnt lgkmcnt(6)
    v_mfma_f32_32x32x16_bf16 v[128:143], v[56:59], a[100:103], v[128:143]
    ds_read_b64_tr_b16 v[40:41], v10 offset:4096
    v_mfma_f32_32x32x16_bf16 v[192:207], v[56:59], a[244:247], v[192:207]
    ds_read_b64_tr_b16 v[42:43], v10 offset:4608
    s_waitcnt lgkmcnt(6)
    v_mfma_f32_32x32x16_bf16 v[144:159], v[60:63], a[100:103], v[144:159]
    ds_read_b64_tr_b16 v[44:45], v11 offset:4096
    v_mfma_f32_32x32x16_bf16 v[208:223], v[60:63], a[244:247], v[208:223]
    ds_read_b64_tr_b16 v[46:47], v11 offset:4608
    s_waitcnt lgkmcnt(6)
    v_mfma_f32_32x32x16_bf16 v[96:111], v[32:35], a[104:107], v[96:111]
    ds_read_b64_tr_b16 v[48:49], v8 offset:6144
    v_mfma_f32_32x32x16_bf16 v[160:175], v[32:35], a[248:251], v[160:175]
    ds_read_b64_tr_b16 v[50:51], v8 offset:6656
    s_waitcnt lgkmcnt(6)
    v_add_u32 v8, s56, v4
    v_mfma_f32_32x32x16_bf16 v[112:127], v[36:39], a[104:107], v[112:127]
    ds_read_b64_tr_b16 v[52:53], v9 offset:6144
    v_mfma_f32_32x32x16_bf16 v[176:191], v[36:39], a[248:251], v[176:191]
    ds_read_b64_tr_b16 v[54:55], v9 offset:6656
    s_waitcnt lgkmcnt(6)
    v_add_u32 v9, s56, v5
    v_mfma_f32_32x32x16_bf16 v[128:143], v[40:43], a[104:107], v[128:143]
    ds_read_b64_tr_b16 v[56:57], v10 offset:6144
    v_mfma_f32_32x32x16_bf16 v[192:207], v[40:43], a[248:251], v[192:207]
    ds_read_b64_tr_b16 v[58:59], v10 offset:6656
    s_waitcnt lgkmcnt(6)
    v_add_u32 v10, s56, v6
    v_mfma_f32_32x32x16_bf16 v[144:159], v[44:47], a[104:107], v[144:159]
    ds_read_b64_tr_b16 v[60:61], v11 offset:6144
    v_mfma_f32_32x32x16_bf16 v[208:223], v[44:47], a[248:251], v[208:223]
    ds_read_b64_tr_b16 v[62:63], v11 offset:6656
    s_waitcnt lgkmcnt(6)
    v_add_u32 v11, s56, v7
    v_mfma_f32_32x32x16_bf16 v[96:111], v[48:51], a[108:111], v[96:111]
    ds_read_b64_tr_b16 v[32:33], v8 offset:0
    v_mfma_f32_32x32x16_bf16 v[160:175], v[48:51], a[252:255], v[160:175]
    ds_read_b64_tr_b16 v[34:35], v8 offset:512
    s_waitcnt lgkmcnt(6)
    v_mfma_f32_32x32x16_bf16 v[112:127], v[52:55], a[108:111], v[112:127]
    ds_read_b64_tr_b16 v[36:37], v9 offset:0
    v_mfma_f32_32x32x16_bf16 v[176:191], v[52:55], a[252:255], v[176:191]
    ds_read_b64_tr_b16 v[38:39], v9 offset:512
    s_waitcnt lgkmcnt(6)
    v_mfma_f32_32x32x16_bf16 v[128:143], v[56:59], a[108:111], v[128:143]
    ds_read_b64_tr_b16 v[40:41], v10 offset:0
    v_mfma_f32_32x32x16_bf16 v[192:207], v[56:59], a[252:255], v[192:207]
    ds_read_b64_tr_b16 v[42:43], v10 offset:512
    s_waitcnt lgkmcnt(6)
    v_mfma_f32_32x32x16_bf16 v[144:159], v[60:63], a[108:111], v[144:159]
    ds_read_b64_tr_b16 v[44:45], v11 offset:0
    v_mfma_f32_32x32x16_bf16 v[208:223], v[60:63], a[252:255], v[208:223]
    ds_read_b64_tr_b16 v[46:47], v11 offset:512
    s_waitcnt lgkmcnt(6)
    v_mfma_f32_32x32x16_bf16 v[96:111], v[32:35], a[112:115], v[96:111]
    ds_read_b64_tr_b16 v[48:49], v8 offset:2048
    s_waitcnt vmcnt(16)
    s_barrier
    v_mfma_f32_32x32x16_bf16 v[160:175], v[32:35], v[64:67], v[160:175]
    ds_read_b64_tr_b16 v[50:51], v8 offset:2560
    s_add_u32 m0, s46, 0
    s_nop 0
    buffer_load_dwordx4 v3, s[20:23], s44 offen  lds
    s_waitcnt lgkmcnt(6)
    v_mfma_f32_32x32x16_bf16 v[112:127], v[36:39], a[112:115], v[112:127]
    ds_read_b64_tr_b16 v[52:53], v9 offset:2048
    s_add_u32 m0, s46, 1024
    s_add_u32 s44, s44, s45
    buffer_load_dwordx4 v3, s[20:23], s44 offen  lds
    v_mfma_f32_32x32x16_bf16 v[176:191], v[36:39], v[64:67], v[176:191]
    ds_read_b64_tr_b16 v[54:55], v9 offset:2560
    s_add_u32 m0, s46, 2048
    s_add_u32 s44, s44, s45
    buffer_load_dwordx4 v3, s[20:23], s44 offen  lds
    s_waitcnt lgkmcnt(6)
    v_mfma_f32_32x32x16_bf16 v[128:143], v[40:43], a[112:115], v[128:143]
    ds_read_b64_tr_b16 v[56:57], v10 offset:2048
    s_add_u32 m0, s46, 3072
    s_add_u32 s44, s44, s45
    buffer_load_dwordx4 v3, s[20:23], s44 offen  lds
    v_mfma_f32_32x32x16_bf16 v[192:207], v[40:43], v[64:67], v[192:207]
    ds_read_b64_tr_b16 v[58:59], v10 offset:2560
    s_add_u32 s44, s44, s57
    s_add_u32 s46, s46, 16384
    s_and_b32 s46, s46, 131071
    s_waitcnt lgkmcnt(6)
    v_mfma_f32_32x32x16_bf16 v[144:159], v[44:47], a[112:115], v[144:159]
    ds_read_b64_tr_b16 v[60:61], v11 offset:2048
    s_add_u32 s56, s56, 16384
    s_and_b32 s56, s56, 131071
    v_mfma_f32_32x32x16_bf16 v[208:223], v[44:47], v[64:67], v[208:223]
    ds_read_b64_tr_b16 v[62:63], v11 offset:2560
    s_waitcnt lgkmcnt(6)
    v_mfma_f32_32x32x16_bf16 v[96:111], v[48:51], a[116:119], v[96:111]
    ds_read_b64_tr_b16 v[32:33], v8 offset:4096
    v_mfma_f32_32x32x16_bf16 v[160:175], v[48:51], v[68:71], v[160:175]
    ds_read_b64_tr_b16 v[34:35], v8 offset:4608
    s_waitcnt lgkmcnt(6)
    v_mfma_f32_32x32x16_bf16 v[112:127], v[52:55], a[116:119], v[112:127]
    ds_read_b64_tr_b16 v[36:37], v9 offset:4096
    v_mfma_f32_32x32x16_bf16 v[176:191], v[52:55], v[68:71], v[176:191]
    ds_read_b64_tr_b16 v[38:39], v9 offset:4608
    s_waitcnt lgkmcnt(6)
    v_mfma_f32_32x32x16_bf16 v[128:143], v[56:59], a[116:119], v[128:143]
    ds_read_b64_tr_b16 v[40:41], v10 offset:4096
    v_mfma_f32_32x32x16_bf16 v[192:207], v[56:59], v[68:71], v[192:207]
    ds_read_b64_tr_b16 v[42:43], v10 offset:4608
    s_waitcnt lgkmcnt(6)
    v_mfma_f32_32x32x16_bf16 v[144:159], v[60:63], a[116:119], v[144:159]
    ds_read_b64_tr_b16 v[44:45], v11 offset:4096
    v_mfma_f32_32x32x16_bf16 v[208:223], v[60:63], v[68:71], v[208:223]
    ds_read_b64_tr_b16 v[46:47], v11 offset:4608
    s_waitcnt lgkmcnt(6)
    v_mfma_f32_32x32x16_bf16 v[96:111], v[32:35], a[120:123], v[96:111]
    ds_read_b64_tr_b16 v[48:49], v8 offset:6144
    v_mfma_f32_32x32x16_bf16 v[160:175], v[32:35], v[72:75], v[160:175]
    ds_read_b64_tr_b16 v[50:51], v8 offset:6656
    s_waitcnt lgkmcnt(6)
    v_add_u32 v8, s56, v4
    v_mfma_f32_32x32x16_bf16 v[112:127], v[36:39], a[120:123], v[112:127]
    ds_read_b64_tr_b16 v[52:53], v9 offset:6144
    v_mfma_f32_32x32x16_bf16 v[176:191], v[36:39], v[72:75], v[176:191]
    ds_read_b64_tr_b16 v[54:55], v9 offset:6656
    s_waitcnt lgkmcnt(6)
    v_add_u32 v9, s56, v5
    v_mfma_f32_32x32x16_bf16 v[128:143], v[40:43], a[120:123], v[128:143]
    ds_read_b64_tr_b16 v[56:57], v10 offset:6144
    v_mfma_f32_32x32x16_bf16 v[192:207], v[40:43], v[72:75], v[192:207]
    ds_read_b64_tr_b16 v[58:59], v10 offset:6656
    s_waitcnt lgkmcnt(6)
    v_add_u32 v10, s56, v6
    v_mfma_f32_32x32x16_bf16 v[144:159], v[44:47], a[120:123], v[144:159]
    ds_read_b64_tr_b16 v[60:61], v11 offset:6144
    v_mfma_f32_32x32x16_bf16 v[208:223], v[44:47], v[72:75], v[208:223]
    ds_read_b64_tr_b16 v[62:63], v11 offset:6656
    s_waitcnt lgkmcnt(6)
    v_add_u32 v11, s56, v7
    v_mfma_f32_32x32x16_bf16 v[96:111], v[48:51], a[124:127], v[96:111]
    ds_read_b64_tr_b16 v[32:33], v8 offset:0
    v_mfma_f32_32x32x16_bf16 v[160:175], v[48:51], v[76:79], v[160:175]
    ds_read_b64_tr_b16 v[34:35], v8 offset:512
    s_waitcnt lgkmcnt(6)
    v_mfma_f32_32x32x16_bf16 v[112:127], v[52:55], a[124:127], v[112:127]
    ds_read_b64_tr_b16 v[36:37], v9 offset:0
    v_mfma_f32_32x32x16_bf16 v[176:191], v[52:55], v[76:79], v[176:191]
    ds_read_b64_tr_b16 v[38:39], v9 offset:512
    s_waitcnt lgkmcnt(6)
    v_mfma_f32_32x32x16_bf16 v[128:143], v[56:59], a[124:127], v[128:143]
    ds_read_b64_tr_b16 v[40:41], v10 offset:0
    v_mfma_f32_32x32x16_bf16 v[192:207], v[56:59], v[76:79], v[192:207]
    ds_read_b64_tr_b16 v[42:43], v10 offset:512
    s_waitcnt lgkmcnt(6)
    v_mfma_f32_32x32x16_bf16 v[144:159], v[60:63], a[124:127], v[144:159]
    ds_read_b64_tr_b16 v[44:45], v11 offset:0
    v_mfma_f32_32x32x16_bf16 v[208:223], v[60:63], v[76:79], v[208:223]
    ds_read_b64_tr_b16 v[46:47], v11 offset:512
    s_waitcnt lgkmcnt(6)
    v_mfma_f32_32x32x16_bf16 v[96:111], v[32:35], a[128:131], v[96:111]
    ds_read_b64_tr_b16 v[48:49], v8 offset:2048
    s_waitcnt vmcnt(16)
    s_barrier
    v_mfma_f32_32x32x16_bf16 v[160:175], v[32:35], v[80:83], v[160:175]
    ds_read_b64_tr_b16 v[50:51], v8 offset:2560
    s_add_u32 m0, s46, 0
    s_nop 0
    buffer_load_dwordx4 v3, s[20:23], s44 offen  lds
    s_waitcnt lgkmcnt(6)
    v_mfma_f32_32x32x16_bf16 v[112:127], v[36:39], a[128:131], v[112:127]
    ds_read_b64_tr_b16 v[52:53], v9 offset:2048
    s_add_u32 m0, s46, 1024
    s_add_u32 s44, s44, s45
    buffer_load_dwordx4 v3, s[20:23], s44 offen  lds
    v_mfma_f32_32x32x16_bf16 v[176:191], v[36:39], v[80:83], v[176:191]
    ds_read_b64_tr_b16 v[54:55], v9 offset:2560
    s_add_u32 m0, s46, 2048
    s_add_u32 s44, s44, s45
    buffer_load_dwordx4 v3, s[20:23], s44 offen  lds
    s_waitcnt lgkmcnt(6)
    v_mfma_f32_32x32x16_bf16 v[128:143], v[40:43], a[128:131], v[128:143]
    ds_read_b64_tr_b16 v[56:57], v10 offset:2048
    s_add_u32 m0, s46, 3072
    s_add_u32 s44, s44, s45
    buffer_load_dwordx4 v3, s[20:23], s44 offen  lds
    v_mfma_f32_32x32x16_bf16 v[192:207], v[40:43], v[80:83], v[192:207]
    ds_read_b64_tr_b16 v[58:59], v10 offset:2560
    s_add_u32 s44, s44, s57
    s_add_u32 s46, s46, 16384
    s_and_b32 s46, s46, 131071
    s_waitcnt lgkmcnt(6)
    v_mfma_f32_32x32x16_bf16 v[144:159], v[44:47], a[128:131], v[144:159]
    ds_read_b64_tr_b16 v[60:61], v11 offset:2048
    s_add_u32 s56, s56, 16384
    s_and_b32 s56, s56, 131071
    v_mfma_f32_32x32x16_bf16 v[208:223], v[44:47], v[80:83], v[208:223]
    ds_read_b64_tr_b16 v[62:63], v11 offset:2560
    s_waitcnt lgkmcnt(6)
    v_mfma_f32_32x32x16_bf16 v[96:111], v[48:51], a[132:135], v[96:111]
    ds_read_b64_tr_b16 v[32:33], v8 offset:4096
    v_mfma_f32_32x32x16_bf16 v[160:175], v[48:51], v[84:87], v[160:175]
    ds_read_b64_tr_b16 v[34:35], v8 offset:4608
    s_waitcnt lgkmcnt(6)
    v_mfma_f32_32x32x16_bf16 v[112:127], v[52:55], a[132:135], v[112:127]
    ds_read_b64_tr_b16 v[36:37], v9 offset:4096
    v_mfma_f32_32x32x16_bf16 v[176:191], v[52:55], v[84:87], v[176:191]
    ds_read_b64_tr_b16 v[38:39], v9 offset:4608
    s_waitcnt lgkmcnt(6)
    v_mfma_f32_32x32x16_bf16 v[128:143], v[56:59], a[132:135], v[128:143]
    ds_read_b64_tr_b16 v[40:41], v10 offset:4096
    v_mfma_f32_32x32x16_bf16 v[192:207], v[56:59], v[84:87], v[192:207]
    ds_read_b64_tr_b16 v[42:43], v10 offset:4608
    s_waitcnt lgkmcnt(6)
    v_mfma_f32_32x32x16_bf16 v[144:159], v[60:63], a[132:135], v[144:159]
    ds_read_b64_tr_b16 v[44:45], v11 offset:4096
    v_mfma_f32_32x32x16_bf16 v[208:223], v[60:63], v[84:87], v[208:223]
    ds_read_b64_tr_b16 v[46:47], v11 offset:4608
    s_waitcnt lgkmcnt(6)
    v_mfma_f32_32x32x16_bf16 v[96:111], v[32:35], a[136:139], v[96:111]
    ds_read_b64_tr_b16 v[48:49], v8 offset:6144
    v_mfma_f32_32x32x16_bf16 v[160:175], v[32:35], v[88:91], v[160:175]
    ds_read_b64_tr_b16 v[50:51], v8 offset:6656
    s_waitcnt lgkmcnt(6)
    v_mfma_f32_32x32x16_bf16 v[112:127], v[36:39], a[136:139], v[112:127]
    ds_read_b64_tr_b16 v[52:53], v9 offset:6144
    v_mfma_f32_32x32x16_bf16 v[176:191], v[36:39], v[88:91], v[176:191]
    ds_read_b64_tr_b16 v[54:55], v9 offset:6656
    s_waitcnt lgkmcnt(6)
    v_mfma_f32_32x32x16_bf16 v[128:143], v[40:43], a[136:139], v[128:143]
    ds_read_b64_tr_b16 v[56:57], v10 offset:6144
    v_mfma_f32_32x32x16_bf16 v[192:207], v[40:43], v[88:91], v[192:207]
    ds_read_b64_tr_b16 v[58:59], v10 offset:6656
    s_waitcnt lgkmcnt(6)
    v_mfma_f32_32x32x16_bf16 v[144:159], v[44:47], a[136:139], v[144:159]
    ds_read_b64_tr_b16 v[60:61], v11 offset:6144
    v_mfma_f32_32x32x16_bf16 v[208:223], v[44:47], v[88:91], v[208:223]
    ds_read_b64_tr_b16 v[62:63], v11 offset:6656
    s_waitcnt lgkmcnt(6)
    v_mfma_f32_32x32x16_bf16 v[96:111], v[48:51], a[140:143], v[96:111]
    v_mfma_f32_32x32x16_bf16 v[160:175], v[48:51], v[92:95], v[160:175]
    s_waitcnt lgkmcnt(4)
    v_mfma_f32_32x32x16_bf16 v[112:127], v[52:55], a[140:143], v[112:127]
    v_mfma_f32_32x32x16_bf16 v[176:191], v[52:55], v[92:95], v[176:191]
    s_waitcnt lgkmcnt(2)
    v_mfma_f32_32x32x16_bf16 v[128:143], v[56:59], a[140:143], v[128:143]
    v_mfma_f32_32x32x16_bf16 v[192:207], v[56:59], v[92:95], v[192:207]
    s_waitcnt lgkmcnt(0)
    v_mfma_f32_32x32x16_bf16 v[144:159], v[60:63], a[140:143], v[144:159]
    v_mfma_f32_32x32x16_bf16 v[208:223], v[60:63], v[92:95], v[208:223]
    s_lshl_b32 s38, s12, 2
    s_add_u32 s38, s38, s13
    s_mul_i32 s38, s38, 589824
    s_sub_u32 s39, s49, 96
    s_lshl_b32 s39, s39, 12
    s_add_u32 s38, s38, s39
    s_add_u32 s64, s38, 50331648
    v_mul_f32 v96, v96, v128
    v_mul_f32 v97, v97, v129
    v_mul_f32 v98, v98, v130
    v_mul_f32 v99, v99, v131
    v_mul_f32 v100, v100, v132
    v_mul_f32 v101, v101, v133
    v_mul_f32 v102, v102, v134
    v_mul_f32 v103, v103, v135
    v_mul_f32 v104, v104, v136
    v_mul_f32 v105, v105, v137
    v_mul_f32 v106, v106, v138
    v_mul_f32 v107, v107, v139
    v_mul_f32 v108, v108, v140
    v_mul_f32 v109, v109, v141
    v_mul_f32 v110, v110, v142
    v_mul_f32 v111, v111, v143
    v_mul_f32 v96, v96, v16
    v_mul_f32 v97, v97, v16
    v_mul_f32 v98, v98, v16
    v_mul_f32 v99, v99, v16
    v_mul_f32 v100, v100, v16
    v_mul_f32 v101, v101, v16
    v_mul_f32 v102, v102, v16
    v_mul_f32 v103, v103, v16
    v_mul_f32 v104, v104, v16
    v_mul_f32 v105, v105, v16
    v_mul_f32 v106, v106, v16
    v_mul_f32 v107, v107, v16
    v_mul_f32 v108, v108, v16
    v_mul_f32 v109, v109, v16
    v_mul_f32 v110, v110, v16
    v_mul_f32 v111, v111, v16
    v_cvt_pk_bf16_f32 v224, v96, v104
    v_cvt_pk_bf16_f32 v225, v97, v105
    v_cvt_pk_bf16_f32 v226, v98, v106
    v_cvt_pk_bf16_f32 v227, v99, v107
    buffer_store_dwordx4 v[224:227], v14, s[4:7], s64 offen offset:0 sc1
    v_cvt_pk_bf16_f32 v228, v100, v108
    v_cvt_pk_bf16_f32 v229, v101, v109
    v_cvt_pk_bf16_f32 v230, v102, v110
    v_cvt_pk_bf16_f32 v231, v103, v111
    buffer_store_dwordx4 v[228:231], v14, s[4:7], s64 offen offset:1024 sc1
    v_mul_f32 v112, v112, v144
    v_mul_f32 v113, v113, v145
    v_mul_f32 v114, v114, v146
    v_mul_f32 v115, v115, v147
    v_mul_f32 v116, v116, v148
    v_mul_f32 v117, v117, v149
    v_mul_f32 v118, v118, v150
    v_mul_f32 v119, v119, v151
    v_mul_f32 v120, v120, v152
    v_mul_f32 v121, v121, v153
    v_mul_f32 v122, v122, v154
    v_mul_f32 v123, v123, v155
    v_mul_f32 v124, v124, v156
    v_mul_f32 v125, v125, v157
    v_mul_f32 v126, v126, v158
    v_mul_f32 v127, v127, v159
    v_mul_f32 v112, v112, v16
    v_mul_f32 v113, v113, v16
    v_mul_f32 v114, v114, v16
    v_mul_f32 v115, v115, v16
    v_mul_f32 v116, v116, v16
    v_mul_f32 v117, v117, v16
    v_mul_f32 v118, v118, v16
    v_mul_f32 v119, v119, v16
    v_mul_f32 v120, v120, v16
    v_mul_f32 v121, v121, v16
    v_mul_f32 v122, v122, v16
    v_mul_f32 v123, v123, v16
    v_mul_f32 v124, v124, v16
    v_mul_f32 v125, v125, v16
    v_mul_f32 v126, v126, v16
    v_mul_f32 v127, v127, v16
    v_cvt_pk_bf16_f32 v232, v112, v120
    v_cvt_pk_bf16_f32 v233, v113, v121
    v_cvt_pk_bf16_f32 v234, v114, v122
    v_cvt_pk_bf16_f32 v235, v115, v123
    buffer_store_dwordx4 v[232:235], v14, s[4:7], s64 offen offset:2048 sc1
    v_cvt_pk_bf16_f32 v236, v116, v124
    v_cvt_pk_bf16_f32 v237, v117, v125
    v_cvt_pk_bf16_f32 v238, v118, v126
    v_cvt_pk_bf16_f32 v239, v119, v127
    buffer_store_dwordx4 v[236:239], v14, s[4:7], s64 offen offset:3072 sc1
    s_add_u32 s64, s64, 294912
    s_add_u32 s65, s65, 294912
    v_mul_f32 v160, v160, v192
    v_mul_f32 v161, v161, v193
    v_mul_f32 v162, v162, v194
    v_mul_f32 v163, v163, v195
    v_mul_f32 v164, v164, v196
    v_mul_f32 v165, v165, v197
    v_mul_f32 v166, v166, v198
    v_mul_f32 v167, v167, v199
    v_mul_f32 v168, v168, v200
    v_mul_f32 v169, v169, v201
    v_mul_f32 v170, v170, v202
    v_mul_f32 v171, v171, v203
    v_mul_f32 v172, v172, v204
    v_mul_f32 v173, v173, v205
    v_mul_f32 v174, v174, v206
    v_mul_f32 v175, v175, v207
    v_mul_f32 v160, v160, v17
    v_mul_f32 v161, v161, v17
    v_mul_f32 v162, v162, v17
    v_mul_f32 v163, v163, v17
    v_mul_f32 v164, v164, v17
    v_mul_f32 v165, v165, v17
    v_mul_f32 v166, v166, v17
    v_mul_f32 v167, v167, v17
    v_mul_f32 v168, v168, v17
    v_mul_f32 v169, v169, v17
    v_mul_f32 v170, v170, v17
    v_mul_f32 v171, v171, v17
    v_mul_f32 v172, v172, v17
    v_mul_f32 v173, v173, v17
    v_mul_f32 v174, v174, v17
    v_mul_f32 v175, v175, v17
    v_cvt_pk_bf16_f32 v240, v160, v168
    v_cvt_pk_bf16_f32 v241, v161, v169
    v_cvt_pk_bf16_f32 v242, v162, v170
    v_cvt_pk_bf16_f32 v243, v163, v171
    buffer_store_dwordx4 v[240:243], v14, s[4:7], s64 offen offset:0 sc1
    v_cvt_pk_bf16_f32 v244, v164, v172
    v_cvt_pk_bf16_f32 v245, v165, v173
    v_cvt_pk_bf16_f32 v246, v166, v174
    v_cvt_pk_bf16_f32 v247, v167, v175
    buffer_store_dwordx4 v[244:247], v14, s[4:7], s64 offen offset:1024 sc1
    v_mul_f32 v176, v176, v208
    v_mul_f32 v177, v177, v209
    v_mul_f32 v178, v178, v210
    v_mul_f32 v179, v179, v211
    v_mul_f32 v180, v180, v212
    v_mul_f32 v181, v181, v213
    v_mul_f32 v182, v182, v214
    v_mul_f32 v183, v183, v215
    v_mul_f32 v184, v184, v216
    v_mul_f32 v185, v185, v217
    v_mul_f32 v186, v186, v218
    v_mul_f32 v187, v187, v219
    v_mul_f32 v188, v188, v220
    v_mul_f32 v189, v189, v221
    v_mul_f32 v190, v190, v222
    v_mul_f32 v191, v191, v223
    v_mul_f32 v176, v176, v17
    v_mul_f32 v177, v177, v17
    v_mul_f32 v178, v178, v17
    v_mul_f32 v179, v179, v17
    v_mul_f32 v180, v180, v17
    v_mul_f32 v181, v181, v17
    v_mul_f32 v182, v182, v17
    v_mul_f32 v183, v183, v17
    v_mul_f32 v184, v184, v17
    v_mul_f32 v185, v185, v17
    v_mul_f32 v186, v186, v17
    v_mul_f32 v187, v187, v17
    v_mul_f32 v188, v188, v17
    v_mul_f32 v189, v189, v17
    v_mul_f32 v190, v190, v17
    v_mul_f32 v191, v191, v17
    v_cvt_pk_bf16_f32 v248, v176, v184
    v_cvt_pk_bf16_f32 v249, v177, v185
    v_cvt_pk_bf16_f32 v250, v178, v186
    v_cvt_pk_bf16_f32 v251, v179, v187
    buffer_store_dwordx4 v[248:251], v14, s[4:7], s64 offen offset:2048 sc1
    v_cvt_pk_bf16_f32 v252, v180, v188
    v_cvt_pk_bf16_f32 v253, v181, v189
    v_cvt_pk_bf16_f32 v254, v182, v190
    v_cvt_pk_bf16_f32 v255, v183, v191
    buffer_store_dwordx4 v[252:255], v14, s[4:7], s64 offen offset:3072 sc1
L_g1_next:
    s_cmp_eq_u32 s101, 0
    s_cbranch_scc0 Lcl_16
    s_mov_b32 s38, 8
    s_cmp_eq_u32 s13, 0
    s_cbranch_scc0 Lw_17_ok
    s_mov_b32 s97, 0
Lw_17:
    buffer_load_dword v25, off, s[8:11], s38 sc1
    s_add_u32 s97, s97, 1
    s_cmp_gt_u32 s97, 0x20000
    s_cbranch_scc1 L_fail
    s_waitcnt vmcnt(0)
    v_and_b32 v25, 0xff, v25
    v_cmp_ne_u32 vcc, 0x20, v25
    s_cbranch_vccz Lw_17_ok
    s_sleep 16
    s_branch Lw_17
Lw_17_ok:
    s_barrier
    s_mov_b32 s101, 1
Lcl_16:
    s_mul_i32 s58, s12, 192
    s_add_u32 s58, s58, s49
    s_lshl_b32 s58, s58, 6
    s_add_u32 s58, s58, 117785600
    s_sub_u32 s38, s49, s14
    s_cmp_eq_u32 s38, 48
    s_cbranch_scc1 L_g1_now
    s_cmp_eq_u32 s59, 1
    s_cbranch_scc1 L_g1_now
    s_lshl_b32 s38, s12, 2
    s_add_u32 s38, s38, s47
    s_cmp_eq_u32 s38, 0
    s_cbranch_scc1 L_g1_now
    s_cmp_eq_u32 s38, 5
    s_cbranch_scc1 L_g1_now
    s_cmp_eq_u32 s47, 6
    s_cbranch_scc0 L_g1_later
L_g1_now:
    s_waitcnt vmcnt(0)
    s_barrier
    s_cmp_eq_u32 s13, 0
    s_cbranch_scc0 Lsig_18
    s_mov_b64 exec, 1
    v_mov_b32 v25, 1
    buffer_store_dword v25, off, s[4:7], s58 sc1
    s_mov_b64 exec, -1
Lsig_18:
    s_mov_b32 s58, 0xf0000000
L_g1_later:
    s_cmp_eq_u32 s47, s62
    s_cselect_b32 s38, s61, 0
    s_add_u32 s47, s47, s38
    s_add_u32 s47, s47, 1
    s_cmp_lt_u32 s47, s59
    s_cbranch_scc1 L_g1_blk
    s_cmp_eq_u32 s59, 1
    s_cbranch_scc0 L_g1_done
    s_cmp_ge_u32 s100, 192
    s_cbranch_scc1 L_fail
    s_and_b32 s12, s100, 7
    s_mov_b32 s59, 7
    s_mov_b32 s60, 0
    s_branch L_g1_pass
L_g1_done:
    s_barrier
    s_and_b32 s12, s100, 31
    s_lshr_b32 s14, s100, 5
    s_mov_b32 s93, -1
    s_mul_i32 s33, s14, 14
    s_mul_i32 s14, s14, 6
    s_add_u32 s92, s14, 6
    s_cmp_lt_u32 s12, 18
    s_cbranch_scc1 L_down
    s_mov_b32 s93, s33
    s_add_u32 s93, s93, s12
    s_sub_u32 s93, s93, 18
    s_cmp_lt_u32 s93, 72
    s_cbranch_scc0 L_att
    s_mul_i32 s14, s93, 3641
    s_lshr_b32 s14, s14, 16
    s_mul_i32 s12, s14, 18
    s_sub_u32 s12, s93, s12
    s_mul_i32 s14, s14, 7
    s_add_u32 s14, s14, 36
    s_add_u32 s92, s14, 7
    s_min_u32 s92, s92, 64
L_down:
    s_mov_b32 s91, -1
    s_load_dwordx2 s[16:17], s[0:1], 80
    s_load_dwordx2 s[20:21], s[0:1], 96
    v_and_b32 v8, 63, v0
    v_lshlrev_b32 v1, 4, v8
    v_lshrrev_b32 v9, 2, v8
    v_mul_u32_u24 v9, 1152, v9
    v_and_b32 v10, 3, v8
    v_lshl_add_u32 v2, v10, 4, v9
    s_lshl_b32 s28, s13, 15
    v_bfe_u32 v11, v8, 2, 2
    v_and_b32 v9, 1, v11
    v_lshlrev_b32 v9, 4, v9
    v_lshrrev_b32 v10, 5, v8
    v_lshl_add_u32 v9, v10, 2, v9
    v_lshrrev_b32 v10, 1, v11
    v_add_u32 v9, v9, v10
    v_lshlrev_b32 v9, 6, v9
    v_bfe_u32 v10, v8, 4, 1
    v_lshl_add_u32 v9, v10, 5, v9
    v_and_b32 v10, 1, v8
    v_lshl_add_u32 v9, v10, 4, v9
    v_bfe_u32 v10, v8, 1, 1
    v_lshl_add_u32 v9, v10, 3, v9
    v_add_u32 v3, s28, v9
    s_lshl_b32 s24, s13, 12
    s_add_u32 s24, s24, 131072
    v_add_u32 v5, s24, v1
    s_lshl_b32 s24, s13, 10
    s_add_u32 s24, s24, 131072
    v_add_u32 v6, s24, v1
    v_bfe_u32 v9, v8, 2, 2
    v_bfe_u32 v10, v8, 4, 1
    v_lshlrev_b32 v10, 2, v10
    v_lshl_add_u32 v9, v9, 3, v10
    v_and_b32 v10, 3, v8
    v_add_u32 v9, v9, v10
    v_mul_u32_u24 v9, 1152, v9
    v_lshrrev_b32 v10, 5, v8
    v_lshl_add_u32 v4, v10, 4, v9
    s_waitcnt lgkmcnt(0)
    s_mov_b32 s18, 5308416
    s_mov_b32 s19, 0x00020000
    s_mov_b32 s22, 2359296
    s_mov_b32 s23, 0x00020000
    s_mul_i32 s24, s13, 1327104
    s_lshl_b32 s25, s12, 6
    s_add_u32 s24, s24, s25
    s_mov_b32 s29, 0
    s_add_u32 m0, s28, 0
    s_add_u32 s25, s24, 0
    buffer_load_dwordx4 v2, s[16:19], s25 offen lds
    s_add_u32 m0, s28, 1024
    s_add_u32 s25, s24, 18432
    buffer_load_dwordx4 v2, s[16:19], s25 offen lds
    s_add_u32 m0, s28, 2048
    s_add_u32 s25, s24, 36864
    buffer_load_dwordx4 v2, s[16:19], s25 offen lds
    s_add_u32 m0, s28, 3072
    s_add_u32 s25, s24, 55296
    buffer_load_dwordx4 v2, s[16:19], s25 offen lds
    s_add_u32 m0, s28, 4096
    s_add_u32 s25, s24, 73728
    buffer_load_dwordx4 v2, s[16:19], s25 offen lds
    s_add_u32 m0, s28, 5120
    s_add_u32 s25, s24, 92160
    buffer_load_dwordx4 v2, s[16:19], s25 offen lds
    s_add_u32 m0, s28, 6144
    s_add_u32 s25, s24, 110592
    buffer_load_dwordx4 v2, s[16:19], s25 offen lds
    s_add_u32 m0, s28, 7168
    s_add_u32 s25, s24, 129024
    buffer_load_dwordx4 v2, s[16:19], s25 offen lds
    s_add_u32 m0, s28, 8192
    s_add_u32 s25, s24, 147456
    buffer_load_dwordx4 v2, s[16:19], s25 offen lds
    s_add_u32 m0, s28, 9216
    s_add_u32 s25, s24, 165888
    buffer_load_dwordx4 v2, s[16:19], s25 offen lds
    s_add_u32 m0, s28, 10240
    s_add_u32 s25, s24, 184320
    buffer_load_dwordx4 v2, s[16:19], s25 offen lds
    s_add_u32 m0, s28, 11264
    s_add_u32 s25, s24, 202752
    buffer_load_dwordx4 v2, s[16:19], s25 offen lds
    s_add_u32 m0, s28, 12288
    s_add_u32 s25, s24, 221184
    buffer_load_dwordx4 v2, s[16:19], s25 offen lds
    s_add_u32 m0, s28, 13312
    s_add_u32 s25, s24, 239616
    buffer_load_dwordx4 v2, s[16:19], s25 offen lds
    s_add_u32 m0, s28, 14336
    s_add_u32 s25, s24, 258048
    buffer_load_dwordx4 v2, s[16:19], s25 offen lds
    s_add_u32 m0, s28, 15360
    s_add_u32 s25, s24, 276480
    buffer_load_dwordx4 v2, s[16:19], s25 offen lds
    s_add_u32 m0, s28, 16384
    s_add_u32 s25, s24, 294912
    buffer_load_dwordx4 v2, s[16:19], s25 offen lds
    s_add_u32 m0, s28, 17408
    s_add_u32 s25, s24, 313344
    buffer_load_dwordx4 v2, s[16:19], s25 offen lds
    s_add_u32 m0, s28, 18432
    s_add_u32 s25, s24, 331776
    buffer_load_dwordx4 v2, s[16:19], s25 offen lds
    s_add_u32 m0, s28, 19456
    s_add_u32 s25, s24, 350208
    buffer_load_dwordx4 v2, s[16:19], s25 offen lds
    s_add_u32 m0, s28, 20480
    s_add_u32 s25, s24, 368640
    buffer_load_dwordx4 v2, s[16:19], s25 offen lds
    s_add_u32 m0, s28, 21504
    s_add_u32 s25, s24, 387072
    buffer_load_dwordx4 v2, s[16:19], s25 offen lds
    s_add_u32 m0, s28, 22528
    s_add_u32 s25, s24, 405504
    buffer_load_dwordx4 v2, s[16:19], s25 offen lds
    s_add_u32 m0, s28, 23552
    s_add_u32 s25, s24, 423936
    buffer_load_dwordx4 v2, s[16:19], s25 offen lds
    s_add_u32 m0, s28, 24576
    s_add_u32 s25, s24, 442368
    buffer_load_dwordx4 v2, s[16:19], s25 offen lds
    s_add_u32 m0, s28, 25600
    s_add_u32 s25, s24, 460800
    buffer_load_dwordx4 v2, s[16:19], s25 offen lds
    s_add_u32 m0, s28, 26624
    s_add_u32 s25, s24, 479232
    buffer_load_dwordx4 v2, s[16:19], s25 offen lds
    s_add_u32 m0, s28, 27648
    s_add_u32 s25, s24, 497664
    buffer_load_dwordx4 v2, s[16:19], s25 offen lds
    s_add_u32 m0, s28, 28672
    s_add_u32 s25, s24, 516096
    buffer_load_dwordx4 v2, s[16:19], s25 offen lds
    s_add_u32 m0, s28, 29696
    s_add_u32 s25, s24, 534528
    buffer_load_dwordx4 v2, s[16:19], s25 offen lds
    s_add_u32 m0, s28, 30720
    s_add_u32 s25, s24, 552960
    buffer_load_dwordx4 v2, s[16:19], s25 offen lds
    s_add_u32 m0, s28, 31744
    s_add_u32 s25, s24, 571392
    buffer_load_dwordx4 v2, s[16:19], s25 offen lds
    s_waitcnt vmcnt(28)
    ds_read_b64_tr_b16 a[0:1], v3 offset:0
    ds_read_b64_tr_b16 a[2:3], v3 offset:128
    ds_read_b64_tr_b16 a[4:5], v3 offset:512
    ds_read_b64_tr_b16 a[6:7], v3 offset:640
    ds_read_b64_tr_b16 a[8:9], v3 offset:2048
    ds_read_b64_tr_b16 a[10:11], v3 offset:2176
    ds_read_b64_tr_b16 a[12:13], v3 offset:2560
    ds_read_b64_tr_b16 a[14:15], v3 offset:2688
    s_waitcnt lgkmcnt(0)
    s_add_u32 m0, s28, 0
    s_add_u32 s25, s24, 589824
    buffer_load_dwordx4 v2, s[16:19], s25 offen lds
    s_add_u32 m0, s28, 1024
    s_add_u32 s25, s24, 608256
    buffer_load_dwordx4 v2, s[16:19], s25 offen lds
    s_add_u32 m0, s28, 2048
    s_add_u32 s25, s24, 626688
    buffer_load_dwordx4 v2, s[16:19], s25 offen lds
    s_add_u32 m0, s28, 3072
    s_add_u32 s25, s24, 645120
    buffer_load_dwordx4 v2, s[16:19], s25 offen lds
    s_waitcnt vmcnt(28)
    ds_read_b64_tr_b16 a[16:17], v3 offset:4096
    ds_read_b64_tr_b16 a[18:19], v3 offset:4224
    ds_read_b64_tr_b16 a[20:21], v3 offset:4608
    ds_read_b64_tr_b16 a[22:23], v3 offset:4736
    ds_read_b64_tr_b16 a[24:25], v3 offset:6144
    ds_read_b64_tr_b16 a[26:27], v3 offset:6272
    ds_read_b64_tr_b16 a[28:29], v3 offset:6656
    ds_read_b64_tr_b16 a[30:31], v3 offset:6784
    s_waitcnt lgkmcnt(0)
    s_add_u32 m0, s28, 4096
    s_add_u32 s25, s24, 663552
    buffer_load_dwordx4 v2, s[16:19], s25 offen lds
    s_add_u32 m0, s28, 5120
    s_add_u32 s25, s24, 681984
    buffer_load_dwordx4 v2, s[16:19], s25 offen lds
    s_add_u32 m0, s28, 6144
    s_add_u32 s25, s24, 700416
    buffer_load_dwordx4 v2, s[16:19], s25 offen lds
    s_add_u32 m0, s28, 7168
    s_add_u32 s25, s24, 718848
    buffer_load_dwordx4 v2, s[16:19], s25 offen lds
    s_waitcnt vmcnt(28)
    ds_read_b64_tr_b16 a[32:33], v3 offset:8192
    ds_read_b64_tr_b16 a[34:35], v3 offset:8320
    ds_read_b64_tr_b16 a[36:37], v3 offset:8704
    ds_read_b64_tr_b16 a[38:39], v3 offset:8832
    ds_read_b64_tr_b16 a[40:41], v3 offset:10240
    ds_read_b64_tr_b16 a[42:43], v3 offset:10368
    ds_read_b64_tr_b16 a[44:45], v3 offset:10752
    ds_read_b64_tr_b16 a[46:47], v3 offset:10880
    s_waitcnt lgkmcnt(0)
    s_add_u32 m0, s28, 8192
    s_add_u32 s25, s24, 737280
    buffer_load_dwordx4 v2, s[16:19], s25 offen lds
    s_add_u32 m0, s28, 9216
    s_add_u32 s25, s24, 755712
    buffer_load_dwordx4 v2, s[16:19], s25 offen lds
    s_add_u32 m0, s28, 10240
    s_add_u32 s25, s24, 774144
    buffer_load_dwordx4 v2, s[16:19], s25 offen lds
    s_add_u32 m0, s28, 11264
    s_add_u32 s25, s24, 792576
    buffer_load_dwordx4 v2, s[16:19], s25 offen lds
    s_waitcnt vmcnt(28)
    ds_read_b64_tr_b16 a[48:49], v3 offset:12288
    ds_read_b64_tr_b16 a[50:51], v3 offset:12416
    ds_read_b64_tr_b16 a[52:53], v3 offset:12800
    ds_read_b64_tr_b16 a[54:55], v3 offset:12928
    ds_read_b64_tr_b16 a[56:57], v3 offset:14336
    ds_read_b64_tr_b16 a[58:59], v3 offset:14464
    ds_read_b64_tr_b16 a[60:61], v3 offset:14848
    ds_read_b64_tr_b16 a[62:63], v3 offset:14976
    s_waitcnt lgkmcnt(0)
    s_add_u32 m0, s28, 12288
    s_add_u32 s25, s24, 811008
    buffer_load_dwordx4 v2, s[16:19], s25 offen lds
    s_add_u32 m0, s28, 13312
    s_add_u32 s25, s24, 829440
    buffer_load_dwordx4 v2, s[16:19], s25 offen lds
    s_add_u32 m0, s28, 14336
    s_add_u32 s25, s24, 847872
    buffer_load_dwordx4 v2, s[16:19], s25 offen lds
    s_add_u32 m0, s28, 15360
    s_add_u32 s25, s24, 866304
    buffer_load_dwordx4 v2, s[16:19], s25 offen lds
    s_waitcnt vmcnt(28)
    ds_read_b64_tr_b16 a[64:65], v3 offset:16384
    ds_read_b64_tr_b16 a[66:67], v3 offset:16512
    ds_read_b64_tr_b16 a[68:69], v3 offset:16896
    ds_read_b64_tr_b16 a[70:71], v3 offset:17024
    ds_read_b64_tr_b16 a[72:73], v3 offset:18432
    ds_read_b64_tr_b16 a[74:75], v3 offset:18560
    ds_read_b64_tr_b16 a[76:77], v3 offset:18944
    ds_read_b64_tr_b16 a[78:79], v3 offset:19072
    s_waitcnt lgkmcnt(0)
    s_add_u32 m0, s28, 16384
    s_add_u32 s25, s24, 884736
    buffer_load_dwordx4 v2, s[16:19], s25 offen lds
    s_add_u32 m0, s28, 17408
    s_add_u32 s25, s24, 903168
    buffer_load_dwordx4 v2, s[16:19], s25 offen lds
    s_add_u32 m0, s28, 18432
    s_add_u32 s25, s24, 921600
    buffer_load_dwordx4 v2, s[16:19], s25 offen lds
    s_add_u32 m0, s28, 19456
    s_add_u32 s25, s24, 940032
    buffer_load_dwordx4 v2, s[16:19], s25 offen lds
    s_waitcnt vmcnt(28)
    ds_read_b64_tr_b16 a[80:81], v3 offset:20480
    ds_read_b64_tr_b16 a[82:83], v3 offset:20608
    ds_read_b64_tr_b16 a[84:85], v3 offset:20992
    ds_read_b64_tr_b16 a[86:87], v3 offset:21120
    ds_read_b64_tr_b16 a[88:89], v3 offset:22528
    ds_read_b64_tr_b16 a[90:91], v3 offset:22656
    ds_read_b64_tr_b16 a[92:93], v3 offset:23040
    ds_read_b64_tr_b16 a[94:95], v3 offset:23168
    s_waitcnt lgkmcnt(0)
    s_add_u32 m0, s28, 20480
    s_add_u32 s25, s24, 958464
    buffer_load_dwordx4 v2, s[16:19], s25 offen lds
    s_add_u32 m0, s28, 21504
    s_add_u32 s25, s24, 976896
    buffer_load_dwordx4 v2, s[16:19], s25 offen lds
    s_add_u32 m0, s28, 22528
    s_add_u32 s25, s24, 995328
    buffer_load_dwordx4 v2, s[16:19], s25 offen lds
    s_add_u32 m0, s28, 23552
    s_add_u32 s25, s24, 1013760
    buffer_load_dwordx4 v2, s[16:19], s25 offen lds
    s_waitcnt vmcnt(28)
    ds_read_b64_tr_b16 a[96:97], v3 offset:24576
    ds_read_b64_tr_b16 a[98:99], v3 offset:24704
    ds_read_b64_tr_b16 a[100:101], v3 offset:25088
    ds_read_b64_tr_b16 a[102:103], v3 offset:25216
    ds_read_b64_tr_b16 a[104:105], v3 offset:26624
    ds_read_b64_tr_b16 a[106:107], v3 offset:26752
    ds_read_b64_tr_b16 a[108:109], v3 offset:27136
    ds_read_b64_tr_b16 a[110:111], v3 offset:27264
    s_waitcnt lgkmcnt(0)
    s_add_u32 m0, s28, 24576
    s_add_u32 s25, s24, 1032192
    buffer_load_dwordx4 v2, s[16:19], s25 offen lds
    s_add_u32 m0, s28, 25600
    s_add_u32 s25, s24, 1050624
    buffer_load_dwordx4 v2, s[16:19], s25 offen lds
    s_add_u32 m0, s28, 26624
    s_add_u32 s25, s24, 1069056
    buffer_load_dwordx4 v2, s[16:19], s25 offen lds
    s_add_u32 m0, s28, 27648
    s_add_u32 s25, s24, 1087488
    buffer_load_dwordx4 v2, s[16:19], s25 offen lds
    s_waitcnt vmcnt(28)
    ds_read_b64_tr_b16 a[112:113], v3 offset:28672
    ds_read_b64_tr_b16 a[114:115], v3 offset:28800
    ds_read_b64_tr_b16 a[116:117], v3 offset:29184
    ds_read_b64_tr_b16 a[118:119], v3 offset:29312
    ds_read_b64_tr_b16 a[120:121], v3 offset:30720
    ds_read_b64_tr_b16 a[122:123], v3 offset:30848
    ds_read_b64_tr_b16 a[124:125], v3 offset:31232
    ds_read_b64_tr_b16 a[126:127], v3 offset:31360
    s_waitcnt lgkmcnt(0)
    s_add_u32 m0, s28, 28672
    s_add_u32 s25, s24, 1105920
    buffer_load_dwordx4 v2, s[16:19], s25 offen lds
    s_add_u32 m0, s28, 29696
    s_add_u32 s25, s24, 1124352
    buffer_load_dwordx4 v2, s[16:19], s25 offen lds
    s_add_u32 m0, s28, 30720
    s_add_u32 s25, s24, 1142784
    buffer_load_dwordx4 v2, s[16:19], s25 offen lds
    s_add_u32 m0, s28, 31744
    s_add_u32 s25, s24, 1161216
    buffer_load_dwordx4 v2, s[16:19], s25 offen lds
    s_waitcnt vmcnt(28)
    ds_read_b64_tr_b16 a[128:129], v3 offset:0
    ds_read_b64_tr_b16 a[130:131], v3 offset:128
    ds_read_b64_tr_b16 a[132:133], v3 offset:512
    ds_read_b64_tr_b16 a[134:135], v3 offset:640
    ds_read_b64_tr_b16 a[136:137], v3 offset:2048
    ds_read_b64_tr_b16 a[138:139], v3 offset:2176
    ds_read_b64_tr_b16 a[140:141], v3 offset:2560
    ds_read_b64_tr_b16 a[142:143], v3 offset:2688
    s_waitcnt lgkmcnt(0)
    s_add_u32 m0, s28, 0
    s_add_u32 s25, s24, 1179648
    buffer_load_dwordx4 v2, s[16:19], s25 offen lds
    s_add_u32 m0, s28, 1024
    s_add_u32 s25, s24, 1198080
    buffer_load_dwordx4 v2, s[16:19], s25 offen lds
    s_add_u32 m0, s28, 2048
    s_add_u32 s25, s24, 1216512
    buffer_load_dwordx4 v2, s[16:19], s25 offen lds
    s_add_u32 m0, s28, 3072
    s_add_u32 s25, s24, 1234944
    buffer_load_dwordx4 v2, s[16:19], s25 offen lds
    s_waitcnt vmcnt(28)
    ds_read_b64_tr_b16 a[144:145], v3 offset:4096
    ds_read_b64_tr_b16 a[146:147], v3 offset:4224
    ds_read_b64_tr_b16 a[148:149], v3 offset:4608
    ds_read_b64_tr_b16 a[150:151], v3 offset:4736
    ds_read_b64_tr_b16 a[152:153], v3 offset:6144
    ds_read_b64_tr_b16 a[154:155], v3 offset:6272
    ds_read_b64_tr_b16 a[156:157], v3 offset:6656
    ds_read_b64_tr_b16 a[158:159], v3 offset:6784
    s_waitcnt lgkmcnt(0)
    s_add_u32 m0, s28, 4096
    s_add_u32 s25, s24, 1253376
    buffer_load_dwordx4 v2, s[16:19], s25 offen lds
    s_add_u32 m0, s28, 5120
    s_add_u32 s25, s24, 1271808
    buffer_load_dwordx4 v2, s[16:19], s25 offen lds
    s_add_u32 m0, s28, 6144
    s_add_u32 s25, s24, 1290240
    buffer_load_dwordx4 v2, s[16:19], s25 offen lds
    s_add_u32 m0, s28, 7168
    s_add_u32 s25, s24, 1308672
    buffer_load_dwordx4 v2, s[16:19], s25 offen lds
    s_waitcnt vmcnt(28)
    ds_read_b64_tr_b16 a[160:161], v3 offset:8192
    ds_read_b64_tr_b16 a[162:163], v3 offset:8320
    ds_read_b64_tr_b16 a[164:165], v3 offset:8704
    ds_read_b64_tr_b16 a[166:167], v3 offset:8832
    ds_read_b64_tr_b16 a[168:169], v3 offset:10240
    ds_read_b64_tr_b16 a[170:171], v3 offset:10368
    ds_read_b64_tr_b16 a[172:173], v3 offset:10752
    ds_read_b64_tr_b16 a[174:175], v3 offset:10880
    s_waitcnt lgkmcnt(0)
    s_waitcnt vmcnt(24)
    ds_read_b64_tr_b16 a[176:177], v3 offset:12288
    ds_read_b64_tr_b16 a[178:179], v3 offset:12416
    ds_read_b64_tr_b16 a[180:181], v3 offset:12800
    ds_read_b64_tr_b16 a[182:183], v3 offset:12928
    ds_read_b64_tr_b16 a[184:185], v3 offset:14336
    ds_read_b64_tr_b16 a[186:187], v3 offset:14464
    ds_read_b64_tr_b16 a[188:189], v3 offset:14848
    ds_read_b64_tr_b16 a[190:191], v3 offset:14976
    s_waitcnt lgkmcnt(0)
    s_waitcnt vmcnt(20)
    ds_read_b64_tr_b16 a[192:193], v3 offset:16384
    ds_read_b64_tr_b16 a[194:195], v3 offset:16512
    ds_read_b64_tr_b16 a[196:197], v3 offset:16896
    ds_read_b64_tr_b16 a[198:199], v3 offset:17024
    ds_read_b64_tr_b16 a[200:201], v3 offset:18432
    ds_read_b64_tr_b16 a[202:203], v3 offset:18560
    ds_read_b64_tr_b16 a[204:205], v3 offset:18944
    ds_read_b64_tr_b16 a[206:207], v3 offset:19072
    s_waitcnt lgkmcnt(0)
    s_waitcnt vmcnt(16)
    ds_read_b64_tr_b16 a[208:209], v3 offset:20480
    ds_read_b64_tr_b16 a[210:211], v3 offset:20608
    ds_read_b64_tr_b16 a[212:213], v3 offset:20992
    ds_read_b64_tr_b16 a[214:215], v3 offset:21120
    ds_read_b64_tr_b16 a[216:217], v3 offset:22528
    ds_read_b64_tr_b16 a[218:219], v3 offset:22656
    ds_read_b64_tr_b16 a[220:221], v3 offset:23040
    ds_read_b64_tr_b16 a[222:223], v3 offset:23168
    s_waitcnt lgkmcnt(0)
    s_waitcnt vmcnt(12)
    ds_read_b64_tr_b16 a[224:225], v3 offset:24576
    ds_read_b64_tr_b16 a[226:227], v3 offset:24704
    ds_read_b64_tr_b16 a[228:229], v3 offset:25088
    ds_read_b64_tr_b16 a[230:231], v3 offset:25216
    ds_read_b64_tr_b16 a[232:233], v3 offset:26624
    ds_read_b64_tr_b16 a[234:235], v3 offset:26752
    ds_read_b64_tr_b16 a[236:237], v3 offset:27136
    ds_read_b64_tr_b16 a[238:239], v3 offset:27264
    s_waitcnt lgkmcnt(0)
    s_waitcnt vmcnt(8)
    ds_read_b64_tr_b16 a[240:241], v3 offset:28672
    ds_read_b64_tr_b16 a[242:243], v3 offset:28800
    ds_read_b64_tr_b16 a[244:245], v3 offset:29184
    ds_read_b64_tr_b16 a[246:247], v3 offset:29312
    ds_read_b64_tr_b16 a[248:249], v3 offset:30720
    ds_read_b64_tr_b16 a[250:251], v3 offset:30848
    ds_read_b64_tr_b16 a[252:253], v3 offset:31232
    ds_read_b64_tr_b16 a[254:255], v3 offset:31360
    s_waitcnt lgkmcnt(0)
    s_waitcnt vmcnt(4)
    ds_read_b64_tr_b16 v[64:65], v3 offset:0
    ds_read_b64_tr_b16 v[66:67], v3 offset:128
    ds_read_b64_tr_b16 v[68:69], v3 offset:512
    ds_read_b64_tr_b16 v[70:71], v3 offset:640
    ds_read_b64_tr_b16 v[72:73], v3 offset:2048
    ds_read_b64_tr_b16 v[74:75], v3 offset:2176
    ds_read_b64_tr_b16 v[76:77], v3 offset:2560
    ds_read_b64_tr_b16 v[78:79], v3 offset:2688
    s_waitcnt lgkmcnt(0)
    s_waitcnt vmcnt(0)
    ds_read_b64_tr_b16 v[80:81], v3 offset:4096
    ds_read_b64_tr_b16 v[82:83], v3 offset:4224
    ds_read_b64_tr_b16 v[84:85], v3 offset:4608
    ds_read_b64_tr_b16 v[86:87], v3 offset:4736
    ds_read_b64_tr_b16 v[88:89], v3 offset:6144
    ds_read_b64_tr_b16 v[90:91], v3 offset:6272
    ds_read_b64_tr_b16 v[92:93], v3 offset:6656
    ds_read_b64_tr_b16 v[94:95], v3 offset:6784
    s_waitcnt lgkmcnt(0)
    s_mov_b32 s36, 0
    s_mov_b32 s37, 0xf0000000
L_down_loop:
    s_cmp_eq_u32 s36, 1
    s_cbranch_scc1 L_down_go
    s_mov_b32 s97, 0
L_down_w:
    s_lshr_b32 s30, s14, 3
    s_mul_i32 s30, s30, 12288
    s_add_u32 s30, s30, 117791744
    v_lshlrev_b32 v12, 2, v1
    buffer_load_dword v10, v12, s[4:7], s30 offen sc1
    buffer_load_dword v11, v12, s[4:7], s30 offen offset:512 sc1
    s_add_u32 s97, s97, 1
    s_cmp_gt_u32 s97, 0x20000
    s_cbranch_scc1 L_fail
    s_waitcnt vmcnt(0)
    v_and_b32 v10, v10, v11
    v_cmp_ne_u32 vcc, 1, v10
    s_cbranch_vccz L_down_ok
    s_sleep 16
    s_branch L_down_w
L_down_ok:
    s_lshl_b32 s34, s14, 2
    s_add_u32 s34, s34, s13
    s_mul_i32 s34, s34, 73728
    s_add_u32 s34, s34, 50331648
    buffer_load_dwordx4 v[96:99], v1, s[4:7], s34 offen offset:0 sc1
    buffer_load_dwordx4 v[100:103], v1, s[4:7], s34 offen offset:1024 sc1
    buffer_load_dwordx4 v[104:107], v1, s[4:7], s34 offen offset:2048 sc1
    buffer_load_dwordx4 v[108:111], v1, s[4:7], s34 offen offset:3072 sc1
    s_add_u32 s34, s34, 4096
    buffer_load_dwordx4 v[112:115], v1, s[4:7], s34 offen offset:0 sc1
    buffer_load_dwordx4 v[116:119], v1, s[4:7], s34 offen offset:1024 sc1
    buffer_load_dwordx4 v[120:123], v1, s[4:7], s34 offen offset:2048 sc1
    buffer_load_dwordx4 v[124:127], v1, s[4:7], s34 offen offset:3072 sc1
    s_add_u32 s34, s34, 4096
    buffer_load_dwordx4 v[128:131], v1, s[4:7], s34 offen offset:0 sc1
    buffer_load_dwordx4 v[132:135], v1, s[4:7], s34 offen offset:1024 sc1
    buffer_load_dwordx4 v[136:139], v1, s[4:7], s34 offen offset:2048 sc1
    buffer_load_dwordx4 v[140:143], v1, s[4:7], s34 offen offset:3072 sc1
    s_add_u32 s34, s34, 4096
    buffer_load_dwordx4 v[144:147], v1, s[4:7], s34 offen offset:0 sc1
    buffer_load_dwordx4 v[148:151], v1, s[4:7], s34 offen offset:1024 sc1
    buffer_load_dwordx4 v[152:155], v1, s[4:7], s34 offen offset:2048 sc1
    buffer_load_dwordx4 v[156:159], v1, s[4:7], s34 offen offset:3072 sc1
    s_add_u32 s34, s34, 4096
    buffer_load_dwordx4 v[160:163], v1, s[4:7], s34 offen offset:0 sc1
    buffer_load_dwordx4 v[164:167], v1, s[4:7], s34 offen offset:1024 sc1
    buffer_load_dwordx4 v[168:171], v1, s[4:7], s34 offen offset:2048 sc1
    buffer_load_dwordx4 v[172:175], v1, s[4:7], s34 offen offset:3072 sc1
    s_add_u32 s34, s34, 4096
    buffer_load_dwordx4 v[176:179], v1, s[4:7], s34 offen offset:0 sc1
    buffer_load_dwordx4 v[180:183], v1, s[4:7], s34 offen offset:1024 sc1
    buffer_load_dwordx4 v[184:187], v1, s[4:7], s34 offen offset:2048 sc1
    buffer_load_dwordx4 v[188:191], v1, s[4:7], s34 offen offset:3072 sc1
    s_add_u32 s34, s34, 4096
    buffer_load_dwordx4 v[192:195], v1, s[4:7], s34 offen offset:0 sc1
    buffer_load_dwordx4 v[196:199], v1, s[4:7], s34 offen offset:1024 sc1
    buffer_load_dwordx4 v[200:203], v1, s[4:7], s34 offen offset:2048 sc1
    buffer_load_dwordx4 v[204:207], v1, s[4:7], s34 offen offset:3072 sc1
    s_add_u32 s34, s34, 4096
    buffer_load_dwordx4 v[208:211], v1, s[4:7], s34 offen offset:0 sc1
    buffer_load_dwordx4 v[212:215], v1, s[4:7], s34 offen offset:1024 sc1
    buffer_load_dwordx4 v[216:219], v1, s[4:7], s34 offen offset:2048 sc1
    buffer_load_dwordx4 v[220:223], v1, s[4:7], s34 offen offset:3072 sc1
    s_add_u32 s34, s34, 4096
    buffer_load_dwordx4 v[224:227], v1, s[4:7], s34 offen offset:0 sc1
    buffer_load_dwordx4 v[228:231], v1, s[4:7], s34 offen offset:1024 sc1
    buffer_load_dwordx4 v[232:235], v1, s[4:7], s34 offen offset:2048 sc1
    buffer_load_dwordx4 v[236:239], v1, s[4:7], s34 offen offset:3072 sc1
    s_add_u32 s34, s34, 4096
    buffer_load_dwordx4 v[240:243], v1, s[4:7], s34 offen offset:0 sc1
    buffer_load_dwordx4 v[244:247], v1, s[4:7], s34 offen offset:1024 sc1
    buffer_load_dwordx4 v[248:251], v1, s[4:7], s34 offen offset:2048 sc1
    buffer_load_dwordx4 v[252:255], v1, s[4:7], s34 offen offset:3072 sc1
L_down_go:
    s_add_u32 s35, s14, 1
    s_cmp_lt_u32 s35, s92
    s_cselect_b32 s36, 1, 0
    s_cselect_b32 s38, s35, s14
    s_lshr_b32 s30, s38, 3
    s_mul_i32 s30, s30, 12288
    s_add_u32 s30, s30, 117791744
    v_lshlrev_b32 v12, 2, v1
    buffer_load_dword v10, v12, s[4:7], s30 offen sc1
    buffer_load_dword v11, v12, s[4:7], s30 offen offset:512 sc1
    s_mul_i32 s26, s14, 18
    s_add_u32 s26, s26, s12
    s_lshl_b32 s26, s26, 2
    s_add_u32 s26, s26, s13
    s_lshl_b32 s26, s26, 10
    s_add_u32 s26, s26, 122683392
    s_waitcnt vmcnt(38)
    v_mfma_f32_32x32x16_bf16 v[16:31], a[0:3], v[96:99], 0
    s_add_u32 s34, s34, 4096
    buffer_load_dwordx4 v[96:99], v1, s[4:7], s34 offen offset:0 sc1
    v_mfma_f32_32x32x16_bf16 v[16:31], a[4:7], v[100:103], v[16:31]
    buffer_load_dwordx4 v[100:103], v1, s[4:7], s34 offen offset:1024 sc1
    s_waitcnt vmcnt(38)
    v_mfma_f32_32x32x16_bf16 v[16:31], a[8:11], v[104:107], v[16:31]
    buffer_load_dwordx4 v[104:107], v1, s[4:7], s34 offen offset:2048 sc1
    v_mfma_f32_32x32x16_bf16 v[16:31], a[12:15], v[108:111], v[16:31]
    buffer_load_dwordx4 v[108:111], v1, s[4:7], s34 offen offset:3072 sc1
    s_waitcnt vmcnt(38)
    v_mfma_f32_32x32x16_bf16 v[16:31], a[16:19], v[112:115], v[16:31]
    s_add_u32 s34, s34, 4096
    buffer_load_dwordx4 v[112:115], v1, s[4:7], s34 offen offset:0 sc1
    v_mfma_f32_32x32x16_bf16 v[16:31], a[20:23], v[116:119], v[16:31]
    buffer_load_dwordx4 v[116:119], v1, s[4:7], s34 offen offset:1024 sc1
    s_waitcnt vmcnt(38)
    v_mfma_f32_32x32x16_bf16 v[16:31], a[24:27], v[120:123], v[16:31]
    buffer_load_dwordx4 v[120:123], v1, s[4:7], s34 offen offset:2048 sc1
    v_mfma_f32_32x32x16_bf16 v[16:31], a[28:31], v[124:127], v[16:31]
    buffer_load_dwordx4 v[124:127], v1, s[4:7], s34 offen offset:3072 sc1
    s_waitcnt vmcnt(38)
    v_mfma_f32_32x32x16_bf16 v[16:31], a[32:35], v[128:131], v[16:31]
    s_add_u32 s34, s34, 4096
    buffer_load_dwordx4 v[128:131], v1, s[4:7], s34 offen offset:0 sc1
    v_mfma_f32_32x32x16_bf16 v[16:31], a[36:39], v[132:135], v[16:31]
    buffer_load_dwordx4 v[132:135], v1, s[4:7], s34 offen offset:1024 sc1
    s_waitcnt vmcnt(38)
    v_mfma_f32_32x32x16_bf16 v[16:31], a[40:43], v[136:139], v[16:31]
    buffer_load_dwordx4 v[136:139], v1, s[4:7], s34 offen offset:2048 sc1
    v_mfma_f32_32x32x16_bf16 v[16:31], a[44:47], v[140:143], v[16:31]
    buffer_load_dwordx4 v[140:143], v1, s[4:7], s34 offen offset:3072 sc1
    s_waitcnt vmcnt(38)
    v_mfma_f32_32x32x16_bf16 v[16:31], a[48:51], v[144:147], v[16:31]
    s_add_u32 s34, s34, 4096
    buffer_load_dwordx4 v[144:147], v1, s[4:7], s34 offen offset:0 sc1
    v_mfma_f32_32x32x16_bf16 v[16:31], a[52:55], v[148:151], v[16:31]
    buffer_load_dwordx4 v[148:151], v1, s[4:7], s34 offen offset:1024 sc1
    s_waitcnt vmcnt(38)
    v_mfma_f32_32x32x16_bf16 v[16:31], a[56:59], v[152:155], v[16:31]
    buffer_load_dwordx4 v[152:155], v1, s[4:7], s34 offen offset:2048 sc1
    v_mfma_f32_32x32x16_bf16 v[16:31], a[60:63], v[156:159], v[16:31]
    buffer_load_dwordx4 v[156:159], v1, s[4:7], s34 offen offset:3072 sc1
    s_waitcnt vmcnt(38)
    v_mfma_f32_32x32x16_bf16 v[16:31], a[64:67], v[160:163], v[16:31]
    s_add_u32 s34, s34, 4096
    buffer_load_dwordx4 v[160:163], v1, s[4:7], s34 offen offset:0 sc1
    v_mfma_f32_32x32x16_bf16 v[16:31], a[68:71], v[164:167], v[16:31]
    buffer_load_dwordx4 v[164:167], v1, s[4:7], s34 offen offset:1024 sc1
    s_waitcnt vmcnt(38)
    v_mfma_f32_32x32x16_bf16 v[16:31], a[72:75], v[168:171], v[16:31]
    buffer_load_dwordx4 v[168:171], v1, s[4:7], s34 offen offset:2048 sc1
    v_mfma_f32_32x32x16_bf16 v[16:31], a[76:79], v[172:175], v[16:31]
    buffer_load_dwordx4 v[172:175], v1, s[4:7], s34 offen offset:3072 sc1
    s_waitcnt vmcnt(38)
    v_mfma_f32_32x32x16_bf16 v[16:31], a[80:83], v[176:179], v[16:31]
    s_add_u32 s34, s34, 4096
    buffer_load_dwordx4 v[176:179], v1, s[4:7], s34 offen offset:0 sc1
    v_mfma_f32_32x32x16_bf16 v[16:31], a[84:87], v[180:183], v[16:31]
    buffer_load_dwordx4 v[180:183], v1, s[4:7], s34 offen offset:1024 sc1
    s_waitcnt vmcnt(38)
    v_mfma_f32_32x32x16_bf16 v[16:31], a[88:91], v[184:187], v[16:31]
    buffer_load_dwordx4 v[184:187], v1, s[4:7], s34 offen offset:2048 sc1
    v_mfma_f32_32x32x16_bf16 v[16:31], a[92:95], v[188:191], v[16:31]
    buffer_load_dwordx4 v[188:191], v1, s[4:7], s34 offen offset:3072 sc1
    s_waitcnt vmcnt(38)
    v_mfma_f32_32x32x16_bf16 v[16:31], a[96:99], v[192:195], v[16:31]
    s_add_u32 s34, s34, 4096
    buffer_load_dwordx4 v[192:195], v1, s[4:7], s34 offen offset:0 sc1
    v_mfma_f32_32x32x16_bf16 v[16:31], a[100:103], v[196:199], v[16:31]
    buffer_load_dwordx4 v[196:199], v1, s[4:7], s34 offen offset:1024 sc1
    s_waitcnt vmcnt(38)
    v_mfma_f32_32x32x16_bf16 v[16:31], a[104:107], v[200:203], v[16:31]
    buffer_load_dwordx4 v[200:203], v1, s[4:7], s34 offen offset:2048 sc1
    v_mfma_f32_32x32x16_bf16 v[16:31], a[108:111], v[204:207], v[16:31]
    buffer_load_dwordx4 v[204:207], v1, s[4:7], s34 offen offset:3072 sc1
    s_waitcnt vmcnt(38)
    v_mfma_f32_32x32x16_bf16 v[16:31], a[112:115], v[208:211], v[16:31]
    s_add_u32 s34, s34, 4096
    buffer_load_dwordx4 v[208:211], v1, s[4:7], s34 offen offset:0 sc1
    v_mfma_f32_32x32x16_bf16 v[16:31], a[116:119], v[212:215], v[16:31]
    buffer_load_dwordx4 v[212:215], v1, s[4:7], s34 offen offset:1024 sc1
    s_waitcnt vmcnt(38)
    v_mfma_f32_32x32x16_bf16 v[16:31], a[120:123], v[216:219], v[16:31]
    buffer_load_dwordx4 v[216:219], v1, s[4:7], s34 offen offset:2048 sc1
    v_mfma_f32_32x32x16_bf16 v[16:31], a[124:127], v[220:223], v[16:31]
    buffer_load_dwordx4 v[220:223], v1, s[4:7], s34 offen offset:3072 sc1
    s_waitcnt vmcnt(38)
    v_mfma_f32_32x32x16_bf16 v[16:31], a[128:131], v[224:227], v[16:31]
    v_mfma_f32_32x32x16_bf16 v[16:31], a[132:135], v[228:231], v[16:31]
    s_waitcnt vmcnt(36)
    v_mfma_f32_32x32x16_bf16 v[16:31], a[136:139], v[232:235], v[16:31]
    v_mfma_f32_32x32x16_bf16 v[16:31], a[140:143], v[236:239], v[16:31]
    s_waitcnt vmcnt(34)
    v_mfma_f32_32x32x16_bf16 v[16:31], a[144:147], v[240:243], v[16:31]
    v_mfma_f32_32x32x16_bf16 v[16:31], a[148:151], v[244:247], v[16:31]
    s_waitcnt vmcnt(32)
    v_mfma_f32_32x32x16_bf16 v[16:31], a[152:155], v[248:251], v[16:31]
    v_mfma_f32_32x32x16_bf16 v[16:31], a[156:159], v[252:255], v[16:31]
    s_waitcnt vmcnt(30)
    v_mfma_f32_32x32x16_bf16 v[16:31], a[160:163], v[96:99], v[16:31]
    v_mfma_f32_32x32x16_bf16 v[16:31], a[164:167], v[100:103], v[16:31]
    s_waitcnt vmcnt(28)
    v_mfma_f32_32x32x16_bf16 v[16:31], a[168:171], v[104:107], v[16:31]
    v_mfma_f32_32x32x16_bf16 v[16:31], a[172:175], v[108:111], v[16:31]
    s_waitcnt vmcnt(26)
    v_mfma_f32_32x32x16_bf16 v[16:31], a[176:179], v[112:115], v[16:31]
    v_mfma_f32_32x32x16_bf16 v[16:31], a[180:183], v[116:119], v[16:31]
    s_waitcnt vmcnt(24)
    v_mfma_f32_32x32x16_bf16 v[16:31], a[184:187], v[120:123], v[16:31]
    v_mfma_f32_32x32x16_bf16 v[16:31], a[188:191], v[124:127], v[16:31]
    s_waitcnt vmcnt(22)
    v_mfma_f32_32x32x16_bf16 v[16:31], a[192:195], v[128:131], v[16:31]
    v_mfma_f32_32x32x16_bf16 v[16:31], a[196:199], v[132:135], v[16:31]
    s_waitcnt vmcnt(20)
    v_mfma_f32_32x32x16_bf16 v[16:31], a[200:203], v[136:139], v[16:31]
    v_mfma_f32_32x32x16_bf16 v[16:31], a[204:207], v[140:143], v[16:31]
    s_waitcnt vmcnt(18)
    v_mfma_f32_32x32x16_bf16 v[16:31], a[208:211], v[144:147], v[16:31]
    v_mfma_f32_32x32x16_bf16 v[16:31], a[212:215], v[148:151], v[16:31]
    s_waitcnt vmcnt(16)
    v_mfma_f32_32x32x16_bf16 v[16:31], a[216:219], v[152:155], v[16:31]
    v_mfma_f32_32x32x16_bf16 v[16:31], a[220:223], v[156:159], v[16:31]
    s_waitcnt vmcnt(14)
    v_mfma_f32_32x32x16_bf16 v[16:31], a[224:227], v[160:163], v[16:31]
    v_mfma_f32_32x32x16_bf16 v[16:31], a[228:231], v[164:167], v[16:31]
    s_waitcnt vmcnt(12)
    v_mfma_f32_32x32x16_bf16 v[16:31], a[232:235], v[168:171], v[16:31]
    v_mfma_f32_32x32x16_bf16 v[16:31], a[236:239], v[172:175], v[16:31]
    s_waitcnt vmcnt(10)
    v_mfma_f32_32x32x16_bf16 v[16:31], a[240:243], v[176:179], v[16:31]
    v_mfma_f32_32x32x16_bf16 v[16:31], a[244:247], v[180:183], v[16:31]
    s_waitcnt vmcnt(8)
    v_mfma_f32_32x32x16_bf16 v[16:31], a[248:251], v[184:187], v[16:31]
    v_mfma_f32_32x32x16_bf16 v[16:31], a[252:255], v[188:191], v[16:31]
    s_waitcnt vmcnt(6)
    v_mfma_f32_32x32x16_bf16 v[16:31], v[64:67], v[192:195], v[16:31]
    v_mfma_f32_32x32x16_bf16 v[16:31], v[68:71], v[196:199], v[16:31]
    s_waitcnt vmcnt(4)
    v_mfma_f32_32x32x16_bf16 v[16:31], v[72:75], v[200:203], v[16:31]
    v_mfma_f32_32x32x16_bf16 v[16:31], v[76:79], v[204:207], v[16:31]
    s_waitcnt vmcnt(2)
    v_mfma_f32_32x32x16_bf16 v[16:31], v[80:83], v[208:211], v[16:31]
    v_mfma_f32_32x32x16_bf16 v[16:31], v[84:87], v[212:215], v[16:31]
    s_waitcnt vmcnt(0)
    v_mfma_f32_32x32x16_bf16 v[16:31], v[88:91], v[216:219], v[16:31]
    v_mfma_f32_32x32x16_bf16 v[16:31], v[92:95], v[220:223], v[16:31]
    s_cmp_eq_u32 s36, 0
    s_cbranch_scc1 L_down_fin
    s_mov_b32 s36, 2
    v_and_b32 v10, v10, v11
    v_cmp_ne_u32 vcc, 1, v10
    s_cbranch_vccnz L_down_fin
    s_mov_b32 s36, 1
    s_lshl_b32 s34, s35, 2
    s_add_u32 s34, s34, s13
    s_mul_i32 s34, s34, 73728
    s_add_u32 s34, s34, 50331648
    buffer_load_dwordx4 v[96:99], v1, s[4:7], s34 offen offset:0 sc1
    buffer_load_dwordx4 v[100:103], v1, s[4:7], s34 offen offset:1024 sc1
    buffer_load_dwordx4 v[104:107], v1, s[4:7], s34 offen offset:2048 sc1
    buffer_load_dwordx4 v[108:111], v1, s[4:7], s34 offen offset:3072 sc1
    s_add_u32 s34, s34, 4096
    buffer_load_dwordx4 v[112:115], v1, s[4:7], s34 offen offset:0 sc1
    buffer_load_dwordx4 v[116:119], v1, s[4:7], s34 offen offset:1024 sc1
    buffer_load_dwordx4 v[120:123], v1, s[4:7], s34 offen offset:2048 sc1
    buffer_load_dwordx4 v[124:127], v1, s[4:7], s34 offen offset:3072 sc1
    s_add_u32 s34, s34, 4096
    buffer_load_dwordx4 v[128:131], v1, s[4:7], s34 offen offset:0 sc1
    buffer_load_dwordx4 v[132:135], v1, s[4:7], s34 offen offset:1024 sc1
    buffer_load_dwordx4 v[136:139], v1, s[4:7], s34 offen offset:2048 sc1
    buffer_load_dwordx4 v[140:143], v1, s[4:7], s34 offen offset:3072 sc1
    s_add_u32 s34, s34, 4096
    buffer_load_dwordx4 v[144:147], v1, s[4:7], s34 offen offset:0 sc1
    buffer_load_dwordx4 v[148:151], v1, s[4:7], s34 offen offset:1024 sc1
    buffer_load_dwordx4 v[152:155], v1, s[4:7], s34 offen offset:2048 sc1
    buffer_load_dwordx4 v[156:159], v1, s[4:7], s34 offen offset:3072 sc1
    s_add_u32 s34, s34, 4096
    buffer_load_dwordx4 v[160:163], v1, s[4:7], s34 offen offset:0 sc1
    buffer_load_dwordx4 v[164:167], v1, s[4:7], s34 offen offset:1024 sc1
    buffer_load_dwordx4 v[168:171], v1, s[4:7], s34 offen offset:2048 sc1
    buffer_load_dwordx4 v[172:175], v1, s[4:7], s34 offen offset:3072 sc1
    s_add_u32 s34, s34, 4096
    buffer_load_dwordx4 v[176:179], v1, s[4:7], s34 offen offset:0 sc1
    buffer_load_dwordx4 v[180:183], v1, s[4:7], s34 offen offset:1024 sc1
    buffer_load_dwordx4 v[184:187], v1, s[4:7], s34 offen offset:2048 sc1
    buffer_load_dwordx4 v[188:191], v1, s[4:7], s34 offen offset:3072 sc1
    s_add_u32 s34, s34, 4096
    buffer_load_dwordx4 v[192:195], v1, s[4:7], s34 offen offset:0 sc1
    buffer_load_dwordx4 v[196:199], v1, s[4:7], s34 offen offset:1024 sc1
    buffer_load_dwordx4 v[200:203], v1, s[4:7], s34 offen offset:2048 sc1
    buffer_load_dwordx4 v[204:207], v1, s[4:7], s34 offen offset:3072 sc1
    s_add_u32 s34, s34, 4096
    buffer_load_dwordx4 v[208:211], v1, s[4:7], s34 offen offset:0 sc1
    buffer_load_dwordx4 v[212:215], v1, s[4:7], s34 offen offset:1024 sc1
    buffer_load_dwordx4 v[216:219], v1, s[4:7], s34 offen offset:2048 sc1
    buffer_load_dwordx4 v[220:223], v1, s[4:7], s34 offen offset:3072 sc1
    s_add_u32 s34, s34, 4096
    buffer_load_dwordx4 v[224:227], v1, s[4:7], s34 offen offset:0 sc1
    buffer_load_dwordx4 v[228:231], v1, s[4:7], s34 offen offset:1024 sc1
    buffer_load_dwordx4 v[232:235], v1, s[4:7], s34 offen offset:2048 sc1
    buffer_load_dwordx4 v[236:239], v1, s[4:7], s34 offen offset:3072 sc1
    s_add_u32 s34, s34, 4096
    buffer_load_dwordx4 v[240:243], v1, s[4:7], s34 offen offset:0 sc1
    buffer_load_dwordx4 v[244:247], v1, s[4:7], s34 offen offset:1024 sc1
    buffer_load_dwordx4 v[248:251], v1, s[4:7], s34 offen offset:2048 sc1
    buffer_load_dwordx4 v[252:255], v1, s[4:7], s34 offen offset:3072 sc1
L_down_fin:
    v_add_u32 v8, s29, v5
    v_add_u32 v9, s29, v6
    s_xor_b32 s29, s29, 16384
    ds_write_b128 v8, v[16:19] offset:0
    ds_write_b128 v8, v[20:23] offset:1024
    ds_write_b128 v8, v[24:27] offset:2048
    ds_write_b128 v8, v[28:31] offset:3072
    s_waitcnt lgkmcnt(0)
    s_barrier
    ds_read_b128 v[36:39], v9 offset:0
    ds_read_b128 v[40:43], v9 offset:4096
    ds_read_b128 v[44:47], v9 offset:8192
    ds_read_b128 v[48:51], v9 offset:12288
    s_cmp_eq_u32 s13, 0
    s_cbranch_scc0 Low_19
    s_mov_b64 exec, 1
    v_mov_b32 v13, 1
    buffer_store_dword v13, off, s[4:7], s37 sc1
    s_mov_b64 exec, -1
Low_19:
    s_mul_i32 s24, s14, 36864
    s_lshl_b32 s25, s12, 6
    s_add_u32 s24, s24, s25
    s_lshr_b32 s25, s13, 1
    s_lshl_b32 s25, s25, 5
    s_add_u32 s24, s24, s25
    s_and_b32 s25, s13, 1
    s_lshl_b32 s25, s25, 3
    s_add_u32 s24, s24, s25
    s_waitcnt lgkmcnt(0)
    v_add_f32 v36, v36, v40
    v_add_f32 v44, v44, v48
    v_add_f32 v37, v37, v41
    v_add_f32 v45, v45, v49
    v_add_f32 v38, v38, v42
    v_add_f32 v46, v46, v50
    v_add_f32 v39, v39, v43
    v_add_f32 v47, v47, v51
    v_add_f32 v36, v36, v44
    v_add_f32 v37, v37, v45
    v_add_f32 v38, v38, v46
    v_add_f32 v39, v39, v47
    buffer_store_dwordx4 v[36:39], v1, s[4:7], s26 offen sc1
    s_mul_i32 s37, s14, 24
    s_add_u32 s37, s37, s12
    s_lshl_b32 s37, s37, 6
    s_add_u32 s37, s37, 117916672
    s_cmp_eq_u32 s36, 0
    s_cbranch_scc1 L_down_end
    s_mov_b32 s14, s35
    s_branch L_down_loop
L_down_end:
    s_waitcnt vmcnt(0)
    s_barrier
    s_cmp_eq_u32 s13, 0
    s_cbranch_scc0 Lsg_20
    s_mov_b64 exec, 1
    v_mov_b32 v10, 1
    buffer_store_dword v10, off, s[4:7], s37 sc1
    s_mov_b64 exec, -1
Lsg_20:
    s_cmp_lt_i32 s93, 0
    s_cbranch_scc0 L_att
    s_lshr_b32 s14, s100, 5
    s_load_dwordx2 s[16:17], s[0:1], 40
    s_load_dwordx2 s[20:21], s[0:1], 96
    v_and_b32 v8, 63, v0
    v_lshlrev_b32 v1, 4, v8
    v_lshrrev_b32 v9, 2, v8
    v_mul_u32_u24 v9, 1152, v9
    v_and_b32 v10, 3, v8
    v_lshl_add_u32 v2, v10, 4, v9
    s_lshl_b32 s28, s13, 15
    v_bfe_u32 v11, v8, 2, 2
    v_and_b32 v9, 1, v11
    v_lshlrev_b32 v9, 4, v9
    v_lshrrev_b32 v10, 5, v8
    v_lshl_add_u32 v9, v10, 2, v9
    v_lshrrev_b32 v10, 1, v11
    v_add_u32 v9, v9, v10
    v_lshlrev_b32 v9, 6, v9
    v_bfe_u32 v10, v8, 4, 1
    v_lshl_add_u32 v9, v10, 5, v9
    v_and_b32 v10, 1, v8
    v_lshl_add_u32 v9, v10, 4, v9
    v_bfe_u32 v10, v8, 1, 1
    v_lshl_add_u32 v9, v10, 3, v9
    v_add_u32 v3, s28, v9
    s_lshl_b32 s24, s13, 12
    s_add_u32 s24, s24, 131072
    v_add_u32 v5, s24, v1
    s_lshl_b32 s24, s13, 10
    s_add_u32 s24, s24, 131072
    v_add_u32 v6, s24, v1
    v_bfe_u32 v9, v8, 2, 2
    v_bfe_u32 v10, v8, 4, 1
    v_lshlrev_b32 v10, 2, v10
    v_lshl_add_u32 v9, v9, 3, v10
    v_and_b32 v10, 3, v8
    v_add_u32 v9, v9, v10
    v_mul_u32_u24 v9, 1152, v9
    v_lshrrev_b32 v10, 5, v8
    v_lshl_add_u32 v4, v10, 4, v9
    s_waitcnt lgkmcnt(0)
    s_mov_b32 s18, 4718592
    s_mov_b32 s19, 0x00020000
    s_mov_b32 s22, 2359296
    s_mov_b32 s23, 0x00020000
    s_mul_i32 s24, s13, 1179648
    s_lshl_b32 s25, s12, 6
    s_add_u32 s24, s24, s25
    s_mov_b32 s29, 0
    s_add_u32 m0, s28, 0
    s_add_u32 s25, s24, 0
    buffer_load_dwordx4 v2, s[16:19], s25 offen lds
    s_add_u32 m0, s28, 1024
    s_add_u32 s25, s24, 18432
    buffer_load_dwordx4 v2, s[16:19], s25 offen lds
    s_add_u32 m0, s28, 2048
    s_add_u32 s25, s24, 36864
    buffer_load_dwordx4 v2, s[16:19], s25 offen lds
    s_add_u32 m0, s28, 3072
    s_add_u32 s25, s24, 55296
    buffer_load_dwordx4 v2, s[16:19], s25 offen lds
    s_add_u32 m0, s28, 4096
    s_add_u32 s25, s24, 73728
    buffer_load_dwordx4 v2, s[16:19], s25 offen lds
    s_add_u32 m0, s28, 5120
    s_add_u32 s25, s24, 92160
    buffer_load_dwordx4 v2, s[16:19], s25 offen lds
    s_add_u32 m0, s28, 6144
    s_add_u32 s25, s24, 110592
    buffer_load_dwordx4 v2, s[16:19], s25 offen lds
    s_add_u32 m0, s28, 7168
    s_add_u32 s25, s24, 129024
    buffer_load_dwordx4 v2, s[16:19], s25 offen lds
    s_add_u32 m0, s28, 8192
    s_add_u32 s25, s24, 147456
    buffer_load_dwordx4 v2, s[16:19], s25 offen lds
    s_add_u32 m0, s28, 9216
    s_add_u32 s25, s24, 165888
    buffer_load_dwordx4 v2, s[16:19], s25 offen lds
    s_add_u32 m0, s28, 10240
    s_add_u32 s25, s24, 184320
    buffer_load_dwordx4 v2, s[16:19], s25 offen lds
    s_add_u32 m0, s28, 11264
    s_add_u32 s25, s24, 202752
    buffer_load_dwordx4 v2, s[16:19], s25 offen lds
    s_add_u32 m0, s28, 12288
    s_add_u32 s25, s24, 221184
    buffer_load_dwordx4 v2, s[16:19], s25 offen lds
    s_add_u32 m0, s28, 13312
    s_add_u32 s25, s24, 239616
    buffer_load_dwordx4 v2, s[16:19], s25 offen lds
    s_add_u32 m0, s28, 14336
    s_add_u32 s25, s24, 258048
    buffer_load_dwordx4 v2, s[16:19], s25 offen lds
    s_add_u32 m0, s28, 15360
    s_add_u32 s25, s24, 276480
    buffer_load_dwordx4 v2, s[16:19], s25 offen lds
    s_add_u32 m0, s28, 16384
    s_add_u32 s25, s24, 294912
    buffer_load_dwordx4 v2, s[16:19], s25 offen lds
    s_add_u32 m0, s28, 17408
    s_add_u32 s25, s24, 313344
    buffer_load_dwordx4 v2, s[16:19], s25 offen lds
    s_add_u32 m0, s28, 18432
    s_add_u32 s25, s24, 331776
    buffer_load_dwordx4 v2, s[16:19], s25 offen lds
    s_add_u32 m0, s28, 19456
    s_add_u32 s25, s24, 350208
    buffer_load_dwordx4 v2, s[16:19], s25 offen lds
    s_add_u32 m0, s28, 20480
    s_add_u32 s25, s24, 368640
    buffer_load_dwordx4 v2, s[16:19], s25 offen lds
    s_add_u32 m0, s28, 21504
    s_add_u32 s25, s24, 387072
    buffer_load_dwordx4 v2, s[16:19], s25 offen lds
    s_add_u32 m0, s28, 22528
    s_add_u32 s25, s24, 405504
    buffer_load_dwordx4 v2, s[16:19], s25 offen lds
    s_add_u32 m0, s28, 23552
    s_add_u32 s25, s24, 423936
    buffer_load_dwordx4 v2, s[16:19], s25 offen lds
    s_add_u32 m0, s28, 24576
    s_add_u32 s25, s24, 442368
    buffer_load_dwordx4 v2, s[16:19], s25 offen lds
    s_add_u32 m0, s28, 25600
    s_add_u32 s25, s24, 460800
    buffer_load_dwordx4 v2, s[16:19], s25 offen lds
    s_add_u32 m0, s28, 26624
    s_add_u32 s25, s24, 479232
    buffer_load_dwordx4 v2, s[16:19], s25 offen lds
    s_add_u32 m0, s28, 27648
    s_add_u32 s25, s24, 497664
    buffer_load_dwordx4 v2, s[16:19], s25 offen lds
    s_add_u32 m0, s28, 28672
    s_add_u32 s25, s24, 516096
    buffer_load_dwordx4 v2, s[16:19], s25 offen lds
    s_add_u32 m0, s28, 29696
    s_add_u32 s25, s24, 534528
    buffer_load_dwordx4 v2, s[16:19], s25 offen lds
    s_add_u32 m0, s28, 30720
    s_add_u32 s25, s24, 552960
    buffer_load_dwordx4 v2, s[16:19], s25 offen lds
    s_add_u32 m0, s28, 31744
    s_add_u32 s25, s24, 571392
    buffer_load_dwordx4 v2, s[16:19], s25 offen lds
    s_waitcnt vmcnt(28)
    ds_read_b64_tr_b16 a[0:1], v3 offset:0
    ds_read_b64_tr_b16 a[2:3], v3 offset:128
    ds_read_b64_tr_b16 a[4:5], v3 offset:512
    ds_read_b64_tr_b16 a[6:7], v3 offset:640
    ds_read_b64_tr_b16 a[8:9], v3 offset:2048
    ds_read_b64_tr_b16 a[10:11], v3 offset:2176
    ds_read_b64_tr_b16 a[12:13], v3 offset:2560
    ds_read_b64_tr_b16 a[14:15], v3 offset:2688
    s_waitcnt lgkmcnt(0)
    s_add_u32 m0, s28, 0
    s_add_u32 s25, s24, 589824
    buffer_load_dwordx4 v2, s[16:19], s25 offen lds
    s_add_u32 m0, s28, 1024
    s_add_u32 s25, s24, 608256
    buffer_load_dwordx4 v2, s[16:19], s25 offen lds
    s_add_u32 m0, s28, 2048
    s_add_u32 s25, s24, 626688
    buffer_load_dwordx4 v2, s[16:19], s25 offen lds
    s_add_u32 m0, s28, 3072
    s_add_u32 s25, s24, 645120
    buffer_load_dwordx4 v2, s[16:19], s25 offen lds
    s_waitcnt vmcnt(28)
    ds_read_b64_tr_b16 a[16:17], v3 offset:4096
    ds_read_b64_tr_b16 a[18:19], v3 offset:4224
    ds_read_b64_tr_b16 a[20:21], v3 offset:4608
    ds_read_b64_tr_b16 a[22:23], v3 offset:4736
    ds_read_b64_tr_b16 a[24:25], v3 offset:6144
    ds_read_b64_tr_b16 a[26:27], v3 offset:6272
    ds_read_b64_tr_b16 a[28:29], v3 offset:6656
    ds_read_b64_tr_b16 a[30:31], v3 offset:6784
    s_waitcnt lgkmcnt(0)
    s_add_u32 m0, s28, 4096
    s_add_u32 s25, s24, 663552
    buffer_load_dwordx4 v2, s[16:19], s25 offen lds
    s_add_u32 m0, s28, 5120
    s_add_u32 s25, s24, 681984
    buffer_load_dwordx4 v2, s[16:19], s25 offen lds
    s_add_u32 m0, s28, 6144
    s_add_u32 s25, s24, 700416
    buffer_load_dwordx4 v2, s[16:19], s25 offen lds
    s_add_u32 m0, s28, 7168
    s_add_u32 s25, s24, 718848
    buffer_load_dwordx4 v2, s[16:19], s25 offen lds
    s_waitcnt vmcnt(28)
    ds_read_b64_tr_b16 a[32:33], v3 offset:8192
    ds_read_b64_tr_b16 a[34:35], v3 offset:8320
    ds_read_b64_tr_b16 a[36:37], v3 offset:8704
    ds_read_b64_tr_b16 a[38:39], v3 offset:8832
    ds_read_b64_tr_b16 a[40:41], v3 offset:10240
    ds_read_b64_tr_b16 a[42:43], v3 offset:10368
    ds_read_b64_tr_b16 a[44:45], v3 offset:10752
    ds_read_b64_tr_b16 a[46:47], v3 offset:10880
    s_waitcnt lgkmcnt(0)
    s_add_u32 m0, s28, 8192
    s_add_u32 s25, s24, 737280
    buffer_load_dwordx4 v2, s[16:19], s25 offen lds
    s_add_u32 m0, s28, 9216
    s_add_u32 s25, s24, 755712
    buffer_load_dwordx4 v2, s[16:19], s25 offen lds
    s_add_u32 m0, s28, 10240
    s_add_u32 s25, s24, 774144
    buffer_load_dwordx4 v2, s[16:19], s25 offen lds
    s_add_u32 m0, s28, 11264
    s_add_u32 s25, s24, 792576
    buffer_load_dwordx4 v2, s[16:19], s25 offen lds
    s_waitcnt vmcnt(28)
    ds_read_b64_tr_b16 a[48:49], v3 offset:12288
    ds_read_b64_tr_b16 a[50:51], v3 offset:12416
    ds_read_b64_tr_b16 a[52:53], v3 offset:12800
    ds_read_b64_tr_b16 a[54:55], v3 offset:12928
    ds_read_b64_tr_b16 a[56:57], v3 offset:14336
    ds_read_b64_tr_b16 a[58:59], v3 offset:14464
    ds_read_b64_tr_b16 a[60:61], v3 offset:14848
    ds_read_b64_tr_b16 a[62:63], v3 offset:14976
    s_waitcnt lgkmcnt(0)
    s_add_u32 m0, s28, 12288
    s_add_u32 s25, s24, 811008
    buffer_load_dwordx4 v2, s[16:19], s25 offen lds
    s_add_u32 m0, s28, 13312
    s_add_u32 s25, s24, 829440
    buffer_load_dwordx4 v2, s[16:19], s25 offen lds
    s_add_u32 m0, s28, 14336
    s_add_u32 s25, s24, 847872
    buffer_load_dwordx4 v2, s[16:19], s25 offen lds
    s_add_u32 m0, s28, 15360
    s_add_u32 s25, s24, 866304
    buffer_load_dwordx4 v2, s[16:19], s25 offen lds
    s_waitcnt vmcnt(28)
    ds_read_b64_tr_b16 a[64:65], v3 offset:16384
    ds_read_b64_tr_b16 a[66:67], v3 offset:16512
    ds_read_b64_tr_b16 a[68:69], v3 offset:16896
    ds_read_b64_tr_b16 a[70:71], v3 offset:17024
    ds_read_b64_tr_b16 a[72:73], v3 offset:18432
    ds_read_b64_tr_b16 a[74:75], v3 offset:18560
    ds_read_b64_tr_b16 a[76:77], v3 offset:18944
    ds_read_b64_tr_b16 a[78:79], v3 offset:19072
    s_waitcnt lgkmcnt(0)
    s_add_u32 m0, s28, 16384
    s_add_u32 s25, s24, 884736
    buffer_load_dwordx4 v2, s[16:19], s25 offen lds
    s_add_u32 m0, s28, 17408
    s_add_u32 s25, s24, 903168
    buffer_load_dwordx4 v2, s[16:19], s25 offen lds
    s_add_u32 m0, s28, 18432
    s_add_u32 s25, s24, 921600
    buffer_load_dwordx4 v2, s[16:19], s25 offen lds
    s_add_u32 m0, s28, 19456
    s_add_u32 s25, s24, 940032
    buffer_load_dwordx4 v2, s[16:19], s25 offen lds
    s_waitcnt vmcnt(28)
    ds_read_b64_tr_b16 a[80:81], v3 offset:20480
    ds_read_b64_tr_b16 a[82:83], v3 offset:20608
    ds_read_b64_tr_b16 a[84:85], v3 offset:20992
    ds_read_b64_tr_b16 a[86:87], v3 offset:21120
    ds_read_b64_tr_b16 a[88:89], v3 offset:22528
    ds_read_b64_tr_b16 a[90:91], v3 offset:22656
    ds_read_b64_tr_b16 a[92:93], v3 offset:23040
    ds_read_b64_tr_b16 a[94:95], v3 offset:23168
    s_waitcnt lgkmcnt(0)
    s_add_u32 m0, s28, 20480
    s_add_u32 s25, s24, 958464
    buffer_load_dwordx4 v2, s[16:19], s25 offen lds
    s_add_u32 m0, s28, 21504
    s_add_u32 s25, s24, 976896
    buffer_load_dwordx4 v2, s[16:19], s25 offen lds
    s_add_u32 m0, s28, 22528
    s_add_u32 s25, s24, 995328
    buffer_load_dwordx4 v2, s[16:19], s25 offen lds
    s_add_u32 m0, s28, 23552
    s_add_u32 s25, s24, 1013760
    buffer_load_dwordx4 v2, s[16:19], s25 offen lds
    s_waitcnt vmcnt(28)
    ds_read_b64_tr_b16 a[96:97], v3 offset:24576
    ds_read_b64_tr_b16 a[98:99], v3 offset:24704
    ds_read_b64_tr_b16 a[100:101], v3 offset:25088
    ds_read_b64_tr_b16 a[102:103], v3 offset:25216
    ds_read_b64_tr_b16 a[104:105], v3 offset:26624
    ds_read_b64_tr_b16 a[106:107], v3 offset:26752
    ds_read_b64_tr_b16 a[108:109], v3 offset:27136
    ds_read_b64_tr_b16 a[110:111], v3 offset:27264
    s_waitcnt lgkmcnt(0)
    s_add_u32 m0, s28, 24576
    s_add_u32 s25, s24, 1032192
    buffer_load_dwordx4 v2, s[16:19], s25 offen lds
    s_add_u32 m0, s28, 25600
    s_add_u32 s25, s24, 1050624
    buffer_load_dwordx4 v2, s[16:19], s25 offen lds
    s_add_u32 m0, s28, 26624
    s_add_u32 s25, s24, 1069056
    buffer_load_dwordx4 v2, s[16:19], s25 offen lds
    s_add_u32 m0, s28, 27648
    s_add_u32 s25, s24, 1087488
    buffer_load_dwordx4 v2, s[16:19], s25 offen lds
    s_waitcnt vmcnt(28)
    ds_read_b64_tr_b16 a[112:113], v3 offset:28672
    ds_read_b64_tr_b16 a[114:115], v3 offset:28800
    ds_read_b64_tr_b16 a[116:117], v3 offset:29184
    ds_read_b64_tr_b16 a[118:119], v3 offset:29312
    ds_read_b64_tr_b16 a[120:121], v3 offset:30720
    ds_read_b64_tr_b16 a[122:123], v3 offset:30848
    ds_read_b64_tr_b16 a[124:125], v3 offset:31232
    ds_read_b64_tr_b16 a[126:127], v3 offset:31360
    s_waitcnt lgkmcnt(0)
    s_add_u32 m0, s28, 28672
    s_add_u32 s25, s24, 1105920
    buffer_load_dwordx4 v2, s[16:19], s25 offen lds
    s_add_u32 m0, s28, 29696
    s_add_u32 s25, s24, 1124352
    buffer_load_dwordx4 v2, s[16:19], s25 offen lds
    s_add_u32 m0, s28, 30720
    s_add_u32 s25, s24, 1142784
    buffer_load_dwordx4 v2, s[16:19], s25 offen lds
    s_add_u32 m0, s28, 31744
    s_add_u32 s25, s24, 1161216
    buffer_load_dwordx4 v2, s[16:19], s25 offen lds
    s_waitcnt vmcnt(28)
    ds_read_b64_tr_b16 a[128:129], v3 offset:0
    ds_read_b64_tr_b16 a[130:131], v3 offset:128
    ds_read_b64_tr_b16 a[132:133], v3 offset:512
    ds_read_b64_tr_b16 a[134:135], v3 offset:640
    ds_read_b64_tr_b16 a[136:137], v3 offset:2048
    ds_read_b64_tr_b16 a[138:139], v3 offset:2176
    ds_read_b64_tr_b16 a[140:141], v3 offset:2560
    ds_read_b64_tr_b16 a[142:143], v3 offset:2688
    s_waitcnt lgkmcnt(0)
    s_waitcnt vmcnt(24)
    ds_read_b64_tr_b16 a[144:145], v3 offset:4096
    ds_read_b64_tr_b16 a[146:147], v3 offset:4224
    ds_read_b64_tr_b16 a[148:149], v3 offset:4608
    ds_read_b64_tr_b16 a[150:151], v3 offset:4736
    ds_read_b64_tr_b16 a[152:153], v3 offset:6144
    ds_read_b64_tr_b16 a[154:155], v3 offset:6272
    ds_read_b64_tr_b16 a[156:157], v3 offset:6656
    ds_read_b64_tr_b16 a[158:159], v3 offset:6784
    s_waitcnt lgkmcnt(0)
    s_waitcnt vmcnt(20)
    ds_read_b64_tr_b16 a[160:161], v3 offset:8192
    ds_read_b64_tr_b16 a[162:163], v3 offset:8320
    ds_read_b64_tr_b16 a[164:165], v3 offset:8704
    ds_read_b64_tr_b16 a[166:167], v3 offset:8832
    ds_read_b64_tr_b16 a[168:169], v3 offset:10240
    ds_read_b64_tr_b16 a[170:171], v3 offset:10368
    ds_read_b64_tr_b16 a[172:173], v3 offset:10752
    ds_read_b64_tr_b16 a[174:175], v3 offset:10880
    s_waitcnt lgkmcnt(0)
    s_waitcnt vmcnt(16)
    ds_read_b64_tr_b16 a[176:177], v3 offset:12288
    ds_read_b64_tr_b16 a[178:179], v3 offset:12416
    ds_read_b64_tr_b16 a[180:181], v3 offset:12800
    ds_read_b64_tr_b16 a[182:183], v3 offset:12928
    ds_read_b64_tr_b16 a[184:185], v3 offset:14336
    ds_read_b64_tr_b16 a[186:187], v3 offset:14464
    ds_read_b64_tr_b16 a[188:189], v3 offset:14848
    ds_read_b64_tr_b16 a[190:191], v3 offset:14976
    s_waitcnt lgkmcnt(0)
    s_waitcnt vmcnt(12)
    ds_read_b64_tr_b16 a[192:193], v3 offset:16384
    ds_read_b64_tr_b16 a[194:195], v3 offset:16512
    ds_read_b64_tr_b16 a[196:197], v3 offset:16896
    ds_read_b64_tr_b16 a[198:199], v3 offset:17024
    ds_read_b64_tr_b16 a[200:201], v3 offset:18432
    ds_read_b64_tr_b16 a[202:203], v3 offset:18560
    ds_read_b64_tr_b16 a[204:205], v3 offset:18944
    ds_read_b64_tr_b16 a[206:207], v3 offset:19072
    s_waitcnt lgkmcnt(0)
    s_waitcnt vmcnt(8)
    ds_read_b64_tr_b16 a[208:209], v3 offset:20480
    ds_read_b64_tr_b16 a[210:211], v3 offset:20608
    ds_read_b64_tr_b16 a[212:213], v3 offset:20992
    ds_read_b64_tr_b16 a[214:215], v3 offset:21120
    ds_read_b64_tr_b16 a[216:217], v3 offset:22528
    ds_read_b64_tr_b16 a[218:219], v3 offset:22656
    ds_read_b64_tr_b16 a[220:221], v3 offset:23040
    ds_read_b64_tr_b16 a[222:223], v3 offset:23168
    s_waitcnt lgkmcnt(0)
    s_waitcnt vmcnt(4)
    ds_read_b64_tr_b16 a[224:225], v3 offset:24576
    ds_read_b64_tr_b16 a[226:227], v3 offset:24704
    ds_read_b64_tr_b16 a[228:229], v3 offset:25088
    ds_read_b64_tr_b16 a[230:231], v3 offset:25216
    ds_read_b64_tr_b16 a[232:233], v3 offset:26624
    ds_read_b64_tr_b16 a[234:235], v3 offset:26752
    ds_read_b64_tr_b16 a[236:237], v3 offset:27136
    ds_read_b64_tr_b16 a[238:239], v3 offset:27264
    s_waitcnt lgkmcnt(0)
    s_waitcnt vmcnt(0)
    ds_read_b64_tr_b16 a[240:241], v3 offset:28672
    ds_read_b64_tr_b16 a[242:243], v3 offset:28800
    ds_read_b64_tr_b16 a[244:245], v3 offset:29184
    ds_read_b64_tr_b16 a[246:247], v3 offset:29312
    ds_read_b64_tr_b16 a[248:249], v3 offset:30720
    ds_read_b64_tr_b16 a[250:251], v3 offset:30848
    ds_read_b64_tr_b16 a[252:253], v3 offset:31232
    ds_read_b64_tr_b16 a[254:255], v3 offset:31360
    s_waitcnt lgkmcnt(0)
    s_mov_b32 s36, 0
    s_mov_b32 s37, 0xf0000000
L_out_loop:
    s_cmp_eq_u32 s36, 1
    s_cbranch_scc1 L_out_go
    s_mov_b32 s97, 0
L_out_w:
    s_mul_i32 s30, s14, 24
    s_add_u32 s30, s30, s12
    s_lshl_b32 s30, s30, 6
    s_add_u32 s30, s30, 117916672
    s_lshl_b32 s31, s14, 9
    s_add_u32 s31, s31, 117883904
    v_and_b32 v12, 0x70, v1
    v_lshlrev_b32 v12, 2, v12
    buffer_load_dword v10, v12, s[4:7], s31 offen sc1
    buffer_load_dword v11, off, s[4:7], s30 sc1
    s_add_u32 s97, s97, 1
    s_cmp_gt_u32 s97, 0x20000
    s_cbranch_scc1 L_fail
    s_waitcnt vmcnt(0)
    v_and_b32 v10, v10, v11
    v_cmp_ne_u32 vcc, 1, v10
    s_cbranch_vccz L_out_ok
    s_sleep 4
    s_branch L_out_w
L_out_ok:
    s_lshl_b32 s34, s14, 2
    s_add_u32 s34, s34, s13
    s_mul_i32 s34, s34, 65536
    s_add_u32 s34, s34, 75497472
    buffer_load_dwordx4 v[96:99], v1, s[4:7], s34 offen offset:0 sc1
    buffer_load_dwordx4 v[100:103], v1, s[4:7], s34 offen offset:1024 sc1
    buffer_load_dwordx4 v[104:107], v1, s[4:7], s34 offen offset:2048 sc1
    buffer_load_dwordx4 v[108:111], v1, s[4:7], s34 offen offset:3072 sc1
    s_add_u32 s34, s34, 4096
    buffer_load_dwordx4 v[112:115], v1, s[4:7], s34 offen offset:0 sc1
    buffer_load_dwordx4 v[116:119], v1, s[4:7], s34 offen offset:1024 sc1
    buffer_load_dwordx4 v[120:123], v1, s[4:7], s34 offen offset:2048 sc1
    buffer_load_dwordx4 v[124:127], v1, s[4:7], s34 offen offset:3072 sc1
    s_add_u32 s34, s34, 4096
    buffer_load_dwordx4 v[128:131], v1, s[4:7], s34 offen offset:0 sc1
    buffer_load_dwordx4 v[132:135], v1, s[4:7], s34 offen offset:1024 sc1
    buffer_load_dwordx4 v[136:139], v1, s[4:7], s34 offen offset:2048 sc1
    buffer_load_dwordx4 v[140:143], v1, s[4:7], s34 offen offset:3072 sc1
    s_add_u32 s34, s34, 4096
    buffer_load_dwordx4 v[144:147], v1, s[4:7], s34 offen offset:0 sc1
    buffer_load_dwordx4 v[148:151], v1, s[4:7], s34 offen offset:1024 sc1
    buffer_load_dwordx4 v[152:155], v1, s[4:7], s34 offen offset:2048 sc1
    buffer_load_dwordx4 v[156:159], v1, s[4:7], s34 offen offset:3072 sc1
    s_add_u32 s34, s34, 4096
    buffer_load_dwordx4 v[160:163], v1, s[4:7], s34 offen offset:0 sc1
    buffer_load_dwordx4 v[164:167], v1, s[4:7], s34 offen offset:1024 sc1
    buffer_load_dwordx4 v[168:171], v1, s[4:7], s34 offen offset:2048 sc1
    buffer_load_dwordx4 v[172:175], v1, s[4:7], s34 offen offset:3072 sc1
    s_add_u32 s34, s34, 4096
    buffer_load_dwordx4 v[176:179], v1, s[4:7], s34 offen offset:0 sc1
    buffer_load_dwordx4 v[180:183], v1, s[4:7], s34 offen offset:1024 sc1
    buffer_load_dwordx4 v[184:187], v1, s[4:7], s34 offen offset:2048 sc1
    buffer_load_dwordx4 v[188:191], v1, s[4:7], s34 offen offset:3072 sc1
    s_add_u32 s34, s34, 4096
    buffer_load_dwordx4 v[192:195], v1, s[4:7], s34 offen offset:0 sc1
    buffer_load_dwordx4 v[196:199], v1, s[4:7], s34 offen offset:1024 sc1
    buffer_load_dwordx4 v[200:203], v1, s[4:7], s34 offen offset:2048 sc1
    buffer_load_dwordx4 v[204:207], v1, s[4:7], s34 offen offset:3072 sc1
    s_add_u32 s34, s34, 4096
    buffer_load_dwordx4 v[208:211], v1, s[4:7], s34 offen offset:0 sc1
    buffer_load_dwordx4 v[212:215], v1, s[4:7], s34 offen offset:1024 sc1
    buffer_load_dwordx4 v[216:219], v1, s[4:7], s34 offen offset:2048 sc1
    buffer_load_dwordx4 v[220:223], v1, s[4:7], s34 offen offset:3072 sc1
    s_add_u32 s34, s34, 4096
    buffer_load_dwordx4 v[224:227], v1, s[4:7], s34 offen offset:0 sc1
    buffer_load_dwordx4 v[228:231], v1, s[4:7], s34 offen offset:1024 sc1
    buffer_load_dwordx4 v[232:235], v1, s[4:7], s34 offen offset:2048 sc1
    buffer_load_dwordx4 v[236:239], v1, s[4:7], s34 offen offset:3072 sc1
    s_add_u32 s34, s34, 4096
    buffer_load_dwordx4 v[240:243], v1, s[4:7], s34 offen offset:0 sc1
    buffer_load_dwordx4 v[244:247], v1, s[4:7], s34 offen offset:1024 sc1
    buffer_load_dwordx4 v[248:251], v1, s[4:7], s34 offen offset:2048 sc1
    buffer_load_dwordx4 v[252:255], v1, s[4:7], s34 offen offset:3072 sc1
L_out_go:
    s_add_u32 s35, s14, 6
    s_cmp_lt_u32 s35, 64
    s_cselect_b32 s36, 1, 0
    s_cselect_b32 s38, s35, s14
    s_mul_i32 s30, s38, 24
    s_add_u32 s30, s30, s12
    s_lshl_b32 s30, s30, 6
    s_add_u32 s30, s30, 117916672
    s_lshl_b32 s31, s38, 9
    s_add_u32 s31, s31, 117883904
    v_and_b32 v12, 0x70, v1
    v_lshlrev_b32 v12, 2, v12
    buffer_load_dword v10, v12, s[4:7], s31 offen sc1
    buffer_load_dword v11, off, s[4:7], s30 sc1
    s_mul_i32 s26, s14, 18
    s_add_u32 s26, s26, s12
    s_lshl_b32 s26, s26, 2
    s_add_u32 s26, s26, s13
    s_lshl_b32 s26, s26, 10
    s_add_u32 s26, s26, 122683392
    buffer_load_dwordx4 v[32:35], v1, s[4:7], s26 offen sc1
    s_waitcnt vmcnt(39)
    v_mfma_f32_32x32x16_bf16 v[16:31], a[0:3], v[96:99], 0
    s_add_u32 s34, s34, 4096
    buffer_load_dwordx4 v[96:99], v1, s[4:7], s34 offen offset:0 sc1
    v_mfma_f32_32x32x16_bf16 v[16:31], a[4:7], v[100:103], v[16:31]
    buffer_load_dwordx4 v[100:103], v1, s[4:7], s34 offen offset:1024 sc1
    s_waitcnt vmcnt(39)
    v_mfma_f32_32x32x16_bf16 v[16:31], a[8:11], v[104:107], v[16:31]
    buffer_load_dwordx4 v[104:107], v1, s[4:7], s34 offen offset:2048 sc1
    v_mfma_f32_32x32x16_bf16 v[16:31], a[12:15], v[108:111], v[16:31]
    buffer_load_dwordx4 v[108:111], v1, s[4:7], s34 offen offset:3072 sc1
    s_waitcnt vmcnt(39)
    v_mfma_f32_32x32x16_bf16 v[16:31], a[16:19], v[112:115], v[16:31]
    s_add_u32 s34, s34, 4096
    buffer_load_dwordx4 v[112:115], v1, s[4:7], s34 offen offset:0 sc1
    v_mfma_f32_32x32x16_bf16 v[16:31], a[20:23], v[116:119], v[16:31]
    buffer_load_dwordx4 v[116:119], v1, s[4:7], s34 offen offset:1024 sc1
    s_waitcnt vmcnt(39)
    v_mfma_f32_32x32x16_bf16 v[16:31], a[24:27], v[120:123], v[16:31]
    buffer_load_dwordx4 v[120:123], v1, s[4:7], s34 offen offset:2048 sc1
    v_mfma_f32_32x32x16_bf16 v[16:31], a[28:31], v[124:127], v[16:31]
    buffer_load_dwordx4 v[124:127], v1, s[4:7], s34 offen offset:3072 sc1
    s_waitcnt vmcnt(39)
    v_mfma_f32_32x32x16_bf16 v[16:31], a[32:35], v[128:131], v[16:31]
    s_add_u32 s34, s34, 4096
    buffer_load_dwordx4 v[128:131], v1, s[4:7], s34 offen offset:0 sc1
    v_mfma_f32_32x32x16_bf16 v[16:31], a[36:39], v[132:135], v[16:31]
    buffer_load_dwordx4 v[132:135], v1, s[4:7], s34 offen offset:1024 sc1
    s_waitcnt vmcnt(39)
    v_mfma_f32_32x32x16_bf16 v[16:31], a[40:43], v[136:139], v[16:31]
    buffer_load_dwordx4 v[136:139], v1, s[4:7], s34 offen offset:2048 sc1
    v_mfma_f32_32x32x16_bf16 v[16:31], a[44:47], v[140:143], v[16:31]
    buffer_load_dwordx4 v[140:143], v1, s[4:7], s34 offen offset:3072 sc1
    s_waitcnt vmcnt(39)
    v_mfma_f32_32x32x16_bf16 v[16:31], a[48:51], v[144:147], v[16:31]
    s_add_u32 s34, s34, 4096
    buffer_load_dwordx4 v[144:147], v1, s[4:7], s34 offen offset:0 sc1
    v_mfma_f32_32x32x16_bf16 v[16:31], a[52:55], v[148:151], v[16:31]
    buffer_load_dwordx4 v[148:151], v1, s[4:7], s34 offen offset:1024 sc1
    s_waitcnt vmcnt(39)
    v_mfma_f32_32x32x16_bf16 v[16:31], a[56:59], v[152:155], v[16:31]
    buffer_load_dwordx4 v[152:155], v1, s[4:7], s34 offen offset:2048 sc1
    v_mfma_f32_32x32x16_bf16 v[16:31], a[60:63], v[156:159], v[16:31]
    buffer_load_dwordx4 v[156:159], v1, s[4:7], s34 offen offset:3072 sc1
    s_waitcnt vmcnt(39)
    v_mfma_f32_32x32x16_bf16 v[16:31], a[64:67], v[160:163], v[16:31]
    s_add_u32 s34, s34, 4096
    buffer_load_dwordx4 v[160:163], v1, s[4:7], s34 offen offset:0 sc1
    v_mfma_f32_32x32x16_bf16 v[16:31], a[68:71], v[164:167], v[16:31]
    buffer_load_dwordx4 v[164:167], v1, s[4:7], s34 offen offset:1024 sc1
    s_waitcnt vmcnt(39)
    v_mfma_f32_32x32x16_bf16 v[16:31], a[72:75], v[168:171], v[16:31]
    buffer_load_dwordx4 v[168:171], v1, s[4:7], s34 offen offset:2048 sc1
    v_mfma_f32_32x32x16_bf16 v[16:31], a[76:79], v[172:175], v[16:31]
    buffer_load_dwordx4 v[172:175], v1, s[4:7], s34 offen offset:3072 sc1
    s_waitcnt vmcnt(39)
    v_mfma_f32_32x32x16_bf16 v[16:31], a[80:83], v[176:179], v[16:31]
    s_add_u32 s34, s34, 4096
    buffer_load_dwordx4 v[176:179], v1, s[4:7], s34 offen offset:0 sc1
    v_mfma_f32_32x32x16_bf16 v[16:31], a[84:87], v[180:183], v[16:31]
    buffer_load_dwordx4 v[180:183], v1, s[4:7], s34 offen offset:1024 sc1
    s_waitcnt vmcnt(39)
    v_mfma_f32_32x32x16_bf16 v[16:31], a[88:91], v[184:187], v[16:31]
    buffer_load_dwordx4 v[184:187], v1, s[4:7], s34 offen offset:2048 sc1
    v_mfma_f32_32x32x16_bf16 v[16:31], a[92:95], v[188:191], v[16:31]
    buffer_load_dwordx4 v[188:191], v1, s[4:7], s34 offen offset:3072 sc1
    s_waitcnt vmcnt(39)
    v_mfma_f32_32x32x16_bf16 v[16:31], a[96:99], v[192:195], v[16:31]
    v_mfma_f32_32x32x16_bf16 v[16:31], a[100:103], v[196:199], v[16:31]
    s_waitcnt vmcnt(37)
    v_mfma_f32_32x32x16_bf16 v[16:31], a[104:107], v[200:203], v[16:31]
    v_mfma_f32_32x32x16_bf16 v[16:31], a[108:111], v[204:207], v[16:31]
    s_waitcnt vmcnt(35)
    v_mfma_f32_32x32x16_bf16 v[16:31], a[112:115], v[208:211], v[16:31]
    v_mfma_f32_32x32x16_bf16 v[16:31], a[116:119], v[212:215], v[16:31]
    s_waitcnt vmcnt(33)
    v_mfma_f32_32x32x16_bf16 v[16:31], a[120:123], v[216:219], v[16:31]
    v_mfma_f32_32x32x16_bf16 v[16:31], a[124:127], v[220:223], v[16:31]
    s_waitcnt vmcnt(31)
    v_mfma_f32_32x32x16_bf16 v[16:31], a[128:131], v[224:227], v[16:31]
    v_mfma_f32_32x32x16_bf16 v[16:31], a[132:135], v[228:231], v[16:31]
    s_waitcnt vmcnt(29)
    v_mfma_f32_32x32x16_bf16 v[16:31], a[136:139], v[232:235], v[16:31]
    v_mfma_f32_32x32x16_bf16 v[16:31], a[140:143], v[236:239], v[16:31]
    s_waitcnt vmcnt(27)
    v_mfma_f32_32x32x16_bf16 v[16:31], a[144:147], v[240:243], v[16:31]
    v_mfma_f32_32x32x16_bf16 v[16:31], a[148:151], v[244:247], v[16:31]
    s_waitcnt vmcnt(25)
    v_mfma_f32_32x32x16_bf16 v[16:31], a[152:155], v[248:251], v[16:31]
    v_mfma_f32_32x32x16_bf16 v[16:31], a[156:159], v[252:255], v[16:31]
    s_waitcnt vmcnt(22)
    v_mfma_f32_32x32x16_bf16 v[16:31], a[160:163], v[96:99], v[16:31]
    v_mfma_f32_32x32x16_bf16 v[16:31], a[164:167], v[100:103], v[16:31]
    s_waitcnt vmcnt(20)
    v_mfma_f32_32x32x16_bf16 v[16:31], a[168:171], v[104:107], v[16:31]
    v_mfma_f32_32x32x16_bf16 v[16:31], a[172:175], v[108:111], v[16:31]
    s_waitcnt vmcnt(18)
    v_mfma_f32_32x32x16_bf16 v[16:31], a[176:179], v[112:115], v[16:31]
    v_mfma_f32_32x32x16_bf16 v[16:31], a[180:183], v[116:119], v[16:31]
    s_waitcnt vmcnt(16)
    v_mfma_f32_32x32x16_bf16 v[16:31], a[184:187], v[120:123], v[16:31]
    v_mfma_f32_32x32x16_bf16 v[16:31], a[188:191], v[124:127], v[16:31]
    s_waitcnt vmcnt(14)
    v_mfma_f32_32x32x16_bf16 v[16:31], a[192:195], v[128:131], v[16:31]
    v_mfma_f32_32x32x16_bf16 v[16:31], a[196:199], v[132:135], v[16:31]
    s_waitcnt vmcnt(12)
    v_mfma_f32_32x32x16_bf16 v[16:31], a[200:203], v[136:139], v[16:31]
    v_mfma_f32_32x32x16_bf16 v[16:31], a[204:207], v[140:143], v[16:31]
    s_waitcnt vmcnt(10)
    v_mfma_f32_32x32x16_bf16 v[16:31], a[208:211], v[144:147], v[16:31]
    v_mfma_f32_32x32x16_bf16 v[16:31], a[212:215], v[148:151], v[16:31]
    s_waitcnt vmcnt(8)
    v_mfma_f32_32x32x16_bf16 v[16:31], a[216:219], v[152:155], v[16:31]
    v_mfma_f32_32x32x16_bf16 v[16:31], a[220:223], v[156:159], v[16:31]
    s_waitcnt vmcnt(6)
    v_mfma_f32_32x32x16_bf16 v[16:31], a[224:227], v[160:163], v[16:31]
    v_mfma_f32_32x32x16_bf16 v[16:31], a[228:231], v[164:167], v[16:31]
    s_waitcnt vmcnt(4)
    v_mfma_f32_32x32x16_bf16 v[16:31], a[232:235], v[168:171], v[16:31]
    v_mfma_f32_32x32x16_bf16 v[16:31], a[236:239], v[172:175], v[16:31]
    s_waitcnt vmcnt(2)
    v_mfma_f32_32x32x16_bf16 v[16:31], a[240:243], v[176:179], v[16:31]
    v_mfma_f32_32x32x16_bf16 v[16:31], a[244:247], v[180:183], v[16:31]
    s_waitcnt vmcnt(0)
    v_mfma_f32_32x32x16_bf16 v[16:31], a[248:251], v[184:187], v[16:31]
    v_mfma_f32_32x32x16_bf16 v[16:31], a[252:255], v[188:191], v[16:31]
    s_cmp_eq_u32 s36, 0
    s_cbranch_scc1 L_out_fin
    s_mov_b32 s36, 2
    v_and_b32 v10, v10, v11
    v_cmp_ne_u32 vcc, 1, v10
    s_cbranch_vccnz L_out_fin
    s_mov_b32 s36, 1
    s_lshl_b32 s34, s35, 2
    s_add_u32 s34, s34, s13
    s_mul_i32 s34, s34, 65536
    s_add_u32 s34, s34, 75497472
    buffer_load_dwordx4 v[96:99], v1, s[4:7], s34 offen offset:0 sc1
    buffer_load_dwordx4 v[100:103], v1, s[4:7], s34 offen offset:1024 sc1
    buffer_load_dwordx4 v[104:107], v1, s[4:7], s34 offen offset:2048 sc1
    buffer_load_dwordx4 v[108:111], v1, s[4:7], s34 offen offset:3072 sc1
    s_add_u32 s34, s34, 4096
    buffer_load_dwordx4 v[112:115], v1, s[4:7], s34 offen offset:0 sc1
    buffer_load_dwordx4 v[116:119], v1, s[4:7], s34 offen offset:1024 sc1
    buffer_load_dwordx4 v[120:123], v1, s[4:7], s34 offen offset:2048 sc1
    buffer_load_dwordx4 v[124:127], v1, s[4:7], s34 offen offset:3072 sc1
    s_add_u32 s34, s34, 4096
    buffer_load_dwordx4 v[128:131], v1, s[4:7], s34 offen offset:0 sc1
    buffer_load_dwordx4 v[132:135], v1, s[4:7], s34 offen offset:1024 sc1
    buffer_load_dwordx4 v[136:139], v1, s[4:7], s34 offen offset:2048 sc1
    buffer_load_dwordx4 v[140:143], v1, s[4:7], s34 offen offset:3072 sc1
    s_add_u32 s34, s34, 4096
    buffer_load_dwordx4 v[144:147], v1, s[4:7], s34 offen offset:0 sc1
    buffer_load_dwordx4 v[148:151], v1, s[4:7], s34 offen offset:1024 sc1
    buffer_load_dwordx4 v[152:155], v1, s[4:7], s34 offen offset:2048 sc1
    buffer_load_dwordx4 v[156:159], v1, s[4:7], s34 offen offset:3072 sc1
    s_add_u32 s34, s34, 4096
    buffer_load_dwordx4 v[160:163], v1, s[4:7], s34 offen offset:0 sc1
    buffer_load_dwordx4 v[164:167], v1, s[4:7], s34 offen offset:1024 sc1
    buffer_load_dwordx4 v[168:171], v1, s[4:7], s34 offen offset:2048 sc1
    buffer_load_dwordx4 v[172:175], v1, s[4:7], s34 offen offset:3072 sc1
    s_add_u32 s34, s34, 4096
    buffer_load_dwordx4 v[176:179], v1, s[4:7], s34 offen offset:0 sc1
    buffer_load_dwordx4 v[180:183], v1, s[4:7], s34 offen offset:1024 sc1
    buffer_load_dwordx4 v[184:187], v1, s[4:7], s34 offen offset:2048 sc1
    buffer_load_dwordx4 v[188:191], v1, s[4:7], s34 offen offset:3072 sc1
    s_add_u32 s34, s34, 4096
    buffer_load_dwordx4 v[192:195], v1, s[4:7], s34 offen offset:0 sc1
    buffer_load_dwordx4 v[196:199], v1, s[4:7], s34 offen offset:1024 sc1
    buffer_load_dwordx4 v[200:203], v1, s[4:7], s34 offen offset:2048 sc1
    buffer_load_dwordx4 v[204:207], v1, s[4:7], s34 offen offset:3072 sc1
    s_add_u32 s34, s34, 4096
    buffer_load_dwordx4 v[208:211], v1, s[4:7], s34 offen offset:0 sc1
    buffer_load_dwordx4 v[212:215], v1, s[4:7], s34 offen offset:1024 sc1
    buffer_load_dwordx4 v[216:219], v1, s[4:7], s34 offen offset:2048 sc1
    buffer_load_dwordx4 v[220:223], v1, s[4:7], s34 offen offset:3072 sc1
    s_add_u32 s34, s34, 4096
    buffer_load_dwordx4 v[224:227], v1, s[4:7], s34 offen offset:0 sc1
    buffer_load_dwordx4 v[228:231], v1, s[4:7], s34 offen offset:1024 sc1
    buffer_load_dwordx4 v[232:235], v1, s[4:7], s34 offen offset:2048 sc1
    buffer_load_dwordx4 v[236:239], v1, s[4:7], s34 offen offset:3072 sc1
    s_add_u32 s34, s34, 4096
    buffer_load_dwordx4 v[240:243], v1, s[4:7], s34 offen offset:0 sc1
    buffer_load_dwordx4 v[244:247], v1, s[4:7], s34 offen offset:1024 sc1
    buffer_load_dwordx4 v[248:251], v1, s[4:7], s34 offen offset:2048 sc1
    buffer_load_dwordx4 v[252:255], v1, s[4:7], s34 offen offset:3072 sc1
L_out_fin:
    v_add_u32 v8, s29, v5
    v_add_u32 v9, s29, v6
    s_xor_b32 s29, s29, 16384
    ds_write_b128 v8, v[16:19] offset:0
    ds_write_b128 v8, v[20:23] offset:1024
    ds_write_b128 v8, v[24:27] offset:2048
    ds_write_b128 v8, v[28:31] offset:3072
    s_waitcnt lgkmcnt(0)
    s_barrier
    ds_read_b128 v[36:39], v9 offset:0
    ds_read_b128 v[40:43], v9 offset:4096
    ds_read_b128 v[44:47], v9 offset:8192
    ds_read_b128 v[48:51], v9 offset:12288
    s_mul_i32 s24, s14, 36864
    s_lshl_b32 s25, s12, 6
    s_add_u32 s24, s24, s25
    s_lshr_b32 s25, s13, 1
    s_lshl_b32 s25, s25, 5
    s_add_u32 s24, s24, s25
    s_and_b32 s25, s13, 1
    s_lshl_b32 s25, s25, 3
    s_add_u32 s24, s24, s25
    s_waitcnt lgkmcnt(0)
    v_add_f32 v36, v36, v40
    v_add_f32 v44, v44, v48
    v_add_f32 v37, v37, v41
    v_add_f32 v45, v45, v49
    v_add_f32 v38, v38, v42
    v_add_f32 v46, v46, v50
    v_add_f32 v39, v39, v43
    v_add_f32 v47, v47, v51
    v_add_f32 v36, v36, v44
    v_add_f32 v37, v37, v45
    v_add_f32 v38, v38, v46
    v_add_f32 v39, v39, v47
    v_add_f32 v36, v36, v32
    v_add_f32 v37, v37, v33
    v_add_f32 v38, v38, v34
    v_add_f32 v39, v39, v35
    v_cvt_pk_bf16_f32 v36, v36, v37
    v_cvt_pk_bf16_f32 v37, v38, v39
    buffer_store_dwordx2 v[36:37], v4, s[20:23], s24 offen
    s_cmp_eq_u32 s36, 0
    s_cbranch_scc1 L_out_end
    s_mov_b32 s14, s35
    s_branch L_out_loop
L_out_end:
    s_waitcnt vmcnt(0)
    s_endpgm
L_att:
    v_and_b32 v10, 63, v0
    v_and_b32 v11, 15, v10
    v_lshrrev_b32 v12, 4, v10
    v_lshrrev_b32 v13, 2, v11
    v_lshlrev_b32 v1, 4, v10
    s_mul_i32 s20, s13, 14336
    s_add_u32 s20, s20, 0
    s_mov_b32 s21, 0x3e0293ee
    v_mov_b32 v7, 0xf149f2ca
    v_and_b32 v14, 3, v10
    v_lshlrev_b32 v14, 4, v14
    v_lshl_add_u32 v14, v13, 8, v14
    v_add_u32 v14, s20, v14
    v_and_b32 v3, 1, v13
    v_and_b32 v15, 1, v12
    v_lshl_add_u32 v3, v15, 1, v3
    v_lshlrev_b32 v3, 8, v3
    v_and_b32 v15, 2, v12
    v_lshl_add_u32 v3, v15, 6, v3
    v_and_b32 v15, 2, v13
    v_lshl_add_u32 v3, v15, 5, v3
    v_and_b32 v15, 3, v10
    v_lshl_add_u32 v3, v15, 4, v3
    v_add_u32 v3, s20, v3
    v_add_u32 v3, 8192, v3
    v_lshrrev_b32 v15, 1, v12
    v_lshl_add_u32 v14, v15, 10, v14
    v_and_b32 v15, 1, v12
    v_lshl_add_u32 v2, v15, 7, v14
    v_and_b32 v14, 1, v13
    v_lshlrev_b32 v14, 7, v14
    v_lshl_add_u32 v14, v12, 5, v14
    v_lshrrev_b32 v15, 1, v13
    v_lshl_add_u32 v14, v15, 3, v14
    v_and_b32 v15, 1, v10
    v_lshl_add_u32 v14, v15, 8, v14
    v_add_u32 v14, s20, v14
    v_add_u32 v4, 12288, v14
    v_lshlrev_b32 v5, 2, v11
    v_and_b32 v15, 1, v12
    v_lshl_add_u32 v14, v15, 5, v11
    v_lshlrev_b32 v14, 4, v14
    v_lshrrev_b32 v15, 1, v12
    v_lshl_add_u32 v6, v15, 10, v14
    s_mov_b32 s24, 0xfff0ffff
    s_mov_b32 s25, 0xf000ff00
    s_mov_b32 s26, 0xffe0fffe
    s_mov_b32 s27, 0xe000fe00
    s_mov_b32 s28, 0xffc0fffc
    s_mov_b32 s29, 0xc000fc00
    s_mov_b32 s30, 0xff80fff8
    s_mov_b32 s31, 0x8000f800
    s_mov_b32 s32, 0xff00fff0
    s_mov_b32 s33, 0xf000
    s_mov_b32 s34, 0xff00fff0
    s_mov_b32 s35, 0xf000
    s_mov_b32 s36, 0xff00fff0
    s_mov_b32 s37, 0xf000
    s_mov_b32 s38, 0xff00fff0
    s_mov_b32 s39, 0xf000
    s_mov_b32 s40, 0xfff0ffff
    s_mov_b32 s41, 0xf000ff00
    s_mov_b32 s42, 0xfff0ffff
    s_mov_b32 s43, 0xf000ff00
    s_mov_b32 s44, 0xfff0ffff
    s_mov_b32 s45, 0xf000ff00
    s_mov_b32 s46, 0xfff0ffff
    s_mov_b32 s47, 0xf000ff00
    s_mov_b32 s48, 0xfff0ffff
    s_mov_b32 s49, 0xf000ff00
    s_mov_b32 s50, 0xffe0fffe
    s_mov_b32 s51, 0xe000fe00
    s_mov_b32 s52, 0xffc0fffc
    s_mov_b32 s53, 0xc000fc00
    s_mov_b32 s54, 0xff80fff8
    s_mov_b32 s55, 0x8000f800
    s_mov_b32 s60, s93
    s_mov_b32 s61, 8
    s_mov_b32 s62, 117781504
    v_and_b32 v18, 0x1f0, v1
    v_lshlrev_b32 v18, 3, v18
L_att_loop:
    s_lshr_b32 s12, s60, 3
    s_and_b32 s14, s60, 7
    s_lshl_b32 s14, s14, 2
    s_add_u32 s14, s14, s13
    s_lshr_b32 s61, s12, 3
    s_mul_i32 s61, s61, 12288
    s_add_u32 s61, s61, 117785600
    v_and_b32 v11, 63, v0
    v_min_u32 v11, 63, v11
    v_lshlrev_b32 v11, 6, v11
    s_cmp_eq_u32 s13, 0
    s_cbranch_scc0 Lw_21_ok
    s_mov_b32 s97, 0
Lw_21:
    buffer_load_dword v10, v11, s[4:7], s61 offen sc1
    buffer_load_dword v12, v11, s[4:7], s61 offen offset:2048 sc1
    s_add_u32 s97, s97, 1
    s_cmp_gt_u32 s97, 0x20000
    s_cbranch_scc1 L_fail
    s_waitcnt vmcnt(0)
    v_and_b32 v10, v10, v12
    v_cmp_ne_u32 vcc, 1, v10
    s_cbranch_vccz Lw_21_ok
    s_sleep 16
    s_branch Lw_21
Lw_21_ok:
    s_barrier
    s_lshl_b32 s61, s60, 6
    s_add_u32 s61, s61, 117883904
    s_lshl_b32 s16, s12, 5
    s_add_u32 s16, s16, s14
    s_lshl_b32 s18, s16, 13
    s_add_u32 s17, s18, 0
    s_add_u32 s19, s17, 4096
    buffer_load_dwordx4 v[52:55], v1, s[4:7], s17 offen offset:0 sc1
    buffer_load_dwordx4 v[56:59], v1, s[4:7], s17 offen offset:1024 sc1
    buffer_load_dwordx4 v[60:63], v1, s[4:7], s17 offen offset:2048 sc1
    buffer_load_dwordx4 v[64:67], v1, s[4:7], s17 offen offset:3072 sc1
    buffer_load_dwordx4 v[68:71], v1, s[4:7], s19 offen offset:0 sc1
    buffer_load_dwordx4 v[72:75], v1, s[4:7], s19 offen offset:1024 sc1
    buffer_load_dwordx4 v[76:79], v1, s[4:7], s19 offen offset:2048 sc1
    buffer_load_dwordx4 v[80:83], v1, s[4:7], s19 offen offset:3072 sc1
    s_add_u32 s17, s18, 16777216
    s_add_u32 s19, s17, 4096
    buffer_load_dwordx4 v[20:23], v1, s[4:7], s17 offen offset:0 sc1
    buffer_load_dwordx4 v[24:27], v1, s[4:7], s17 offen offset:1024 sc1
    buffer_load_dwordx4 v[28:31], v1, s[4:7], s17 offen offset:2048 sc1
    buffer_load_dwordx4 v[32:35], v1, s[4:7], s17 offen offset:3072 sc1
    buffer_load_dwordx4 v[36:39], v1, s[4:7], s19 offen offset:0 sc1
    buffer_load_dwordx4 v[40:43], v1, s[4:7], s19 offen offset:1024 sc1
    buffer_load_dwordx4 v[44:47], v1, s[4:7], s19 offen offset:2048 sc1
    buffer_load_dwordx4 v[48:51], v1, s[4:7], s19 offen offset:3072 sc1
    s_lshl_b32 s17, s12, 7
    s_add_u32 s17, s17, 121634816
    buffer_load_dword v8, v5, s[4:7], s17 offen offset:0 sc1
    buffer_load_dword v9, v5, s[4:7], s17 offen offset:64 sc1
    s_add_u32 s17, s18, 33554432
    s_mov_b32 m0, s20
    s_add_u32 s19, s17, 4096
    buffer_load_dwordx4 v1, s[4:7], s17 offen offset:0 sc1 lds
    buffer_load_dwordx4 v1, s[4:7], s17 offen offset:1024 sc1 lds
    buffer_load_dwordx4 v1, s[4:7], s17 offen offset:2048 sc1 lds
    buffer_load_dwordx4 v1, s[4:7], s17 offen offset:3072 sc1 lds
    s_add_u32 m0, s20, 4096
    s_nop 0
    buffer_load_dwordx4 v1, s[4:7], s19 offen offset:0 sc1 lds
    buffer_load_dwordx4 v1, s[4:7], s19 offen offset:1024 sc1 lds
    buffer_load_dwordx4 v1, s[4:7], s19 offen offset:2048 sc1 lds
    buffer_load_dwordx4 v1, s[4:7], s19 offen offset:3072 sc1 lds
    s_waitcnt vmcnt(10)
    v_mfma_f32_16x16x32_bf16 v[100:103], v[20:23], v[52:55], 0
    v_mfma_f32_16x16x32_bf16 v[104:107], v[24:27], v[52:55], 0
    v_mfma_f32_16x16x32_bf16 v[112:115], v[20:23], v[56:59], 0
    v_mfma_f32_16x16x32_bf16 v[116:119], v[24:27], v[56:59], 0
    v_mfma_f32_16x16x32_bf16 v[100:103], v[28:31], v[60:63], v[100:103]
    v_mfma_f32_16x16x32_bf16 v[104:107], v[32:35], v[60:63], v[104:107]
    v_mfma_f32_16x16x32_bf16 v[112:115], v[28:31], v[64:67], v[112:115]
    v_mfma_f32_16x16x32_bf16 v[116:119], v[32:35], v[64:67], v[116:119]
    v_mfma_f32_16x16x32_bf16 v[100:103], v[36:39], v[68:71], v[100:103]
    v_mfma_f32_16x16x32_bf16 v[104:107], v[40:43], v[68:71], v[104:107]
    v_mfma_f32_16x16x32_bf16 v[112:115], v[36:39], v[72:75], v[112:115]
    v_mfma_f32_16x16x32_bf16 v[116:119], v[40:43], v[72:75], v[116:119]
    v_mfma_f32_16x16x32_bf16 v[100:103], v[44:47], v[76:79], v[100:103]
    v_mfma_f32_16x16x32_bf16 v[104:107], v[48:51], v[76:79], v[104:107]
    v_mfma_f32_16x16x32_bf16 v[112:115], v[44:47], v[80:83], v[112:115]
    v_mfma_f32_16x16x32_bf16 v[116:119], v[48:51], v[80:83], v[116:119]
    s_waitcnt vmcnt(0)
    ds_read_b64_tr_b16 v[124:125], v2 offset:0
    ds_read_b64_tr_b16 v[126:127], v2 offset:64
    ds_read_b64_tr_b16 v[130:131], v2 offset:8
    ds_read_b64_tr_b16 v[132:133], v2 offset:72
    ds_read_b64_tr_b16 v[136:137], v2 offset:2048
    ds_read_b64_tr_b16 v[138:139], v2 offset:2112
    ds_read_b64_tr_b16 v[142:143], v2 offset:2056
    ds_read_b64_tr_b16 v[144:145], v2 offset:2120
    ds_read_b64_tr_b16 v[148:149], v2 offset:4096
    ds_read_b64_tr_b16 v[150:151], v2 offset:4160
    s_waitcnt lgkmcnt(4)
    ds_read_b64_tr_b16 v[154:155], v2 offset:4104
    ds_read_b64_tr_b16 v[156:157], v2 offset:4168
    ds_read_b64_tr_b16 v[160:161], v2 offset:6144
    ds_read_b64_tr_b16 v[162:163], v2 offset:6208
    ds_read_b64_tr_b16 v[166:167], v2 offset:6152
    ds_read_b64_tr_b16 v[168:169], v2 offset:6216
    v_cndmask_b32 v100, v7, v100, s[24:25]
    v_cndmask_b32 v101, v7, v101, s[26:27]
    v_cndmask_b32 v102, v7, v102, s[28:29]
    v_cndmask_b32 v103, v7, v103, s[30:31]
    v_cndmask_b32 v104, v7, v104, s[32:33]
    v_cndmask_b32 v105, v7, v105, s[34:35]
    v_cndmask_b32 v106, v7, v106, s[36:37]
    v_cndmask_b32 v107, v7, v107, s[38:39]
    v_cndmask_b32 v112, v7, v112, s[40:41]
    v_cndmask_b32 v113, v7, v113, s[42:43]
    v_cndmask_b32 v114, v7, v114, s[44:45]
    v_cndmask_b32 v115, v7, v115, s[46:47]
    v_cndmask_b32 v116, v7, v116, s[48:49]
    v_cndmask_b32 v117, v7, v117, s[50:51]
    v_cndmask_b32 v118, v7, v118, s[52:53]
    v_cndmask_b32 v119, v7, v119, s[54:55]
    s_waitcnt lgkmcnt(0)
    s_cmp_eq_u32 s13, 0
    s_cbranch_scc0 Lw_22_ok
    s_mov_b32 s97, 0
Lw_22:
    buffer_load_dword v10, v18, s[4:7], s62 offen sc1
    s_add_u32 s97, s97, 1
    s_cmp_gt_u32 s97, 0x20000
    s_cbranch_scc1 L_fail
    s_waitcnt vmcnt(0)
    v_cmp_ge_u32 vcc, s12, v10
    s_cbranch_vccz Lw_22_ok
    s_sleep 3
    s_branch Lw_22
Lw_22_ok:
    s_barrier
    s_lshl_b32 s17, s16, 11
    s_add_u32 s17, s17, 100663296
    s_add_u32 m0, s20, 12288
    s_lshl_b32 s19, s16, 12
    buffer_load_dwordx4 v1, s[4:7], s17 offen sc1 lds
    buffer_load_dwordx4 v1, s[4:7], s17 offen offset:1024 sc1 lds
    s_add_u32 m0, s20, 8192
    s_add_u32 s19, s19, 105906176
    buffer_load_dwordx4 v1, s[4:7], s19 offen offset:0 sc1 lds
    buffer_load_dwordx4 v1, s[4:7], s19 offen offset:1024 sc1 lds
    buffer_load_dwordx4 v1, s[4:7], s19 offen offset:2048 sc1 lds
    buffer_load_dwordx4 v1, s[4:7], s19 offen offset:3072 sc1 lds
    s_waitcnt vmcnt(4)
    ds_read_b64_tr_b16 v[84:85], v4 offset:0
    ds_read_b64_tr_b16 v[86:87], v4 offset:16
    ds_read_b64_tr_b16 v[88:89], v4 offset:512
    ds_read_b64_tr_b16 v[90:91], v4 offset:528
    ds_read_b64_tr_b16 v[92:93], v4 offset:1024
    ds_read_b64_tr_b16 v[94:95], v4 offset:1040
    ds_read_b64_tr_b16 v[96:97], v4 offset:1536
    ds_read_b64_tr_b16 v[98:99], v4 offset:1552
    s_waitcnt lgkmcnt(0)
    v_mfma_f32_16x16x32_bf16 v[108:111], v[84:87], v[52:55], 0
    v_mfma_f32_16x16x32_bf16 v[120:123], v[84:87], v[56:59], 0
    v_mfma_f32_16x16x32_bf16 v[108:111], v[88:91], v[60:63], v[108:111]
    v_mfma_f32_16x16x32_bf16 v[120:123], v[88:91], v[64:67], v[120:123]
    v_mfma_f32_16x16x32_bf16 v[108:111], v[92:95], v[68:71], v[108:111]
    v_mfma_f32_16x16x32_bf16 v[120:123], v[92:95], v[72:75], v[120:123]
    v_mfma_f32_16x16x32_bf16 v[108:111], v[96:99], v[76:79], v[108:111]
    v_mfma_f32_16x16x32_bf16 v[120:123], v[96:99], v[80:83], v[120:123]
    s_waitcnt vmcnt(0)
    ds_read_b64_tr_b16 v[128:129], v3 offset:0
    ds_read_b64_tr_b16 v[134:135], v3 offset:8
    ds_read_b64_tr_b16 v[140:141], v3 offset:1024
    ds_read_b64_tr_b16 v[146:147], v3 offset:1032
    ds_read_b64_tr_b16 v[152:153], v3 offset:2048
    ds_read_b64_tr_b16 v[158:159], v3 offset:2056
    ds_read_b64_tr_b16 v[164:165], v3 offset:3072
    ds_read_b64_tr_b16 v[170:171], v3 offset:3080
    v_max3_f32 v10, v100, v101, v102
    v_max3_f32 v10, v10, v103, v104
    v_max3_f32 v10, v10, v105, v106
    v_max3_f32 v10, v10, v107, v108
    v_max3_f32 v10, v10, v109, v110
    v_max_f32 v10, v10, v111
    v_mov_b32 v11, v10
    s_nop 1
    v_permlane16_swap_b32 v10, v11
    v_max_f32 v10, v10, v11
    v_mov_b32 v11, v10
    s_nop 1
    v_permlane32_swap_b32 v10, v11
    v_max_f32 v10, v10, v11
    v_mul_f32_e64 v12, -s21, v10
    v_fma_f32 v100, v100, s21, v12
    v_fma_f32 v101, v101, s21, v12
    v_fma_f32 v102, v102, s21, v12
    v_fma_f32 v103, v103, s21, v12
    v_fma_f32 v104, v104, s21, v12
    v_fma_f32 v105, v105, s21, v12
    v_fma_f32 v106, v106, s21, v12
    v_fma_f32 v107, v107, s21, v12
    v_fma_f32 v108, v108, s21, v12
    v_fma_f32 v109, v109, s21, v12
    v_fma_f32 v110, v110, s21, v12
    v_fma_f32 v111, v111, s21, v12
    v_exp_f32 v100, v100
    v_exp_f32 v101, v101
    v_exp_f32 v102, v102
    v_exp_f32 v103, v103
    v_exp_f32 v104, v104
    v_exp_f32 v105, v105
    v_exp_f32 v106, v106
    v_exp_f32 v107, v107
    v_exp_f32 v108, v108
    v_exp_f32 v109, v109
    v_exp_f32 v110, v110
    v_exp_f32 v111, v111
    v_add_f32 v10, v108, v109
    v_add_f32 v11, v110, v111
    v_add_f32 v10, v10, v11
    v_mul_f32 v10, 0.5, v10
    v_add_f32 v10, v10, v100
    v_add_f32 v10, v10, v101
    v_add_f32 v10, v10, v102
    v_add_f32 v10, v10, v103
    v_add_f32 v10, v10, v104
    v_add_f32 v10, v10, v105
    v_add_f32 v10, v10, v106
    v_add_f32 v10, v10, v107
    v_mov_b32 v11, v10
    s_nop 1
    v_permlane16_swap_b32 v10, v11
    v_add_f32 v10, v10, v11
    v_mov_b32 v11, v10
    s_nop 1
    v_permlane32_swap_b32 v10, v11
    v_add_f32 v10, v10, v11
    v_rcp_f32 v10, v10
    s_nop 0
    v_mul_f32 v10, v10, v8
    v_mul_f32 v100, v100, v10
    v_mul_f32 v101, v101, v10
    v_mul_f32 v102, v102, v10
    v_mul_f32 v103, v103, v10
    v_mul_f32 v104, v104, v10
    v_mul_f32 v105, v105, v10
    v_mul_f32 v106, v106, v10
    v_mul_f32 v107, v107, v10
    v_mul_f32 v108, v108, v10
    v_mul_f32 v109, v109, v10
    v_mul_f32 v110, v110, v10
    v_mul_f32 v111, v111, v10
    v_cvt_pk_bf16_f32 v100, v100, v101
    v_cvt_pk_bf16_f32 v101, v102, v103
    v_cvt_pk_bf16_f32 v102, v104, v105
    v_cvt_pk_bf16_f32 v103, v106, v107
    v_cvt_pk_bf16_f32 v104, v108, v109
    v_cvt_pk_bf16_f32 v105, v110, v111
    v_max3_f32 v13, v112, v113, v114
    v_max3_f32 v13, v13, v115, v116
    v_max3_f32 v13, v13, v117, v118
    v_max3_f32 v13, v13, v119, v120
    v_max3_f32 v13, v13, v121, v122
    v_max_f32 v13, v13, v123
    v_mov_b32 v14, v13
    s_nop 1
    v_permlane16_swap_b32 v13, v14
    v_max_f32 v13, v13, v14
    v_mov_b32 v14, v13
    s_nop 1
    v_permlane32_swap_b32 v13, v14
    v_max_f32 v13, v13, v14
    v_mul_f32_e64 v15, -s21, v13
    v_fma_f32 v112, v112, s21, v15
    v_fma_f32 v113, v113, s21, v15
    v_fma_f32 v114, v114, s21, v15
    v_fma_f32 v115, v115, s21, v15
    v_fma_f32 v116, v116, s21, v15
    v_fma_f32 v117, v117, s21, v15
    v_fma_f32 v118, v118, s21, v15
    v_fma_f32 v119, v119, s21, v15
    v_fma_f32 v120, v120, s21, v15
    v_fma_f32 v121, v121, s21, v15
    v_fma_f32 v122, v122, s21, v15
    v_fma_f32 v123, v123, s21, v15
    v_exp_f32 v112, v112
    v_exp_f32 v113, v113
    v_exp_f32 v114, v114
    v_exp_f32 v115, v115
    v_exp_f32 v116, v116
    v_exp_f32 v117, v117
    v_exp_f32 v118, v118
    v_exp_f32 v119, v119
    v_exp_f32 v120, v120
    v_exp_f32 v121, v121
    v_exp_f32 v122, v122
    v_exp_f32 v123, v123
    v_add_f32 v13, v120, v121
    v_add_f32 v14, v122, v123
    v_add_f32 v13, v13, v14
    v_mul_f32 v13, 0.5, v13
    v_add_f32 v13, v13, v112
    v_add_f32 v13, v13, v113
    v_add_f32 v13, v13, v114
    v_add_f32 v13, v13, v115
    v_add_f32 v13, v13, v116
    v_add_f32 v13, v13, v117
    v_add_f32 v13, v13, v118
    v_add_f32 v13, v13, v119
    v_mov_b32 v14, v13
    s_nop 1
    v_permlane16_swap_b32 v13, v14
    v_add_f32 v13, v13, v14
    v_mov_b32 v14, v13
    s_nop 1
    v_permlane32_swap_b32 v13, v14
    v_add_f32 v13, v13, v14
    v_rcp_f32 v13, v13
    s_nop 0
    v_mul_f32 v13, v13, v9
    v_mul_f32 v112, v112, v13
    v_mul_f32 v113, v113, v13
    v_mul_f32 v114, v114, v13
    v_mul_f32 v115, v115, v13
    v_mul_f32 v116, v116, v13
    v_mul_f32 v117, v117, v13
    v_mul_f32 v118, v118, v13
    v_mul_f32 v119, v119, v13
    v_mul_f32 v120, v120, v13
    v_mul_f32 v121, v121, v13
    v_mul_f32 v122, v122, v13
    v_mul_f32 v123, v123, v13
    v_cvt_pk_bf16_f32 v112, v112, v113
    v_cvt_pk_bf16_f32 v113, v114, v115
    v_cvt_pk_bf16_f32 v114, v116, v117
    v_cvt_pk_bf16_f32 v115, v118, v119
    v_cvt_pk_bf16_f32 v116, v120, v121
    v_cvt_pk_bf16_f32 v117, v122, v123
    s_waitcnt lgkmcnt(0)
    v_mfma_f32_16x16x32_bf16 v[172:175], v[124:127], v[100:103], 0
    v_mfma_f32_16x16x32_bf16 v[176:179], v[130:133], v[100:103], 0
    v_mfma_f32_16x16x32_bf16 v[180:183], v[136:139], v[100:103], 0
    v_mfma_f32_16x16x32_bf16 v[184:187], v[142:145], v[100:103], 0
    v_mfma_f32_16x16x32_bf16 v[188:191], v[148:151], v[100:103], 0
    v_mfma_f32_16x16x32_bf16 v[192:195], v[154:157], v[100:103], 0
    v_mfma_f32_16x16x32_bf16 v[196:199], v[160:163], v[100:103], 0
    v_mfma_f32_16x16x32_bf16 v[200:203], v[166:169], v[100:103], 0
    v_mfma_f32_16x16x32_bf16 v[204:207], v[124:127], v[112:115], 0
    v_mfma_f32_16x16x32_bf16 v[208:211], v[130:133], v[112:115], 0
    v_mfma_f32_16x16x32_bf16 v[212:215], v[136:139], v[112:115], 0
    v_mfma_f32_16x16x32_bf16 v[216:219], v[142:145], v[112:115], 0
    v_mfma_f32_16x16x32_bf16 v[220:223], v[148:151], v[112:115], 0
    v_mfma_f32_16x16x32_bf16 v[224:227], v[154:157], v[112:115], 0
    v_mfma_f32_16x16x32_bf16 v[228:231], v[160:163], v[112:115], 0
    v_mfma_f32_16x16x32_bf16 v[232:235], v[166:169], v[112:115], 0
    v_mfma_f32_16x16x16_bf16 v[172:175], v[128:129], v[104:105], v[172:175]
    v_mfma_f32_16x16x16_bf16 v[176:179], v[134:135], v[104:105], v[176:179]
    v_mfma_f32_16x16x16_bf16 v[180:183], v[140:141], v[104:105], v[180:183]
    v_mfma_f32_16x16x16_bf16 v[184:187], v[146:147], v[104:105], v[184:187]
    v_mfma_f32_16x16x16_bf16 v[188:191], v[152:153], v[104:105], v[188:191]
    v_mfma_f32_16x16x16_bf16 v[192:195], v[158:159], v[104:105], v[192:195]
    v_mfma_f32_16x16x16_bf16 v[196:199], v[164:165], v[104:105], v[196:199]
    v_mfma_f32_16x16x16_bf16 v[200:203], v[170:171], v[104:105], v[200:203]
    v_mfma_f32_16x16x16_bf16 v[204:207], v[128:129], v[116:117], v[204:207]
    v_mfma_f32_16x16x16_bf16 v[208:211], v[134:135], v[116:117], v[208:211]
    v_mfma_f32_16x16x16_bf16 v[212:215], v[140:141], v[116:117], v[212:215]
    v_mfma_f32_16x16x16_bf16 v[216:219], v[146:147], v[116:117], v[216:219]
    v_mfma_f32_16x16x16_bf16 v[220:223], v[152:153], v[116:117], v[220:223]
    v_mfma_f32_16x16x16_bf16 v[224:227], v[158:159], v[116:117], v[224:227]
    v_mfma_f32_16x16x16_bf16 v[228:231], v[164:165], v[116:117], v[228:231]
    v_mfma_f32_16x16x16_bf16 v[232:235], v[170:171], v[116:117], v[232:235]
    s_lshl_b32 s17, s16, 13
    s_add_u32 s17, s17, 75497472
    s_add_u32 s19, s17, 4096
    v_cvt_pk_bf16_f32 v172, v172, v173
    v_cvt_pk_bf16_f32 v173, v174, v175
    v_cvt_pk_bf16_f32 v174, v176, v177
    v_cvt_pk_bf16_f32 v175, v178, v179
    buffer_store_dwordx4 v[172:175], v6, s[4:7], s17 offen offset:0 sc1
    v_cvt_pk_bf16_f32 v180, v180, v181
    v_cvt_pk_bf16_f32 v181, v182, v183
    v_cvt_pk_bf16_f32 v182, v184, v185
    v_cvt_pk_bf16_f32 v183, v186, v187
    buffer_store_dwordx4 v[180:183], v6, s[4:7], s17 offen offset:2048 sc1
    v_cvt_pk_bf16_f32 v188, v188, v189
    v_cvt_pk_bf16_f32 v189, v190, v191
    v_cvt_pk_bf16_f32 v190, v192, v193
    v_cvt_pk_bf16_f32 v191, v194, v195
    buffer_store_dwordx4 v[188:191], v6, s[4:7], s19 offen offset:0 sc1
    v_cvt_pk_bf16_f32 v196, v196, v197
    v_cvt_pk_bf16_f32 v197, v198, v199
    v_cvt_pk_bf16_f32 v198, v200, v201
    v_cvt_pk_bf16_f32 v199, v202, v203
    buffer_store_dwordx4 v[196:199], v6, s[4:7], s19 offen offset:2048 sc1
    v_cvt_pk_bf16_f32 v204, v204, v205
    v_cvt_pk_bf16_f32 v205, v206, v207
    v_cvt_pk_bf16_f32 v206, v208, v209
    v_cvt_pk_bf16_f32 v207, v210, v211
    buffer_store_dwordx4 v[204:207], v6, s[4:7], s17 offen offset:256 sc1
    v_cvt_pk_bf16_f32 v212, v212, v213
    v_cvt_pk_bf16_f32 v213, v214, v215
    v_cvt_pk_bf16_f32 v214, v216, v217
    v_cvt_pk_bf16_f32 v215, v218, v219
    buffer_store_dwordx4 v[212:215], v6, s[4:7], s17 offen offset:2304 sc1
    v_cvt_pk_bf16_f32 v220, v220, v221
    v_cvt_pk_bf16_f32 v221, v222, v223
    v_cvt_pk_bf16_f32 v222, v224, v225
    v_cvt_pk_bf16_f32 v223, v226, v227
    buffer_store_dwordx4 v[220:223], v6, s[4:7], s19 offen offset:256 sc1
    v_cvt_pk_bf16_f32 v228, v228, v229
    v_cvt_pk_bf16_f32 v229, v230, v231
    v_cvt_pk_bf16_f32 v230, v232, v233
    v_cvt_pk_bf16_f32 v231, v234, v235
    buffer_store_dwordx4 v[228:231], v6, s[4:7], s19 offen offset:2304 sc1
    s_waitcnt vmcnt(0)
    s_barrier
    s_cmp_eq_u32 s13, 0
    s_cbranch_scc0 Lsg_23
    s_mov_b64 exec, 1
    v_mov_b32 v10, 1
    buffer_store_dword v10, off, s[4:7], s61 sc1
    s_mov_b64 exec, -1
Lsg_23:
    s_add_u32 s60, s60, 84
    s_cmp_lt_u32 s60, 512
    s_cbranch_scc1 L_att_loop
    s_endpgm
.section .rodata,"a"
.p2align 6
.amdhsa_kernel gated_mix__memory_aug_recurrent_mem_tr__glu_gated_bilinear__prompt_kernel
  .amdhsa_next_free_vgpr 512
  .amdhsa_next_free_sgpr 102
  .amdhsa_accum_offset 256
  .amdhsa_group_segment_fixed_size 0
  .amdhsa_kernarg_size 120
  .amdhsa_user_sgpr_count 2
  .amdhsa_user_sgpr_kernarg_segment_ptr 1
  .amdhsa_system_sgpr_workgroup_id_x 1
.end_amdhsa_kernel
```
